```python
import torch

def _softmax(x, axis=-1):
    return torch.softmax(x, dim=axis)
def _gelu(x):
    return torch.nn.functional.gelu(x, approximate="tanh")
def _silu(x):
    return torch.nn.functional.silu(x)
def _sigmoid(x):
    return torch.sigmoid(x)
def _layernorm(x, axis=-1, eps=1e-5):
    m = x.mean(dim=axis, keepdim=True)
    v = x.var(dim=axis, keepdim=True, unbiased=False)
    return (x - m) / torch.sqrt(v + eps)
def _scatter_add(tgt, idx, src, axis=0):
    return tgt.clone().index_add_(axis, idx, src)
def _segment_sum(src, seg, n):
    out = torch.zeros((n,) + src.shape[1:], dtype=src.dtype)
    return out.index_add_(0, seg, src)
def _pad(x, pw):
    flat = tuple(v for pair in reversed(pw) for v in pair)
    return torch.nn.functional.pad(x, flat)

kernel_name = 'interleave_layers__spectral_fnet__swiglu_ffn__prompt'

def setup_inputs():

    _w = (lambda a: (lambda t: t.to(torch.bfloat16) if t.is_floating_point() else t)(torch.as_tensor(a)))
    def _A_setup():
        B, S, D = 1, 2048, 448
        ns = torch.arange(S)[:, None] * torch.arange(S)[None, :]
        nd = torch.arange(D)[:, None] * torch.arange(D)[None, :]
        Ws_re = torch.cos(-2.0 * torch.pi * ns / S).to(float)
        Ws_im = torch.sin(-2.0 * torch.pi * ns / S).to(float)
        Wd_re = torch.cos(-2.0 * torch.pi * nd / D).to(float)
        Wd_im = torch.sin(-2.0 * torch.pi * nd / D).to(float)
        return {
            "x": _w((lambda *s: torch.randn(*s, dtype=torch.bfloat16) * 0.05)(B, S, D)),
            "dft_seq_re": _w(Ws_re),
            "dft_seq_im": _w(Ws_im),
            "dft_hid_re": _w(Wd_re),
            "dft_hid_im": _w(Wd_im),
        }
    _A_in = _A_setup()

    def _B_setup():
        B, S, D, F = 1, 2048, 448, 1792
        return {
            "x": _w((lambda *s: torch.randn(*s, dtype=torch.bfloat16) * 0.05)(B, S, D)),
            "w_gate": _w((lambda *s: torch.randn(*s, dtype=torch.bfloat16) * 0.4)(D, F)),
            "w_up": _w((lambda *s: torch.randn(*s, dtype=torch.bfloat16) * 0.4)(D, F)),
            "w_down": _w((lambda *s: torch.randn(*s, dtype=torch.bfloat16) * 0.4)(F, D)),
        }
    _B_in = _B_setup()

    return {
        "A_x": _A_in["x"],
        "A_dft_seq_re": _A_in["dft_seq_re"],
        "A_dft_seq_im": _A_in["dft_seq_im"],
        "A_dft_hid_re": _A_in["dft_hid_re"],
        "A_dft_hid_im": _A_in["dft_hid_im"],
        "B_x": _B_in["x"],
        "B_w_gate": _B_in["w_gate"],
        "B_w_up": _B_in["w_up"],
        "B_w_down": _B_in["w_down"],
    }

def reference(A_x, A_dft_seq_re, A_dft_seq_im, A_dft_hid_re, A_dft_hid_im, B_x, B_w_gate, B_w_up, B_w_down):
    def _A_ref(x, dft_seq_re, dft_seq_im, dft_hid_re, dft_hid_im):
        a = torch.einsum("bsd,ed->bse", x, dft_hid_re)
        b = torch.einsum("bsd,ed->bse", x, dft_hid_im)
        y = torch.einsum("ts,bse->bte", dft_seq_re, a) - torch.einsum("ts,bse->bte", dft_seq_im, b)
        return y

    def _B_ref(x, w_gate, w_up, w_down):
        g = _silu(x @ w_gate)
        u = x @ w_up
        return (g * u) @ w_down

    x = A_x
    x = x + _A_ref(_layernorm(x, axis=-1), A_dft_seq_re, A_dft_seq_im, A_dft_hid_re, A_dft_hid_im)
    x = x + _B_ref(_layernorm(x, axis=-1), B_w_gate, B_w_up, B_w_down)
    x = x + _A_ref(_layernorm(x, axis=-1), A_dft_seq_re, A_dft_seq_im, A_dft_hid_re, A_dft_hid_im)
    x = x + _B_ref(_layernorm(x, axis=-1), B_w_gate, B_w_up, B_w_down)
    return x
```

```asm
; @launch grid=(224,1,1) block=(256,1,1) lds=163840
.amdgcn_target "amdgcn-amd-amdhsa--gfx950"
.text
.p2align 12
.fill 832, 4, 0xbf810000
.globl interleave_layers__spectral_fnet__swiglu_ffn__prompt_kernel
.p2align 8
.type interleave_layers__spectral_fnet__swiglu_ffn__prompt_kernel,@function
interleave_layers__spectral_fnet__swiglu_ffn__prompt_kernel:
  s_cmp_ge_u32 s2, 224
  s_cbranch_scc1 L_exit
  s_load_dwordx2 s[40:41], s[0:1], 0
  s_load_dwordx4 s[52:55], s[0:1], 48
  s_load_dwordx8 s[56:63], s[0:1], 64
  s_memrealtime s[38:39]
  s_getpc_b64 s[34:35]
L_pc:
  v_lshrrev_b32 v1, 6, v0
  v_and_b32 v253, 63, v0
  v_readfirstlane_b32 s64, v1
  v_lshlrev_b32 v255, 4, v253
  s_lshr_b32 s89, s2, 3
  s_lshl_b32 s88, s89, 12
  v_lshl_add_u32 v243, v0, 4, s88
  v_min_u32 v243, L_code_end-L_pc-16, v243
  global_load_dwordx4 v[232:235], v243, s[34:35]
  s_mov_b32 s75, 0
  s_and_b32 s88, s2, 7
  s_mul_i32 s92, s89, 37
  s_lshr_b32 s92, s92, 8
  s_mul_i32 s93, s92, 7
  s_sub_u32 s65, s89, s93
  s_lshr_b32 s93, s88, 1
  s_lshl_b32 s93, s93, 2
  s_add_u32 s66, s93, s92
  s_and_b32 s88, s88, 1
  s_sub_u32 s93, 32, s66
  s_cmp_eq_u32 s66, 0
  s_cselect_b32 s93, 16, s93
  s_cmp_eq_u32 s88, 0
  s_cselect_b32 s67, s66, s93
  s_cselect_b32 s68, s93, s66
  s_mul_i32 s88, s88, 7
  s_add_u32 s69, s65, s88
  s_and_b32 s74, s64, 1
  s_lshr_b32 s73, s64, 1
  s_lshl_b32 s88, s74, 5
  s_add_u32 s71, s67, s88
  s_add_u32 s89, s68, s88
  s_cmp_eq_u32 s73, 0
  s_cselect_b32 s70, s71, s89
  s_cselect_b32 s86, 96, -15
  s_mul_i32 s92, s71, 896
  s_mul_i32 s93, s89, 896
  s_mul_i32 s100, s74, 28672
  s_add_u32 s100, s100, 4096
  s_lshl_b32 s3, s73, 11
  s_add_u32 s3, s3, s100
  v_lshrrev_b32 v2, 3, v253
  s_lshl_b32 s88, s73, 4
  v_add_u32 v2, s88, v2
  v_mul_u32_u24 v2, 57344, v2
  v_lshrrev_b32 v3, 4, v253
  v_xor_b32 v3, v3, v253
  v_and_b32 v3, 7, v3
  v_lshl_add_u32 v241, v3, 4, v2
  v_xor_b32 v242, 64, v241
  v_add_u32 v242, 457728, v242
  s_mov_b32 s10, 1835008
  s_mov_b32 s11, 0x20000
  s_lshl_b32 s24, s65, 12
  s_add_u32 s25, s24, 4096
  s_cmp_eq_u32 s25, 28672
  s_cselect_b32 s25, 0, s25
  s_add_u32 s26, s25, 4096
  s_cmp_eq_u32 s26, 28672
  s_cselect_b32 s26, 0, s26
  s_add_u32 s27, s26, 4096
  s_cmp_eq_u32 s27, 28672
  s_cselect_b32 s27, 0, s27
  s_add_u32 s28, s27, 4096
  s_cmp_eq_u32 s28, 28672
  s_cselect_b32 s28, 0, s28
  s_add_u32 s29, s28, 4096
  s_cmp_eq_u32 s29, 28672
  s_cselect_b32 s29, 0, s29
  s_add_u32 s30, s29, 4096
  s_cmp_eq_u32 s30, 28672
  s_cselect_b32 s30, 0, s30
  v_lshlrev_b32 v239, 4, v0
  s_mul_i32 s44, s2, 7168
  s_lshl_b32 s84, s64, 10
  s_mov_b32 s18, 1605632
  s_mov_b32 s19, 0x20000
  s_add_u32 s101, s3, 57344
  s_add_u32 m0, s3, s24
  s_lshl_b32 s88, s65, 7
  s_add_u32 s88, s88, s92
  s_waitcnt lgkmcnt(0)
  s_mov_b32 s21, s59
  s_mov_b32 s59, s88
  s_mov_b32 s8, s40
  s_mov_b32 s9, s41
  buffer_load_dwordx4 v241, s[8:11], s59 offen lds
  buffer_load_dwordx4 v242, s[8:11], s59 offen offset:1024 lds
  s_add_u32 m0, s3, s25
  s_lshr_b32 s59, s25, 5
  s_add_u32 s59, s59, s92
  buffer_load_dwordx4 v241, s[8:11], s59 offen lds
  buffer_load_dwordx4 v242, s[8:11], s59 offen offset:1024 lds
  s_add_u32 m0, s3, s26
  s_lshr_b32 s59, s26, 5
  s_add_u32 s59, s59, s92
  buffer_load_dwordx4 v241, s[8:11], s59 offen lds
  buffer_load_dwordx4 v242, s[8:11], s59 offen offset:1024 lds
  s_mov_b32 s16, s56
  s_mov_b32 s17, s57
  s_add_u32 m0, s84, 135168
  s_nop 0
  buffer_load_dwordx4 v239, s[16:19], s44 offen lds
  buffer_load_dwordx4 v239, s[16:19], s44 offen offset:3072 lds
  s_add_u32 m0, s3, s27
  s_lshr_b32 s59, s27, 5
  s_add_u32 s59, s59, s92
  buffer_load_dwordx4 v241, s[8:11], s59 offen lds
  buffer_load_dwordx4 v242, s[8:11], s59 offen offset:1024 lds
  s_mov_b32 s36, s60
  s_mov_b32 s37, s61
  s_or_b32 s88, s2, s64
  s_cmp_lg_u32 s88, 0
  s_cbranch_scc1 L_nopub
  s_or_b32 s38, s38, 1
  v_mov_b32 v108, s38
  v_mov_b32 v109, s39
  s_mov_b64 exec, 1
  global_store_dwordx2 v255, v[108:109], s[36:37] sc1
  s_mov_b64 exec, -1
L_nopub:
  s_add_u32 s4, s62, 0
  s_addc_u32 s5, s63, 0
  s_mov_b32 s6, 268435456
  s_mov_b32 s7, 0x20000
  s_mov_b32 s20, s58
  s_movk_i32 s57, 224
  s_mov_b32 s58, 229376
  v_sub_u32 v1, 448, v0
  v_min_u32 v1, v1, v0
  v_cmp_eq_u32 vcc, s57, v0
  s_nop 1
  v_cndmask_b32_e64 v1, v1, 0, vcc
  v_cmp_gt_u32 vcc, s57, v0
  s_nop 1
  v_cndmask_b32_e64 v110, 64, 0, vcc
  s_min_u32 s57, s64, 2
  s_lshl_b32 s57, s57, 6
  s_sub_u32 s45, 192, s57
  v_and_or_b32 v110, v1, 3, v110
  v_bfe_u32 v3, v1, 2, 2
  v_lshl_add_u32 v110, v3, 3, v110
  v_bfe_u32 v3, v1, 4, 1
  v_lshl_add_u32 v110, v3, 2, v110
  v_lshrrev_b32 v2, 5, v1
  v_lshlrev_b32 v110, 4, v110
  v_mad_u32_u24 v110, v2, s58, v110
  v_sub_u32 v1, s45, v253
  v_and_b32 v111, 3, v1
  v_bfe_u32 v3, v1, 2, 2
  v_lshl_add_u32 v111, v3, 3, v111
  v_bfe_u32 v3, v1, 4, 1
  v_lshl_add_u32 v111, v3, 2, v111
  v_lshrrev_b32 v2, 5, v1
  v_lshlrev_b32 v111, 4, v111
  v_mad_u32_u24 v111, v2, s58, v111
  v_bfe_u32 v1, v253, 2, 2
  v_mul_u32_u24 v1, 896, v1
  v_lshrrev_b32 v2, 4, v253
  v_lshl_add_u32 v1, v2, 5, v1
  v_and_b32 v2, 3, v253
  v_lshl_add_u32 v1, v2, 3, v1
  s_lshl1_add_u32 s57, s57, 135680
  v_add_u32 v225, s57, v1
  s_lshl_b32 s57, s64, 7
  s_add_u32 s57, s57, 135168
  v_add_u32 v224, s57, v1
  s_lshr_b32 s57, s2, 1
  s_lshl_b32 s57, s57, 11
  s_and_b32 s58, s2, 1
  s_lshl_b32 s58, s58, 9
  s_add_u32 s57, s57, s58
  s_add_u32 s45, s57, 29360128
  s_lshl_b32 s80, s64, 8
  s_add_u32 s80, s80, s2
  s_lshl_b32 s80, s80, 7
  s_add_u32 s81, s80, 34865152
  s_add_u32 s80, s80, 131072
  s_min_u32 s94, s66, 13
  s_lshr_b32 s95, s94, 1
  s_and_b32 s94, s94, 1
  v_bfe_u32 v108, v253, 4, 1
  v_lshlrev_b32 v108, 2, v108
  v_and_b32 v109, 7, v253
  v_xor_b32 v108, v108, v109
  s_lshl_b32 s96, s73, 1
  v_xor_b32 v108, s96, v108
  s_lshl_b32 s96, s69, 8
  v_lshl_add_u32 v108, v108, 4, s96
  s_lshl_b32 s96, s74, 4
  s_lshl_b32 s97, s95, 5
  s_add_u32 s96, s96, s97
  v_lshrrev_b32 v38, 3, v253
  v_add_u32 v38, s96, v38
  s_cmp_eq_u32 s94, 0
  s_cselect_b32 s96, 0, -1
  s_cselect_b32 s97, 0, 449
  s_cselect_b32 s98, 8, -8
  s_movk_i32 s99, 448
  v_xor_b32 v38, s96, v38
  v_add_u32 v38, s97, v38
  v_add_u32 v39, s98, v38
  v_cmp_eq_u32 vcc, s99, v38
  v_mov_b32 v109, 224
  s_movk_i32 s99, 3584
  v_cndmask_b32 v38, v38, v109, vcc
  v_mad_u32_u24 v39, v39, s99, v108
  v_mad_u32_u24 v38, v38, s99, v108
  s_movk_i32 s98, 128
  s_cmp_eq_u32 s73, 0
  s_cselect_b32 s12, s52, s54
  s_cselect_b32 s13, s53, s55
  s_mov_b32 s14, 1605632
  s_mov_b32 s15, 0x20000
  v_and_b32 v32, 3, v253
  v_bfe_u32 v33, v253, 3, 2
  v_lshl_add_u32 v32, v33, 2, v32
  v_bfe_u32 v33, v253, 2, 1
  v_lshl_add_u32 v32, v33, 4, v32
  s_lshl_b32 s40, s65, 5
  v_add_u32 v32, s40, v32
  v_cvt_f32_u32 v33, v32
  v_mul_f32 v33, 0x3b124925, v33
  v_cmp_eq_u32 vcc, 0, v32
  v_and_b32 v35, 32, v253
  v_cvt_f32_u32 v35, v35
  v_cndmask_b32_e64 v32, v33, 0.5, vcc
  v_mul_f32 v34, 0x42000000, v32
  v_cos_f32 v36, v32
  v_mul_f32 v33, 0.5, v32
  v_cos_f32 v34, v34
  s_mul_i32 s40, s73, 0x3e800000
  v_fma_f32 v33, v33, v35, s40
  s_mul_i32 s40, s73, 0x41000000
  v_fma_f32 v35, v32, -s40, v33
  v_fma_f32 v33, v32, s40, v33
  v_add_f32 v36, v36, v36
  v_add_f32 v34, v34, v34
  v_fmamk_f32 v0, v32, 0x00000000, v33
  v_fmamk_f32 v1, v32, 0x41000000, v35
  v_fmamk_f32 v2, v32, 0x3f800000, v33
  v_fmamk_f32 v3, v32, 0x41100000, v35
  v_fmamk_f32 v16, v32, 0x42000000, v33
  v_fmamk_f32 v17, v32, 0x42200000, v35
  v_fmamk_f32 v18, v32, 0x42040000, v33
  v_fmamk_f32 v19, v32, 0x42240000, v35
  v_cos_f32 v0, v0
  v_cos_f32 v1, v1
  v_cos_f32 v2, v2
  v_cos_f32 v3, v3
  v_cos_f32 v16, v16
  v_cos_f32 v17, v17
  v_cos_f32 v18, v18
  v_cos_f32 v19, v19
  v_pk_fma_f32 v[4:5], v[36:37], v[2:3], v[0:1] op_sel_hi:[0,1,1] neg_lo:[0,0,1] neg_hi:[0,0,1]
  v_pk_fma_f32 v[20:21], v[36:37], v[18:19], v[16:17] op_sel_hi:[0,1,1] neg_lo:[0,0,1] neg_hi:[0,0,1]
  v_pk_fma_f32 v[6:7], v[36:37], v[4:5], v[2:3] op_sel_hi:[0,1,1] neg_lo:[0,0,1] neg_hi:[0,0,1]
  v_pk_fma_f32 v[22:23], v[36:37], v[20:21], v[18:19] op_sel_hi:[0,1,1] neg_lo:[0,0,1] neg_hi:[0,0,1]
  v_pk_fma_f32 v[8:9], v[36:37], v[6:7], v[4:5] op_sel_hi:[0,1,1] neg_lo:[0,0,1] neg_hi:[0,0,1]
  v_pk_fma_f32 v[24:25], v[36:37], v[22:23], v[20:21] op_sel_hi:[0,1,1] neg_lo:[0,0,1] neg_hi:[0,0,1]
  v_pk_fma_f32 v[10:11], v[36:37], v[8:9], v[6:7] op_sel_hi:[0,1,1] neg_lo:[0,0,1] neg_hi:[0,0,1]
  v_pk_fma_f32 v[26:27], v[36:37], v[24:25], v[22:23] op_sel_hi:[0,1,1] neg_lo:[0,0,1] neg_hi:[0,0,1]
  v_pk_fma_f32 v[12:13], v[36:37], v[10:11], v[8:9] op_sel_hi:[0,1,1] neg_lo:[0,0,1] neg_hi:[0,0,1]
  v_pk_fma_f32 v[28:29], v[36:37], v[26:27], v[24:25] op_sel_hi:[0,1,1] neg_lo:[0,0,1] neg_hi:[0,0,1]
  v_pk_fma_f32 v[14:15], v[36:37], v[12:13], v[10:11] op_sel_hi:[0,1,1] neg_lo:[0,0,1] neg_hi:[0,0,1]
  v_pk_fma_f32 v[30:31], v[36:37], v[28:29], v[26:27] op_sel_hi:[0,1,1] neg_lo:[0,0,1] neg_hi:[0,0,1]
  v_cvt_pk_bf16_f32 v112, v0, v2
  v_cvt_pk_bf16_f32 v113, v4, v6
  v_cvt_pk_bf16_f32 v114, v8, v10
  v_cvt_pk_bf16_f32 v115, v12, v14
  v_cvt_pk_bf16_f32 v116, v1, v3
  v_cvt_pk_bf16_f32 v117, v5, v7
  v_cvt_pk_bf16_f32 v118, v9, v11
  v_cvt_pk_bf16_f32 v119, v13, v15
  v_cvt_pk_bf16_f32 v120, v16, v18
  v_cvt_pk_bf16_f32 v121, v20, v22
  v_cvt_pk_bf16_f32 v122, v24, v26
  v_cvt_pk_bf16_f32 v123, v28, v30
  v_cvt_pk_bf16_f32 v124, v17, v19
  v_cvt_pk_bf16_f32 v125, v21, v23
  v_cvt_pk_bf16_f32 v126, v25, v27
  v_cvt_pk_bf16_f32 v127, v29, v31
  v_pk_fma_f32 v[0:1], v[34:35], v[16:17], v[0:1] op_sel_hi:[0,1,1] neg_lo:[0,0,1] neg_hi:[0,0,1]
  v_pk_fma_f32 v[2:3], v[34:35], v[18:19], v[2:3] op_sel_hi:[0,1,1] neg_lo:[0,0,1] neg_hi:[0,0,1]
  v_pk_fma_f32 v[4:5], v[34:35], v[20:21], v[4:5] op_sel_hi:[0,1,1] neg_lo:[0,0,1] neg_hi:[0,0,1]
  v_pk_fma_f32 v[6:7], v[34:35], v[22:23], v[6:7] op_sel_hi:[0,1,1] neg_lo:[0,0,1] neg_hi:[0,0,1]
  v_pk_fma_f32 v[8:9], v[34:35], v[24:25], v[8:9] op_sel_hi:[0,1,1] neg_lo:[0,0,1] neg_hi:[0,0,1]
  v_pk_fma_f32 v[10:11], v[34:35], v[26:27], v[10:11] op_sel_hi:[0,1,1] neg_lo:[0,0,1] neg_hi:[0,0,1]
  v_pk_fma_f32 v[12:13], v[34:35], v[28:29], v[12:13] op_sel_hi:[0,1,1] neg_lo:[0,0,1] neg_hi:[0,0,1]
  v_pk_fma_f32 v[14:15], v[34:35], v[30:31], v[14:15] op_sel_hi:[0,1,1] neg_lo:[0,0,1] neg_hi:[0,0,1]
  v_cvt_pk_bf16_f32 v128, v0, v2
  v_cvt_pk_bf16_f32 v129, v4, v6
  v_cvt_pk_bf16_f32 v130, v8, v10
  v_cvt_pk_bf16_f32 v131, v12, v14
  v_cvt_pk_bf16_f32 v132, v1, v3
  v_cvt_pk_bf16_f32 v133, v5, v7
  v_cvt_pk_bf16_f32 v134, v9, v11
  v_cvt_pk_bf16_f32 v135, v13, v15
  v_pk_fma_f32 v[16:17], v[34:35], v[0:1], v[16:17] op_sel_hi:[0,1,1] neg_lo:[0,0,1] neg_hi:[0,0,1]
  v_pk_fma_f32 v[18:19], v[34:35], v[2:3], v[18:19] op_sel_hi:[0,1,1] neg_lo:[0,0,1] neg_hi:[0,0,1]
  v_pk_fma_f32 v[20:21], v[34:35], v[4:5], v[20:21] op_sel_hi:[0,1,1] neg_lo:[0,0,1] neg_hi:[0,0,1]
  v_pk_fma_f32 v[22:23], v[34:35], v[6:7], v[22:23] op_sel_hi:[0,1,1] neg_lo:[0,0,1] neg_hi:[0,0,1]
  v_pk_fma_f32 v[24:25], v[34:35], v[8:9], v[24:25] op_sel_hi:[0,1,1] neg_lo:[0,0,1] neg_hi:[0,0,1]
  v_pk_fma_f32 v[26:27], v[34:35], v[10:11], v[26:27] op_sel_hi:[0,1,1] neg_lo:[0,0,1] neg_hi:[0,0,1]
  v_pk_fma_f32 v[28:29], v[34:35], v[12:13], v[28:29] op_sel_hi:[0,1,1] neg_lo:[0,0,1] neg_hi:[0,0,1]
  v_pk_fma_f32 v[30:31], v[34:35], v[14:15], v[30:31] op_sel_hi:[0,1,1] neg_lo:[0,0,1] neg_hi:[0,0,1]
  v_cvt_pk_bf16_f32 v136, v16, v18
  v_cvt_pk_bf16_f32 v137, v20, v22
  v_cvt_pk_bf16_f32 v138, v24, v26
  v_cvt_pk_bf16_f32 v139, v28, v30
  v_cvt_pk_bf16_f32 v140, v17, v19
  v_cvt_pk_bf16_f32 v141, v21, v23
  v_cvt_pk_bf16_f32 v142, v25, v27
  v_cvt_pk_bf16_f32 v143, v29, v31
  v_pk_fma_f32 v[0:1], v[34:35], v[16:17], v[0:1] op_sel_hi:[0,1,1] neg_lo:[0,0,1] neg_hi:[0,0,1]
  v_pk_fma_f32 v[2:3], v[34:35], v[18:19], v[2:3] op_sel_hi:[0,1,1] neg_lo:[0,0,1] neg_hi:[0,0,1]
  v_pk_fma_f32 v[4:5], v[34:35], v[20:21], v[4:5] op_sel_hi:[0,1,1] neg_lo:[0,0,1] neg_hi:[0,0,1]
  v_pk_fma_f32 v[6:7], v[34:35], v[22:23], v[6:7] op_sel_hi:[0,1,1] neg_lo:[0,0,1] neg_hi:[0,0,1]
  v_pk_fma_f32 v[8:9], v[34:35], v[24:25], v[8:9] op_sel_hi:[0,1,1] neg_lo:[0,0,1] neg_hi:[0,0,1]
  v_pk_fma_f32 v[10:11], v[34:35], v[26:27], v[10:11] op_sel_hi:[0,1,1] neg_lo:[0,0,1] neg_hi:[0,0,1]
  v_pk_fma_f32 v[12:13], v[34:35], v[28:29], v[12:13] op_sel_hi:[0,1,1] neg_lo:[0,0,1] neg_hi:[0,0,1]
  v_pk_fma_f32 v[14:15], v[34:35], v[30:31], v[14:15] op_sel_hi:[0,1,1] neg_lo:[0,0,1] neg_hi:[0,0,1]
  v_cvt_pk_bf16_f32 v144, v0, v2
  v_cvt_pk_bf16_f32 v145, v4, v6
  v_cvt_pk_bf16_f32 v146, v8, v10
  v_cvt_pk_bf16_f32 v147, v12, v14
  v_cvt_pk_bf16_f32 v148, v1, v3
  v_cvt_pk_bf16_f32 v149, v5, v7
  v_cvt_pk_bf16_f32 v150, v9, v11
  v_cvt_pk_bf16_f32 v151, v13, v15
  v_pk_fma_f32 v[16:17], v[34:35], v[0:1], v[16:17] op_sel_hi:[0,1,1] neg_lo:[0,0,1] neg_hi:[0,0,1]
  v_pk_fma_f32 v[18:19], v[34:35], v[2:3], v[18:19] op_sel_hi:[0,1,1] neg_lo:[0,0,1] neg_hi:[0,0,1]
  v_pk_fma_f32 v[20:21], v[34:35], v[4:5], v[20:21] op_sel_hi:[0,1,1] neg_lo:[0,0,1] neg_hi:[0,0,1]
  v_pk_fma_f32 v[22:23], v[34:35], v[6:7], v[22:23] op_sel_hi:[0,1,1] neg_lo:[0,0,1] neg_hi:[0,0,1]
  v_pk_fma_f32 v[24:25], v[34:35], v[8:9], v[24:25] op_sel_hi:[0,1,1] neg_lo:[0,0,1] neg_hi:[0,0,1]
  v_pk_fma_f32 v[26:27], v[34:35], v[10:11], v[26:27] op_sel_hi:[0,1,1] neg_lo:[0,0,1] neg_hi:[0,0,1]
  v_pk_fma_f32 v[28:29], v[34:35], v[12:13], v[28:29] op_sel_hi:[0,1,1] neg_lo:[0,0,1] neg_hi:[0,0,1]
  s_add_u32 m0, s84, 118784
  s_nop 0
  buffer_load_dwordx4 v38, s[12:15], 0 offen lds
  s_add_u32 m0, s84, 122880
  s_nop 0
  buffer_load_dwordx4 v39, s[12:15], 0 offen lds
  s_add_u32 m0, s84, 126976
  s_nop 0
  buffer_load_dwordx4 v38, s[12:15], s98 offen lds
  s_add_u32 m0, s84, 131072
  s_nop 0
  buffer_load_dwordx4 v39, s[12:15], s98 offen lds
  s_cmp_eq_u32 s64, 0
  s_cbranch_scc1 L_pad1
  s_cmp_eq_u32 s64, 1
  s_cbranch_scc1 L_pad2
  s_cmp_eq_u32 s64, 2
  s_cbranch_scc1 L_pad3
  s_cmp_eq_u32 s64, 3
  s_cbranch_scc1 L_pad4
L_ret_F:
  s_add_u32 m0, s3, s28
  s_lshr_b32 s59, s28, 5
  s_add_u32 s59, s59, s92
  buffer_load_dwordx4 v241, s[8:11], s59 offen lds
  buffer_load_dwordx4 v242, s[8:11], s59 offen offset:1024 lds
  v_pk_fma_f32 v[30:31], v[34:35], v[14:15], v[30:31] op_sel_hi:[0,1,1] neg_lo:[0,0,1] neg_hi:[0,0,1]
  v_cvt_pk_bf16_f32 v152, v16, v18
  v_cvt_pk_bf16_f32 v153, v20, v22
  v_cvt_pk_bf16_f32 v154, v24, v26
  v_cvt_pk_bf16_f32 v155, v28, v30
  v_cvt_pk_bf16_f32 v156, v17, v19
  v_cvt_pk_bf16_f32 v157, v21, v23
  v_cvt_pk_bf16_f32 v158, v25, v27
  v_cvt_pk_bf16_f32 v159, v29, v31
  v_pk_fma_f32 v[0:1], v[34:35], v[16:17], v[0:1] op_sel_hi:[0,1,1] neg_lo:[0,0,1] neg_hi:[0,0,1]
  s_add_u32 m0, s3, s29
  s_lshr_b32 s59, s29, 5
  s_add_u32 s59, s59, s92
  buffer_load_dwordx4 v241, s[8:11], s59 offen lds
  buffer_load_dwordx4 v242, s[8:11], s59 offen offset:1024 lds
  v_pk_fma_f32 v[2:3], v[34:35], v[18:19], v[2:3] op_sel_hi:[0,1,1] neg_lo:[0,0,1] neg_hi:[0,0,1]
  v_pk_fma_f32 v[4:5], v[34:35], v[20:21], v[4:5] op_sel_hi:[0,1,1] neg_lo:[0,0,1] neg_hi:[0,0,1]
  v_pk_fma_f32 v[6:7], v[34:35], v[22:23], v[6:7] op_sel_hi:[0,1,1] neg_lo:[0,0,1] neg_hi:[0,0,1]
  v_pk_fma_f32 v[8:9], v[34:35], v[24:25], v[8:9] op_sel_hi:[0,1,1] neg_lo:[0,0,1] neg_hi:[0,0,1]
  v_pk_fma_f32 v[10:11], v[34:35], v[26:27], v[10:11] op_sel_hi:[0,1,1] neg_lo:[0,0,1] neg_hi:[0,0,1]
  v_pk_fma_f32 v[12:13], v[34:35], v[28:29], v[12:13] op_sel_hi:[0,1,1] neg_lo:[0,0,1] neg_hi:[0,0,1]
  v_pk_fma_f32 v[14:15], v[34:35], v[30:31], v[14:15] op_sel_hi:[0,1,1] neg_lo:[0,0,1] neg_hi:[0,0,1]
  v_cvt_pk_bf16_f32 v160, v0, v2
  v_cvt_pk_bf16_f32 v161, v4, v6
  v_cvt_pk_bf16_f32 v162, v8, v10
  s_add_u32 m0, s3, s30
  s_lshr_b32 s59, s30, 5
  s_add_u32 s59, s59, s92
  buffer_load_dwordx4 v241, s[8:11], s59 offen lds
  buffer_load_dwordx4 v242, s[8:11], s59 offen offset:1024 lds
  v_cvt_pk_bf16_f32 v163, v12, v14
  v_cvt_pk_bf16_f32 v164, v1, v3
  v_cvt_pk_bf16_f32 v165, v5, v7
  v_cvt_pk_bf16_f32 v166, v9, v11
  v_cvt_pk_bf16_f32 v167, v13, v15
  v_and_b32 v32, 15, v253
  s_lshl_b32 s40, s64, 4
  v_add_u32 v32, s40, v32
  v_cvt_f32_u32 v32, v32
  v_mul_f32 v32, 0x3c800000, v32
  v_and_b32 v35, 32, v253
  v_mov_b32 v238, 0
  global_load_dwordx2 v[236:237], v238, s[36:37] sc1
  s_add_u32 m0, s101, s24
  s_lshr_b32 s59, s24, 5
  s_add_u32 s59, s59, s93
  buffer_load_dwordx4 v241, s[8:11], s59 offen lds
  buffer_load_dwordx4 v242, s[8:11], s59 offen offset:1024 lds
  s_add_u32 m0, s101, s25
  s_lshr_b32 s59, s25, 5
  s_add_u32 s59, s59, s93
  buffer_load_dwordx4 v241, s[8:11], s59 offen lds
  buffer_load_dwordx4 v242, s[8:11], s59 offen offset:1024 lds
  v_cos_f32 v36, v32
  v_cvt_f32_u32 v35, v35
  v_and_b32 v34, 16, v253
  v_cvt_f32_u32 v34, v34
  v_mul_f32 v34, 0x3c800000, v34
  v_mul_f32 v33, 0x3e800000, v32
  v_fma_f32 v33, v33, v35, v34
  v_add_f32 v36, v36, v36
  v_lshlrev_b32 v34, 31, v253
  v_lshrrev_b32 v35, 16, v34
  v_or_b32 v34, v34, v35
  v_fmamk_f32 v0, v32, 0x00000000, v33
  v_fmamk_f32 v2, v32, 0x3f800000, v33
  v_fmamk_f32 v16, v32, 0x41800000, v33
  v_fmamk_f32 v18, v32, 0x41880000, v33
  v_sin_f32 v1, v0
  v_cos_f32 v0, v0
  v_sin_f32 v3, v2
  v_cos_f32 v2, v2
  v_sin_f32 v17, v16
  v_cos_f32 v16, v16
  v_sin_f32 v19, v18
  v_cos_f32 v18, v18
  v_pk_fma_f32 v[4:5], v[36:37], v[2:3], v[0:1] op_sel_hi:[0,1,1] neg_lo:[0,0,1] neg_hi:[0,0,1]
  v_pk_fma_f32 v[20:21], v[36:37], v[18:19], v[16:17] op_sel_hi:[0,1,1] neg_lo:[0,0,1] neg_hi:[0,0,1]
  v_pk_fma_f32 v[6:7], v[36:37], v[4:5], v[2:3] op_sel_hi:[0,1,1] neg_lo:[0,0,1] neg_hi:[0,0,1]
  v_pk_fma_f32 v[22:23], v[36:37], v[20:21], v[18:19] op_sel_hi:[0,1,1] neg_lo:[0,0,1] neg_hi:[0,0,1]
  v_pk_fma_f32 v[8:9], v[36:37], v[6:7], v[4:5] op_sel_hi:[0,1,1] neg_lo:[0,0,1] neg_hi:[0,0,1]
  v_pk_fma_f32 v[24:25], v[36:37], v[22:23], v[20:21] op_sel_hi:[0,1,1] neg_lo:[0,0,1] neg_hi:[0,0,1]
  v_pk_fma_f32 v[10:11], v[36:37], v[8:9], v[6:7] op_sel_hi:[0,1,1] neg_lo:[0,0,1] neg_hi:[0,0,1]
  v_pk_fma_f32 v[26:27], v[36:37], v[24:25], v[22:23] op_sel_hi:[0,1,1] neg_lo:[0,0,1] neg_hi:[0,0,1]
  v_pk_fma_f32 v[12:13], v[36:37], v[10:11], v[8:9] op_sel_hi:[0,1,1] neg_lo:[0,0,1] neg_hi:[0,0,1]
  v_pk_fma_f32 v[28:29], v[36:37], v[26:27], v[24:25] op_sel_hi:[0,1,1] neg_lo:[0,0,1] neg_hi:[0,0,1]
  v_pk_fma_f32 v[14:15], v[36:37], v[12:13], v[10:11] op_sel_hi:[0,1,1] neg_lo:[0,0,1] neg_hi:[0,0,1]
  v_pk_fma_f32 v[30:31], v[36:37], v[28:29], v[26:27] op_sel_hi:[0,1,1] neg_lo:[0,0,1] neg_hi:[0,0,1]
  v_cvt_pk_bf16_f32 v72, v0, v4
  v_cvt_pk_bf16_f32 v73, v8, v12
  v_cvt_pk_bf16_f32 v74, v16, v20
  v_cvt_pk_bf16_f32 v75, v24, v28
  v_xor_b32 v76, v34, v72
  v_xor_b32 v77, v34, v73
  v_xor_b32 v78, v34, v74
  v_xor_b32 v79, v34, v75
  v_cvt_pk_bf16_f32 v80, v2, v6
  v_cvt_pk_bf16_f32 v81, v10, v14
  v_cvt_pk_bf16_f32 v82, v18, v22
  v_cvt_pk_bf16_f32 v83, v26, v30
  v_xor_b32 v84, v34, v80
  v_xor_b32 v85, v34, v81
  v_xor_b32 v86, v34, v82
  v_xor_b32 v87, v34, v83
  v_cvt_pk_bf16_f32 v88, v1, v5
  v_cvt_pk_bf16_f32 v89, v9, v13
  v_cvt_pk_bf16_f32 v90, v17, v21
  v_cvt_pk_bf16_f32 v91, v25, v29
  v_xor_b32 v92, v34, v88
  v_xor_b32 v93, v34, v89
  v_xor_b32 v94, v34, v90
  v_xor_b32 v95, v34, v91
  v_cvt_pk_bf16_f32 v96, v3, v7
  s_waitcnt vmcnt(17)
  s_barrier
  ds_read_b64_tr_b16 v[228:229], v224 offset:0
  ds_read_b64_tr_b16 v[230:231], v224 offset:3584
  ds_read_b64_tr_b16 v[232:233], v225 offset:0
  ds_read_b64_tr_b16 v[234:235], v225 offset:3584
  v_cvt_pk_bf16_f32 v97, v11, v15
  v_cvt_pk_bf16_f32 v98, v19, v23
  v_cvt_pk_bf16_f32 v99, v27, v31
  v_xor_b32 v100, v34, v96
  v_xor_b32 v101, v34, v97
  v_xor_b32 v102, v34, v98
  v_xor_b32 v103, v34, v99
  v_lshrrev_b32 v104, 5, v253
  v_lshlrev_b32 v104, 1, v104
  v_bfe_u32 v105, v253, 1, 3
  v_xor_b32 v104, v104, v105
  v_and_b32 v105, 31, v253
  s_waitcnt lgkmcnt(2)
  buffer_store_dwordx4 v[228:231], v110, s[4:7], s45 offen offset:0 sc1
  s_waitcnt lgkmcnt(0)
  buffer_store_dwordx4 v[232:235], v111, s[4:7], s45 offen offset:1024 sc1
  v_lshlrev_b32 v105, 7, v105
  v_lshl_add_u32 v254, v104, 4, v105
  s_lshl_b32 s40, s73, 4
  v_xor_b32 v104, s40, v254
  v_add_u32 v104, s100, v104
  v_xor_b32 v105, 16, v104
  v_xor_b32 v106, 64, v104
  v_xor_b32 v107, 0x50, v104
  v_and_b32 v8, 15, v253
  s_lshl_b32 s40, s73, 4
  v_add_u32 v8, s40, v8
  v_lshrrev_b32 v4, 4, v253
  v_bfe_u32 v5, v253, 1, 3
  v_xor_b32 v4, v4, v5
  v_lshl_add_u32 v4, v8, 3, v4
  v_lshl_add_u32 v4, v4, 4, s100
  v_xor_b32 v5, 64, v4
  v_mov_b32 v0, 0x3f803f80
  v_mov_b32 v1, 0x3f803f80
  v_mov_b32 v2, 0x3f803f80
  v_mov_b32 v3, 0x3f803f80
  v_lshrrev_b32 v10, 5, v253
  v_lshlrev_b32 v10, 10, v10
  v_bfe_u32 v11, v253, 2, 2
  v_lshl_add_u32 v10, v11, 7, v10
  v_bfe_u32 v11, v253, 3, 1
  v_lshl_add_u32 v10, v11, 6, v10
  v_bfe_u32 v11, v253, 4, 1
  v_mul_u32_u24 v11, 2080, v11
  v_add_u32 v10, v11, v10
  v_and_b32 v11, 1, v253
  v_lshl_add_u32 v10, v11, 4, v10
  v_bfe_u32 v11, v253, 1, 1
  v_lshl_add_u32 v10, v11, 3, v10
  s_lshl_b32 s40, s74, 6
  v_xor_b32 v10, s40, v10
  s_lshl_b32 s40, s73, 13
  s_add_u32 s40, s40, 118784
  v_add_u32 v10, s40, v10
  v_xor_b32 v11, 32, v10
  s_waitcnt vmcnt(7)
  s_barrier
  ds_read_b128 a[128:131], v4 offset:0
  ds_read_b128 a[132:135], v5 offset:0
  ds_read_b128 a[136:139], v4 offset:4096
  ds_read_b128 a[140:143], v5 offset:4096
  ds_read_b128 a[144:147], v4 offset:8192
  ds_read_b128 a[148:151], v5 offset:8192
  ds_read_b128 a[152:155], v4 offset:12288
  ds_read_b128 a[156:159], v5 offset:12288
  ds_read_b128 a[160:163], v4 offset:16384
  ds_read_b128 a[164:167], v5 offset:16384
  ds_read_b128 a[168:171], v4 offset:20480
  ds_read_b128 a[172:175], v5 offset:20480
  ds_read_b128 a[176:179], v4 offset:24576
  ds_read_b128 a[180:183], v5 offset:24576
  s_waitcnt lgkmcnt(12)
  v_mfma_f32_16x16x32_bf16 v[16:19], a[128:131], a[128:131], 0
  v_and_b32 v12, 31, v253
  v_lshlrev_b32 v12, 3, v12
  v_mfma_f32_16x16x32_bf16 v[20:23], v[0:3], a[128:131], 0
  s_lshl_b32 s99, s69, 2
  s_add_u32 s99, s99, s64
  s_lshl_b32 s99, s99, 4
  v_mfma_f32_16x16x32_bf16 v[16:19], a[132:135], a[132:135], v[16:19]
  s_lshl_b32 s40, s74, 7
  v_lshl_add_u32 v8, v8, 2, s40
  v_mfma_f32_16x16x32_bf16 v[20:23], v[0:3], a[132:135], v[20:23]
  s_add_u32 s99, s99, s66
  s_lshl_b32 s99, s99, 8
  s_add_u32 s99, s99, 31195136
  s_waitcnt lgkmcnt(10)
  v_mfma_f32_16x16x32_bf16 v[16:19], a[136:139], a[136:139], v[16:19]
  s_mul_i32 s32, s69, 229376
  ds_read_b128 v[168:171], v104 offset:0
  v_mfma_f32_16x16x32_bf16 v[20:23], v[0:3], a[136:139], v[20:23]
  s_add_u32 s32, s32, 31457280
  ds_read_b128 a[0:3], v105 offset:0
  v_mfma_f32_16x16x32_bf16 v[16:19], a[140:143], a[140:143], v[16:19]
  ds_read_b128 v[172:175], v106 offset:0
  v_lshrrev_b32 v9, 5, v253
  v_mfma_f32_16x16x32_bf16 v[20:23], v[0:3], a[140:143], v[20:23]
  s_sub_i32 s95, s95, s65
  s_cmp_lt_i32 s95, 0
  s_cselect_b32 s88, 7, 0
  s_add_u32 s95, s95, s88
  s_waitcnt lgkmcnt(11)
  v_mfma_f32_16x16x32_bf16 v[16:19], a[144:147], a[144:147], v[16:19]
  ds_read_b128 a[4:7], v107 offset:0
  s_lshl1_add_u32 s95, s95, s94
  v_mfma_f32_16x16x32_bf16 v[20:23], v[0:3], a[144:147], v[20:23]
  ds_read_b128 v[176:179], v104 offset:4096
  s_mul_i32 s88, s64, 28
  s_add_u32 s95, s95, s88
  v_mfma_f32_16x16x32_bf16 v[16:19], a[148:151], a[148:151], v[16:19]
  s_lshl_b32 s95, s95, 11
  ds_read_b128 a[8:11], v105 offset:4096
  v_mfma_f32_16x16x32_bf16 v[20:23], v[0:3], a[148:151], v[20:23]
  s_add_u32 s87, s95, s32
  s_lshl_b32 s33, s64, 12
  s_waitcnt lgkmcnt(12)
  v_mfma_f32_16x16x32_bf16 v[16:19], a[152:155], a[152:155], v[16:19]
  ds_read_b128 v[180:183], v106 offset:4096
  s_add_u32 s32, s32, s33
  v_mfma_f32_16x16x32_bf16 v[20:23], v[0:3], a[152:155], v[20:23]
  ds_read_b128 a[12:15], v107 offset:4096
  s_add_u32 s33, s33, 118784
  s_add_u32 s98, s87, 28672
  v_mfma_f32_16x16x32_bf16 v[16:19], a[156:159], a[156:159], v[16:19]
  ds_read_b128 v[184:187], v104 offset:8192
  ds_read_b128 a[16:19], v105 offset:8192
  v_mfma_f32_16x16x32_bf16 v[20:23], v[0:3], a[156:159], v[20:23]
  ds_read_b64_tr_b16 a[64:65], v10 offset:0
  ds_read_b64_tr_b16 a[66:67], v10 offset:512
  s_waitcnt lgkmcnt(15)
  v_mfma_f32_16x16x32_bf16 v[16:19], a[160:163], a[160:163], v[16:19]
  ds_read_b64_tr_b16 a[68:69], v10 offset:4096
  ds_read_b128 v[188:191], v106 offset:8192
  v_mfma_f32_16x16x32_bf16 v[20:23], v[0:3], a[160:163], v[20:23]
  ds_read_b64_tr_b16 a[70:71], v10 offset:4608
  ds_read_b128 a[20:23], v107 offset:8192
  v_mfma_f32_16x16x32_bf16 v[16:19], a[164:167], a[164:167], v[16:19]
  ds_read_b64_tr_b16 a[72:73], v11 offset:0
  ds_read_b128 v[192:195], v104 offset:12288
  v_mfma_f32_16x16x32_bf16 v[20:23], v[0:3], a[164:167], v[20:23]
  ds_read_b64_tr_b16 a[74:75], v11 offset:512
  s_waitcnt vmcnt(6)
  v_cmp_eq_u32 vcc, 0, v236
  s_nop 4
  s_cbranch_vccnz SLOW_1
BACK_2:
  v_readfirstlane_b32 s38, v236
  v_readfirstlane_b32 s39, v237
  s_waitcnt lgkmcnt(15)
  v_mfma_f32_16x16x32_bf16 v[16:19], a[168:171], a[168:171], v[16:19]
  ds_read_b128 a[24:27], v105 offset:12288
  ds_read_b64_tr_b16 a[76:77], v11 offset:4096
  ds_read_b64_tr_b16 a[78:79], v11 offset:4608
  s_waitcnt vmcnt(0)
  s_barrier
  s_mov_b64 exec, 1
  buffer_store_dwordx2 v[236:237], v255, s[4:7], s81 offen sc1
  s_mov_b64 exec, -1
  v_mfma_f32_16x16x32_bf16 v[20:23], v[0:3], a[168:171], v[20:23]
  ds_read_b128 v[196:199], v106 offset:12288
  s_lshl_b32 s40, s74, 7
  v_lshl_add_u32 v9, v9, 4, s40
  v_mfma_f32_16x16x32_bf16 v[16:19], a[172:175], a[172:175], v[16:19]
  s_mov_b32 s46, 0xaaaaaaaa
  ds_read_b128 a[28:31], v107 offset:12288
  v_mfma_f32_16x16x32_bf16 v[20:23], v[0:3], a[172:175], v[20:23]
  s_mov_b32 s47, 0xaaaaaaaa
  ds_read_b128 v[200:203], v104 offset:16384
  v_mfma_f32_16x16x32_bf16 v[16:19], a[176:179], a[176:179], v[16:19]
  s_mov_b32 s48, 0xcccccccc
  s_waitcnt lgkmcnt(13)
  s_branch L_over1
L_pad1:
  s_branch L_pad5
L_over1:
  buffer_store_dwordx4 a[64:67], v255, s[4:7], s87 offen offset:0 sc1
  v_mfma_f32_16x16x32_bf16 v[20:23], v[0:3], a[176:179], v[20:23]
  ds_read_b128 a[32:35], v105 offset:16384
  s_mov_b32 s49, 0xcccccccc
  v_mfma_f32_16x16x32_bf16 v[16:19], a[180:183], a[180:183], v[16:19]
  ds_read_b128 v[204:207], v106 offset:16384
  v_lshlrev_b32 v14, 31, v253
  v_mfma_f32_16x16x32_bf16 v[20:23], v[0:3], a[180:183], v[20:23]
  ds_read_b128 a[36:39], v107 offset:16384
  v_or_b32 v14, 1.0, v14
  v_mfma_f32_32x32x16_bf16 a[96:111], v[0:3], a[64:67], 0
  s_waitcnt lgkmcnt(13)
  buffer_store_dwordx4 a[68:71], v255, s[4:7], s87 offen offset:1024 sc1
  s_waitcnt lgkmcnt(9)
  buffer_store_dwordx4 a[72:75], v255, s[4:7], s98 offen offset:0 sc1
  v_mfma_f32_32x32x16_bf16 a[96:111], v[0:3], a[68:71], a[96:111]
  ds_read_b128 v[208:211], v104 offset:20480
  ds_read_b128 a[40:43], v105 offset:20480
  v_cndmask_b32_e64 v16, v16, v17, s[46:47]
  v_cndmask_b32_e64 v18, v18, v19, s[46:47]
  v_mul_f32 v20, 0x3b124925, v20
  v_cndmask_b32_e64 v16, v16, v18, s[48:49]
  v_mfma_f32_32x32x16_bf16 a[112:127], v[0:3], a[72:75], 0
  s_waitcnt lgkmcnt(8)
  buffer_store_dwordx4 a[76:79], v255, s[4:7], s98 offen offset:1024 sc1
  s_add_u32 m0, s101, s26
  s_lshr_b32 s59, s26, 5
  s_add_u32 s59, s59, s93
  v_mfma_f32_32x32x16_bf16 a[112:127], v[0:3], a[76:79], a[112:127]
  ds_read_b128 v[212:215], v106 offset:20480
  buffer_load_dwordx4 v241, s[8:11], s59 offen lds
  ds_read_b128 a[44:47], v107 offset:20480
  v_mul_f32 v20, v20, v20
  v_mfma_f32_32x32x16_bf16 v[40:55], v[168:171], v[112:115], 0
  buffer_load_dwordx4 v242, s[8:11], s59 offen offset:1024 lds
  ds_read_b128 v[216:219], v104 offset:24576
  v_mul_f32 v16, 0x3b124925, v16
  v_sub_f32 v16, v16, v20
  v_mfma_f32_32x32x16_bf16 v[40:55], a[0:3], v[116:119], v[40:55]
  v_max_f32 v16, 0, v16
  v_add_f32 v16, 0x3727c5ac, v16
  v_rsq_f32 v16, v16
  v_accvgpr_read_b32 v6, a96
  v_accvgpr_read_b32 v7, a112
  v_mfma_f32_32x32x16_bf16 v[40:55], v[172:175], v[120:123], v[40:55]
  s_add_u32 m0, s101, s27
  s_lshr_b32 s59, s27, 5
  s_add_u32 s59, s59, s93
  ds_read_b128 a[48:51], v105 offset:24576
  s_lshl_b32 s40, s64, 6
  v_add_u32 v239, s40, v253
  v_mfma_f32_32x32x16_bf16 v[40:55], a[4:7], v[124:127], v[40:55]
  s_mov_b32 exec_lo, 0x00f0000f
  s_mov_b32 exec_hi, 0xf0000f00
  ds_write_b32 v8, v16
  s_mov_b64 exec, -1
  buffer_store_dwordx2 v[6:7], v12, s[4:7], s99 offen sc1
  buffer_load_dwordx4 v241, s[8:11], s59 offen lds
  v_mfma_f32_32x32x16_bf16 v[40:55], v[176:179], v[128:131], v[40:55]
  ds_read_b128 v[220:223], v106 offset:24576
  buffer_load_dwordx4 v242, s[8:11], s59 offen offset:1024 lds
  ds_read_b128 a[52:55], v107 offset:24576
  v_min_u32 v239, 223, v239
  v_mfma_f32_32x32x16_bf16 v[40:55], a[8:11], v[132:135], v[40:55]
  s_add_u32 m0, s101, s28
  s_lshr_b32 s59, s28, 5
  s_add_u32 s59, s59, s93
  s_lshl1_add_u32 s97, s74, s73
  s_lshl_b32 s97, s97, 11
  s_add_u32 s97, s97, 155648
  v_mfma_f32_32x32x16_bf16 v[40:55], v[180:183], v[136:139], v[40:55]
  s_waitcnt lgkmcnt(2)
  s_barrier
  v_add_u32 v246, s97, v255
  v_lshrrev_b32 v248, 5, v253
  v_add_u32 v247, 155648, v255
  s_mul_i32 s85, s64, 28672
  v_mfma_f32_32x32x16_bf16 v[40:55], a[12:15], v[140:143], v[40:55]
  buffer_load_dwordx4 v241, s[8:11], s59 offen lds
  ds_read_b128 v[24:27], v9 offset:0
  ds_read_b128 v[28:31], v9 offset:32
  ds_read_b128 v[32:35], v9 offset:64
  v_mfma_f32_32x32x16_bf16 v[40:55], v[184:187], v[144:147], v[40:55]
  buffer_load_dwordx4 v242, s[8:11], s59 offen offset:1024 lds
  s_add_u32 m0, s101, s29
  s_lshr_b32 s59, s29, 5
  s_add_u32 s59, s59, s93
  v_mfma_f32_32x32x16_bf16 v[40:55], a[16:19], v[148:151], v[40:55]
  ds_read_b128 v[36:39], v9 offset:96
  s_add_u32 s85, s85, 4096
  v_lshlrev_b32 v239, 7, v239
  s_mov_b32 s17, 34865152
  s_add_u32 s94, s33, 16384
  v_bfe_u32 v250, v253, 4, 1
  v_mfma_f32_32x32x16_bf16 v[40:55], v[188:191], v[152:155], v[40:55]
  v_lshl_add_u32 v248, v250, 1, v248
  v_lshlrev_b32 v248, 1, v248
  v_and_b32 v249, 7, v253
  v_xor_b32 v248, v248, v249
  v_and_b32 v250, 15, v253
  v_lshl_add_u32 v248, v250, 3, v248
  v_mfma_f32_32x32x16_bf16 v[40:55], a[20:23], v[156:159], v[40:55]
  buffer_load_dwordx4 v241, s[8:11], s59 offen lds
  s_mul_i32 s49, s65, 229376
  s_add_u32 s49, s49, 29360128
  s_lshl_b32 s52, s86, 11
  v_mfma_f32_32x32x16_bf16 v[40:55], v[192:195], v[160:163], v[40:55]
  buffer_load_dwordx4 v242, s[8:11], s59 offen offset:1024 lds
  s_add_u32 m0, s101, s30
  s_lshr_b32 s59, s30, 5
  s_add_u32 s59, s59, s93
  v_mfma_f32_32x32x16_bf16 v[40:55], a[24:27], v[164:167], v[40:55]
  s_add_u32 s52, s52, s49
  s_mul_i32 s83, s71, 28
  s_add_u32 s83, s83, s73
  s_lshl1_add_u32 s83, s65, s83
  s_lshl1_add_u32 s31, s65, s83
  s_lshl_b32 s83, s83, 10
  v_mfma_f32_32x32x16_bf16 v[56:71], v[196:199], v[112:115], 0
  s_lshl_b32 s31, s31, 10
  v_lshl_add_u32 v248, v248, 4, s94
  v_lshrrev_b32 v250, 3, v253
  v_xor_b32 v251, v250, v253
  v_and_b32 v251, 7, v251
  v_mfma_f32_32x32x16_bf16 v[56:71], a[28:31], v[116:119], v[56:71]
  buffer_load_dwordx4 v241, s[8:11], s59 offen lds
  s_lshl_b32 s40, s73, 8
  v_xor_b32 v245, s40, v255
  v_mfma_f32_32x32x16_bf16 v[56:71], v[200:203], v[120:123], v[56:71]
  buffer_load_dwordx4 v242, s[8:11], s59 offen offset:1024 lds
  s_lshl_b32 s40, s64, 14
  v_add_u32 v245, s40, v245
  v_mfma_f32_32x32x16_bf16 v[56:71], a[32:35], v[124:127], v[56:71]
  s_lshl1_add_u32 s44, s65, s73
  s_lshl4_add_u32 s44, s71, s44
  s_lshl_b32 s44, s44, 8
  s_add_u32 s44, s44, 15466496
  v_accvgpr_write_b32 a216, 0
  v_mfma_f32_32x32x16_bf16 v[56:71], v[204:207], v[128:131], v[56:71]
  v_mfma_f32_32x32x16_bf16 v[56:71], a[36:39], v[132:135], v[56:71]
  v_mfma_f32_32x32x16_bf16 v[56:71], v[208:211], v[136:139], v[56:71]
  v_mfma_f32_32x32x16_bf16 v[56:71], a[40:43], v[140:143], v[56:71]
  v_mfma_f32_32x32x16_bf16 v[56:71], v[212:215], v[144:147], v[56:71]
  v_mfma_f32_32x32x16_bf16 v[56:71], a[44:47], v[148:151], v[56:71]
  v_mfma_f32_32x32x16_bf16 v[56:71], v[216:219], v[152:155], v[56:71]
  v_mfma_f32_32x32x16_bf16 v[56:71], a[48:51], v[156:159], v[56:71]
  s_waitcnt lgkmcnt(5)
  v_mfma_f32_32x32x16_bf16 v[56:71], v[220:223], v[160:163], v[56:71]
  buffer_load_dwordx2 v[226:227], v239, s[4:7], s17 offen sc1
  s_waitcnt lgkmcnt(4)
  v_mfma_f32_32x32x16_bf16 v[56:71], a[52:55], v[164:167], v[56:71]
  s_nop 11
  v_pk_fma_f32 v[40:41], v[14:15], v[56:57], v[40:41] op_sel_hi:[0,1,1]
  v_pk_fma_f32 v[42:43], v[14:15], v[58:59], v[42:43] op_sel_hi:[0,1,1]
  v_pk_fma_f32 v[44:45], v[14:15], v[60:61], v[44:45] op_sel_hi:[0,1,1]
  v_pk_fma_f32 v[46:47], v[14:15], v[62:63], v[46:47] op_sel_hi:[0,1,1]
  v_pk_fma_f32 v[48:49], v[14:15], v[64:65], v[48:49] op_sel_hi:[0,1,1]
  v_pk_fma_f32 v[50:51], v[14:15], v[66:67], v[50:51] op_sel_hi:[0,1,1]
  v_pk_fma_f32 v[52:53], v[14:15], v[68:69], v[52:53] op_sel_hi:[0,1,1]
  v_pk_fma_f32 v[54:55], v[14:15], v[70:71], v[54:55] op_sel_hi:[0,1,1]
  s_waitcnt lgkmcnt(3)
  v_pk_mul_f32 v[40:41], v[40:41], v[24:25]
  v_pk_mul_f32 v[42:43], v[42:43], v[26:27]
  v_cvt_pk_bf16_f32 v24, v40, v41
  s_waitcnt lgkmcnt(2)
  v_pk_mul_f32 v[44:45], v[44:45], v[28:29]
  v_cvt_pk_bf16_f32 v25, v42, v43
  v_pk_mul_f32 v[46:47], v[46:47], v[30:31]
  v_cvt_pk_bf16_f32 v26, v44, v45
  s_waitcnt lgkmcnt(1)
  v_pk_mul_f32 v[48:49], v[48:49], v[32:33]
  v_cvt_pk_bf16_f32 v27, v46, v47
  ds_write_b128 v246, v[24:27]
  v_pk_mul_f32 v[50:51], v[50:51], v[34:35]
  v_cvt_pk_bf16_f32 v28, v48, v49
  s_waitcnt lgkmcnt(1)
  v_pk_mul_f32 v[52:53], v[52:53], v[36:37]
  v_cvt_pk_bf16_f32 v29, v50, v51
  v_pk_mul_f32 v[54:55], v[54:55], v[38:39]
  v_cvt_pk_bf16_f32 v30, v52, v53
  v_cvt_pk_bf16_f32 v31, v54, v55
  ds_write_b128 v246, v[28:31] offset:1024
  v_lshl_add_u32 v251, v250, 3, v251
  v_lshl_add_u32 v251, v251, 4, s94
  v_mul_u32_u24 v250, 28672, v250
  v_lshl_add_u32 v249, v249, 4, v250
  v_xor_b32 v250, 16, v248
  s_mul_i32 s96, s64, 458752
  s_waitcnt vmcnt(9)
  s_waitcnt lgkmcnt(0)
  s_barrier
  ds_read_b128 v[0:3], v247 offset:0
  ds_read_b128 v[4:7], v247 offset:1024
  ds_read_b128 v[8:11], v247 offset:4096
  ds_read_b128 v[12:15], v247 offset:5120
  ds_read_b128 v[16:19], v247 offset:2048
  ds_read_b128 v[20:23], v247 offset:3072
  ds_read_b128 v[24:27], v247 offset:6144
  ds_read_b128 v[28:31], v247 offset:7168
  s_add_u32 s81, s81, 4291166208
  s_mov_b64 exec, 1
  buffer_store_dwordx2 v[236:237], v255, s[4:7], s81 offen sc1
  s_mov_b64 exec, -1
  s_add_u32 s96, s96, s24
  s_lshl_b32 s41, s67, 7
  s_add_u32 s96, s96, s41
  s_add_u32 s96, s96, 4718592
  s_mul_i32 s95, s70, 28672
  s_add_u32 s95, s95, 1048576
  v_and_b32 v32, 3, v253
  v_bfe_u32 v33, v253, 3, 2
  v_lshl_add_u32 v32, v33, 2, v32
  v_lshrrev_b32 v33, 3, v253
  v_xnor_b32 v33, v33, v253
  v_bfe_u32 v33, v33, 2, 1
  v_lshrrev_b32 v34, 1, v32
  s_waitcnt lgkmcnt(7)
  v_mfma_f32_32x32x16_bf16 v[40:55], v[0:3], v[72:75], 0
  v_lshlrev_b32 v34, v34, v33
  v_and_b32 v35, 16, v255
  v_mov_b32 v36, 0x3f80
  v_lshlrev_b32 v35, v35, v36
  v_bfe_i32 v36, v34, 0, 1
  s_waitcnt lgkmcnt(6)
  v_mfma_f32_32x32x16_bf16 v[40:55], v[4:7], v[76:79], v[40:55]
  v_and_b32 v36, v35, v36
  v_accvgpr_write_b32 a248, v36
  v_bfe_i32 v37, v34, 1, 1
  v_and_b32 v37, v35, v37
  v_accvgpr_write_b32 a249, v37
  s_waitcnt lgkmcnt(5)
  v_mfma_f32_32x32x16_bf16 v[40:55], v[8:11], v[80:83], v[40:55]
  v_bfe_i32 v36, v34, 2, 1
  v_and_b32 v36, v35, v36
  v_accvgpr_write_b32 a250, v36
  v_bfe_i32 v37, v34, 3, 1
  v_and_b32 v37, v35, v37
  s_waitcnt lgkmcnt(4)
  v_mfma_f32_32x32x16_bf16 v[40:55], v[12:15], v[84:87], v[40:55]
  v_accvgpr_write_b32 a251, v37
  v_bfe_i32 v36, v34, 4, 1
  v_and_b32 v36, v35, v36
  v_accvgpr_write_b32 a252, v36
  v_bfe_i32 v37, v34, 5, 1
  s_waitcnt lgkmcnt(3)
  v_mfma_f32_32x32x16_bf16 v[40:55], v[16:19], v[88:91], v[40:55]
  v_and_b32 v37, v35, v37
  v_accvgpr_write_b32 a253, v37
  v_bfe_i32 v36, v34, 6, 1
  v_and_b32 v36, v35, v36
  v_accvgpr_write_b32 a254, v36
  s_waitcnt lgkmcnt(2)
  v_mfma_f32_32x32x16_bf16 v[40:55], v[20:23], v[92:95], v[40:55]
  v_bfe_i32 v37, v34, 7, 1
  v_and_b32 v37, v35, v37
  v_accvgpr_write_b32 a255, v37
  s_waitcnt lgkmcnt(1)
  v_mfma_f32_32x32x16_bf16 v[40:55], v[24:27], v[96:99], v[40:55]
  v_cmp_eq_u32 vcc, 0, v32
  v_xor_b32 v34, 1, v33
  v_sub_u32 v32, 8, v32
  v_cndmask_b32 v33, v33, v34, vcc
  v_bfe_u32 v34, v32, 1, 3
  s_waitcnt lgkmcnt(0)
  v_mfma_f32_32x32x16_bf16 v[40:55], v[28:31], v[100:103], v[40:55]
  v_lshlrev_b32 v34, v34, v33
  v_bfe_i32 v36, v34, 0, 1
  v_and_b32 v36, v35, v36
  v_accvgpr_write_b32 a208, v36
  v_bfe_i32 v37, v34, 1, 1
  v_and_b32 v37, v35, v37
  v_accvgpr_write_b32 a209, v37
  v_bfe_i32 v36, v34, 2, 1
  v_and_b32 v36, v35, v36
  v_accvgpr_write_b32 a210, v36
  s_add_u32 s40, s96, 229376
  s_nop 0
  v_cvt_pk_bf16_f32 v56, v40, v41
  v_cvt_pk_bf16_f32 v57, v42, v43
  v_cvt_pk_bf16_f32 v58, v44, v45
  v_cvt_pk_bf16_f32 v59, v46, v47
  ds_write_b128 v248, v[56:59]
  v_cvt_pk_bf16_f32 v60, v48, v49
  v_cvt_pk_bf16_f32 v61, v50, v51
  v_cvt_pk_bf16_f32 v62, v52, v53
  v_cvt_pk_bf16_f32 v63, v54, v55
  ds_write_b128 v250, v[60:63]
  ds_read_b128 v[64:67], v251
  ds_read_b128 v[68:71], v251 offset:1024
  v_bfe_i32 v37, v34, 3, 1
  v_and_b32 v37, v35, v37
  v_accvgpr_write_b32 a211, v37
  v_bfe_i32 v36, v34, 4, 1
  v_and_b32 v36, v35, v36
  v_accvgpr_write_b32 a212, v36
  v_bfe_i32 v37, v34, 5, 1
  v_and_b32 v37, v35, v37
  v_accvgpr_write_b32 a213, v37
  v_bfe_i32 v36, v34, 6, 1
  v_and_b32 v36, v35, v36
  v_accvgpr_write_b32 a214, v36
  v_bfe_i32 v37, v34, 7, 1
  v_and_b32 v37, v35, v37
  s_waitcnt lgkmcnt(1)
  buffer_store_dwordx4 v[64:67], v249, s[4:7], s96 offen sc1
  s_waitcnt lgkmcnt(0)
  buffer_store_dwordx4 v[68:71], v249, s[4:7], s40 offen sc1
  s_lshl_b32 s40, s64, 6
  v_add_u32 v247, s40, v253
  s_waitcnt vmcnt(3)
  v_cmp_ne_u64 vcc, v[226:227], s[38:39]
  s_nop 4
  s_cbranch_vccnz SLOW_3
BACK_4:
  s_barrier
  v_min_u32 v247, 223, v247
  s_add_u32 s99, s49, 0
  buffer_load_dwordx4 a[0:3], v245, s[4:7], s99 offen offset:0 sc1
  v_lshlrev_b32 v247, 7, v247
  v_mov_b32 v48, s85
  buffer_load_dwordx4 a[4:7], v245, s[4:7], s99 offen offset:1024 sc1
  s_lshr_b32 s40, s24, 1
  s_bitcmp1_b32 s40, 11
  s_cselect_b32 s41, 0x840, 0
  s_xor_b32 s40, s40, s41
  s_sub_u32 s41, 0x6070, s40
  v_xad_u32 v40, v254, s40, v48
  v_xad_u32 v42, v254, s41, v48
  v_xor_b32 v41, 16, v40
  v_xor_b32 v43, 16, v42
  ds_read_b128 v[112:115], v40
  s_add_u32 s99, s49, 65536
  buffer_load_dwordx4 a[8:11], v245, s[4:7], s99 offen offset:0 sc1
  ds_read_b128 v[116:119], v41
  ds_read_b128 v[120:123], v42
  buffer_load_dwordx4 a[12:15], v245, s[4:7], s99 offen offset:1024 sc1
  ds_read_b128 v[124:127], v43
  s_lshr_b32 s40, s25, 1
  s_bitcmp1_b32 s40, 11
  s_cselect_b32 s41, 0x840, 0
  s_xor_b32 s40, s40, s41
  s_sub_u32 s41, 0x6070, s40
  v_xad_u32 v44, v254, s40, v48
  v_xad_u32 v46, v254, s41, v48
  v_xor_b32 v45, 16, v44
  v_xor_b32 v47, 16, v46
  s_add_u32 s99, s49, 131072
  buffer_load_dwordx4 a[16:19], v245, s[4:7], s99 offen offset:0 sc1
  ds_read_b128 v[128:131], v44
  ds_read_b128 v[132:135], v45
  buffer_load_dwordx4 a[20:23], v245, s[4:7], s99 offen offset:1024 sc1
  ds_read_b128 v[136:139], v46
  ds_read_b128 v[140:143], v47
  s_add_u32 s99, s52, 0
  buffer_load_dwordx4 a[24:27], v245, s[4:7], s99 offen offset:0 sc1
  s_lshr_b32 s40, s26, 1
  s_bitcmp1_b32 s40, 11
  s_cselect_b32 s41, 0x840, 0
  s_xor_b32 s40, s40, s41
  s_sub_u32 s41, 0x6070, s40
  v_xad_u32 v40, v254, s40, v48
  v_xad_u32 v42, v254, s41, v48
  v_xor_b32 v41, 16, v40
  v_xor_b32 v43, 16, v42
  ds_read_b128 v[144:147], v40
  buffer_load_dwordx4 a[28:31], v245, s[4:7], s99 offen offset:1024 sc1
  ds_read_b128 v[148:151], v41
  ds_read_b128 v[152:155], v42
  ds_read_b128 v[156:159], v43
  s_lshr_b32 s40, s27, 1
  s_bitcmp1_b32 s40, 11
  s_cselect_b32 s41, 0x840, 0
  s_xor_b32 s40, s40, s41
  s_sub_u32 s41, 0x6070, s40
  v_xad_u32 v44, v254, s40, v48
  v_xad_u32 v46, v254, s41, v48
  v_xor_b32 v45, 16, v44
  v_xor_b32 v47, 16, v46
  ds_read_b128 v[160:163], v44
  ds_read_b128 v[164:167], v45
  ds_read_b128 v[168:171], v46
  ds_read_b128 v[172:175], v47
  s_lshr_b32 s40, s28, 1
  s_bitcmp1_b32 s40, 11
  s_cselect_b32 s41, 0x840, 0
  s_xor_b32 s40, s40, s41
  s_sub_u32 s41, 0x6070, s40
  v_xad_u32 v40, v254, s40, v48
  v_xad_u32 v42, v254, s41, v48
  v_xor_b32 v41, 16, v40
  v_xor_b32 v43, 16, v42
  ds_read_b128 v[176:179], v40
  ds_read_b128 v[180:183], v41
  ds_read_b128 v[184:187], v42
  ds_read_b128 v[188:191], v43
  s_lshr_b32 s40, s29, 1
  s_bitcmp1_b32 s40, 11
  s_cselect_b32 s41, 0x840, 0
  s_xor_b32 s40, s40, s41
  s_sub_u32 s41, 0x6070, s40
  v_xad_u32 v44, v254, s40, v48
  v_xad_u32 v46, v254, s41, v48
  v_xor_b32 v45, 16, v44
  v_xor_b32 v47, 16, v46
  ds_read_b128 v[192:195], v44
  ds_read_b128 v[196:199], v45
  ds_read_b128 v[200:203], v46
  ds_read_b128 v[204:207], v47
  s_lshr_b32 s40, s30, 1
  s_bitcmp1_b32 s40, 11
  s_cselect_b32 s41, 0x840, 0
  s_xor_b32 s40, s40, s41
  s_sub_u32 s41, 0x6070, s40
  v_xad_u32 v40, v254, s40, v48
  v_xad_u32 v42, v254, s41, v48
  v_xor_b32 v41, 16, v40
  v_xor_b32 v43, 16, v42
  ds_read_b128 v[208:211], v40
  ds_read_b128 v[212:215], v41
  ds_read_b128 a[240:243], v42
  ds_read_b128 v[240:243], v43
  v_mov_b32 v250, s38
  v_mov_b32 v251, s39
  v_accvgpr_write_b32 a215, v37
  v_bfe_i32 v49, v253, 5, 1
  v_lshrrev_b32 v49, 16, v49
  s_waitcnt lgkmcnt(0)
  v_mov_b32 v50, v240
  v_bfi_b32 v240, v49, v204, v240
  v_bfi_b32 v204, v49, v188, v204
  v_bfi_b32 v188, v49, v172, v188
  v_bfi_b32 v172, v49, v156, v172
  v_bfi_b32 v156, v49, v140, v156
  v_bfi_b32 v140, v49, v124, v140
  v_bfi_b32 v124, v49, v50, v124
  v_mfma_f32_32x32x16_bf16 v[0:15], a[248:251], v[112:115], 0
  v_and_b32 v222, 31, v253
  v_lshl_add_u32 v222, v222, 6, s70
  v_cvt_f32_u32 v222, v222
  v_and_b32 v216, 32, v253
  v_mul_f32 v222, 0x3a000000, v222
  v_cvt_f32_u32 v216, v216
  v_mfma_f32_32x32x16_bf16 v[0:15], a[252:255], v[116:119], v[0:15]
  v_mul_f32 v216, 0.5, v216
  v_mul_f32 v216, v216, v222
  v_add_f32 v218, v216, v222
  v_cos_f32 v222, v222
  v_lshrrev_b32 v254, 5, v253
  v_mfma_f32_32x32x16_bf16 v[16:31], a[208:211], v[120:123], 0
  v_sin_f32 v217, v216
  v_cos_f32 v216, v216
  v_sin_f32 v219, v218
  v_mfma_f32_32x32x16_bf16 v[16:31], a[212:215], v[124:127], v[16:31]
  v_cos_f32 v218, v218
  v_add_f32 v222, v222, v222
  v_cvt_pk_bf16_f32 v223, v216, -v217
  v_cvt_pk_bf16_f32 v224, v216, v217
  v_accvgpr_write_b32 a224, v223
  v_mfma_f32_32x32x16_bf16 v[32:47], a[248:251], v[128:131], 0
  s_mov_b32 s97, 31064064
  buffer_load_dwordx2 v[248:249], v247, s[4:7], s97 offen sc1
  v_fma_f32 v220, v222, v218, -v216
  v_fma_f32 v221, v222, v219, -v217
  v_mfma_f32_32x32x16_bf16 v[32:47], a[252:255], v[132:135], v[32:47]
  v_cvt_pk_bf16_f32 v223, v218, -v219
  v_cvt_pk_bf16_f32 v225, v218, v219
  v_accvgpr_write_b32 a225, v223
  v_fma_f32 v216, v222, v220, -v218
  v_fma_f32 v217, v222, v221, -v219
  v_cvt_pk_bf16_f32 v223, v220, -v221
  v_mfma_f32_32x32x16_bf16 v[48:63], a[208:211], v[136:139], 0
  v_cvt_pk_bf16_f32 v226, v220, v221
  v_accvgpr_write_b32 a226, v223
  v_fma_f32 v218, v222, v216, -v220
  v_fma_f32 v219, v222, v217, -v221
  v_cvt_pk_bf16_f32 v223, v216, -v217
  v_mul_u32_u24 v254, 1536, v254
  v_mfma_f32_32x32x16_bf16 v[48:63], a[212:215], v[140:143], v[48:63]
  v_lshl_add_u32 v254, v253, 3, v254
  v_cvt_pk_bf16_f32 v227, v216, v217
  v_accvgpr_write_b32 a227, v223
  v_fma_f32 v220, v222, v218, -v216
  v_fma_f32 v221, v222, v219, -v217
  v_cvt_pk_bf16_f32 v223, v218, -v219
  v_mfma_f32_32x32x16_bf16 v[64:79], a[248:251], v[144:147], 0
  s_waitcnt vmcnt(9)
  s_barrier
  s_mov_b64 exec, 1
  buffer_store_dwordx2 v[250:251], v255, s[4:7], s80 offen sc1
  s_mov_b64 exec, -1
  v_mfma_f32_32x32x16_bf16 v[64:79], a[252:255], v[148:151], v[64:79]
  v_mov_b32 v251, v245
  s_lshl_b32 s92, s69, 2
  s_add_u32 s92, s92, s64
  s_lshl_b32 s92, s92, 12
  s_add_u32 s92, s92, 31195136
  v_cvt_pk_bf16_f32 v228, v218, v219
  v_mfma_f32_32x32x16_bf16 v[80:95], a[208:211], v[152:155], 0
  v_accvgpr_write_b32 a228, v223
  v_fma_f32 v216, v222, v220, -v218
  v_fma_f32 v217, v222, v221, -v219
  v_cvt_pk_bf16_f32 v223, v220, -v221
  v_cvt_pk_bf16_f32 v229, v220, v221
  v_accvgpr_write_b32 a229, v223
  v_mfma_f32_32x32x16_bf16 v[80:95], a[212:215], v[156:159], v[80:95]
  v_fma_f32 v218, v222, v216, -v220
  v_fma_f32 v219, v222, v217, -v221
  v_cvt_pk_bf16_f32 v223, v216, -v217
  v_cvt_pk_bf16_f32 v230, v216, v217
  v_accvgpr_write_b32 a230, v223
  v_fma_f32 v220, v222, v218, -v216
  v_mfma_f32_32x32x16_bf16 v[96:111], a[248:251], v[160:163], 0
  s_waitcnt vmcnt(1)
  v_cmp_ne_u64 vcc, v[248:249], s[38:39]
  s_nop 4
  s_cbranch_vccnz SLOW_5
BACK_6:
  s_barrier
  v_fma_f32 v221, v222, v219, -v217
  v_mfma_f32_32x32x16_bf16 v[96:111], a[252:255], v[164:167], v[96:111]
  v_cvt_pk_bf16_f32 v223, v218, -v219
  buffer_load_dwordx2 a[192:193], v254, s[4:7], s92 offen offset:0 sc1
  v_cvt_pk_bf16_f32 v231, v218, v219
  v_accvgpr_write_b32 a231, v223
  v_mfma_f32_32x32x16_bf16 v[112:127], a[208:211], v[168:171], 0
  buffer_load_dwordx2 a[194:195], v254, s[4:7], s92 offen offset:256 sc1
  buffer_load_dwordx2 a[196:197], v254, s[4:7], s92 offen offset:512 sc1
  v_mfma_f32_32x32x16_bf16 v[112:127], a[212:215], v[172:175], v[112:127]
  buffer_load_dwordx2 a[198:199], v254, s[4:7], s92 offen offset:768 sc1
  buffer_load_dwordx2 a[200:201], v254, s[4:7], s92 offen offset:1024 sc1
  v_mfma_f32_32x32x16_bf16 v[128:143], a[248:251], v[176:179], 0
  buffer_load_dwordx2 a[202:203], v254, s[4:7], s92 offen offset:1280 sc1
  buffer_load_dwordx2 a[204:205], v254, s[4:7], s92 offen offset:1536 sc1
  s_add_u32 m0, s33, 0
  s_add_u32 s43, s32, 0
  buffer_load_dwordx4 v255, s[4:7], s43 offen offset:0 sc1 lds
  v_fma_f32 v216, v222, v220, -v218
  v_fma_f32 v217, v222, v221, -v219
  v_mfma_f32_32x32x16_bf16 v[128:143], a[252:255], v[180:183], v[128:143]
  buffer_load_dwordx4 v255, s[4:7], s43 offen offset:1024 sc1 lds
  v_cvt_pk_bf16_f32 v223, v220, -v221
  v_cvt_pk_bf16_f32 v232, v220, v221
  v_accvgpr_write_b32 a232, v223
  v_fma_f32 v218, v222, v216, -v220
  v_mfma_f32_32x32x16_bf16 v[144:159], a[208:211], v[184:187], 0
  v_fma_f32 v219, v222, v217, -v221
  v_cvt_pk_bf16_f32 v223, v216, -v217
  v_cvt_pk_bf16_f32 v233, v216, v217
  v_accvgpr_write_b32 a233, v223
  v_fma_f32 v220, v222, v218, -v216
  v_fma_f32 v221, v222, v219, -v217
  v_mfma_f32_32x32x16_bf16 v[144:159], a[212:215], v[188:191], v[144:159]
  buffer_load_dwordx4 v255, s[4:7], s43 offen offset:2048 sc1 lds
  v_cvt_pk_bf16_f32 v223, v218, -v219
  v_cvt_pk_bf16_f32 v234, v218, v219
  v_accvgpr_write_b32 a234, v223
  v_mfma_f32_32x32x16_bf16 v[160:175], a[248:251], v[192:195], 0
  buffer_load_dwordx4 v255, s[4:7], s43 offen offset:3072 sc1 lds
  v_fma_f32 v216, v222, v220, -v218
  v_fma_f32 v217, v222, v221, -v219
  v_cvt_pk_bf16_f32 v223, v220, -v221
  v_mfma_f32_32x32x16_bf16 v[160:175], a[252:255], v[196:199], v[160:175]
  v_cvt_pk_bf16_f32 v235, v220, v221
  v_accvgpr_write_b32 a235, v223
  v_fma_f32 v218, v222, v216, -v220
  v_fma_f32 v219, v222, v217, -v221
  s_sub_u32 s88, 64, s70
  s_bfe_u32 s72, s88, 0x10005
  s_and_b32 s88, s88, 31
  s_cmp_eq_u32 s88, s67
  s_cselect_b32 s88, 0, 2
  s_add_u32 s72, s72, s88
  v_mfma_f32_32x32x16_bf16 v[176:191], a[208:211], v[200:203], 0
  s_add_u32 m0, s33, 16384
  s_add_u32 s43, s32, 16384
  buffer_load_dwordx4 v255, s[4:7], s43 offen offset:0 sc1 lds
  v_cvt_pk_bf16_f32 v223, v216, -v217
  v_cvt_pk_bf16_f32 v236, v216, v217
  v_accvgpr_write_b32 a236, v223
  v_fma_f32 v220, v222, v218, -v216
  s_mov_b32 s78, -1
  s_mov_b32 s79, 0
  s_mov_b32 s82, 0xffff0000
  s_mov_b32 s22, 1835008
  s_mov_b32 s23, 0x20000
  v_mfma_f32_32x32x16_bf16 v[176:191], a[212:215], v[204:207], v[176:191]
  buffer_load_dwordx4 v255, s[4:7], s43 offen offset:1024 sc1 lds
  v_fma_f32 v221, v222, v219, -v217
  v_cvt_pk_bf16_f32 v223, v218, -v219
  v_cvt_pk_bf16_f32 v237, v218, v219
  v_accvgpr_write_b32 a237, v223
  s_or_b32 s88, s65, s73
  s_cmp_eq_u32 s88, 0
  s_cselect_b32 s76, -1, 0
  s_mov_b32 s77, 0
  v_mfma_f32_32x32x16_bf16 v[192:207], a[248:251], v[208:211], 0
  v_fma_f32 v216, v222, v220, -v218
  v_fma_f32 v217, v222, v221, -v219
  v_cvt_pk_bf16_f32 v223, v220, -v221
  v_cvt_pk_bf16_f32 v238, v220, v221
  s_mul_i32 s46, s70, 14
  s_add_u32 s46, s46, s69
  s_lshl_b32 s46, s46, 13
  s_add_u32 s46, s46, 6553600
  v_mfma_f32_32x32x16_bf16 v[192:207], a[252:255], v[212:215], v[192:207]
  buffer_load_dwordx4 v255, s[4:7], s43 offen offset:2048 sc1 lds
  v_accvgpr_write_b32 a238, v223
  v_cvt_pk_bf16_f32 v223, v216, -v217
  v_cvt_pk_bf16_f32 v239, v216, v217
  v_accvgpr_write_b32 a239, v223
  s_add_u32 s47, s46, 4096
  v_accvgpr_write_b32 a220, 1
  v_lshrrev_b32 v244, 5, v253
  v_lshlrev_b32 v244, 11, v244
  v_mfma_f32_32x32x16_bf16 v[208:223], a[208:211], a[240:243], 0
  buffer_load_dwordx4 v255, s[4:7], s43 offen offset:3072 sc1 lds
  s_branch L_over2
L_pad2:
  s_branch L_pad6
L_over2:
  v_bfe_u32 v245, v253, 2, 2
  v_lshl_add_u32 v244, v245, 6, v244
  v_and_b32 v245, 1, v253
  v_lshl_add_u32 v244, v245, 5, v244
  v_mfma_f32_32x32x16_bf16 v[208:223], a[212:215], v[240:243], v[208:223]
  v_bfe_u32 v245, v253, 4, 1
  v_lshl_add_u32 v244, v245, 4, v244
  v_bfe_u32 v245, v253, 1, 1
  v_lshl_add_u32 v244, v245, 3, v244
  s_mov_b32 s97, 131072
  buffer_load_dwordx2 v[248:249], v247, s[4:7], s97 offen sc1
  s_add_u32 s95, s95, 3670016
  s_mov_b32 s89, 0
  s_mul_i32 s40, s72, 28672
  s_add_u32 s40, s40, 4096
  v_add_u32 v245, s40, v244
  v_add_u32 v244, s85, v244
  s_lshl_b32 s40, s74, 12
  s_add_u32 s40, s40, 155648
  s_cmp_eq_u32 s73, 0
  s_cselect_b32 s40, s40, 151552
  v_add_u32 v246, s40, v255
  s_waitcnt vmcnt(15)
  v_accvgpr_read_b32 v240, a192
  v_accvgpr_read_b32 v241, a193
  s_waitcnt vmcnt(14)
  v_accvgpr_read_b32 v242, a194
  v_accvgpr_read_b32 v243, a195
  v_pk_add_f32 v[240:241], v[240:241], v[242:243]
  s_waitcnt vmcnt(13)
  v_accvgpr_read_b32 v242, a196
  v_accvgpr_read_b32 v243, a197
  v_pk_add_f32 v[240:241], v[240:241], v[242:243]
  s_waitcnt vmcnt(12)
  v_accvgpr_read_b32 v242, a198
  v_accvgpr_read_b32 v243, a199
  v_pk_add_f32 v[240:241], v[240:241], v[242:243]
  s_waitcnt vmcnt(11)
  v_accvgpr_read_b32 v242, a200
  v_accvgpr_read_b32 v243, a201
  v_pk_add_f32 v[240:241], v[240:241], v[242:243]
  s_waitcnt vmcnt(10)
  v_accvgpr_read_b32 v242, a202
  v_accvgpr_read_b32 v243, a203
  v_pk_add_f32 v[240:241], v[240:241], v[242:243]
  s_waitcnt vmcnt(9)
  v_accvgpr_read_b32 v242, a204
  v_accvgpr_read_b32 v243, a205
  v_pk_add_f32 v[240:241], v[240:241], v[242:243]
  v_mov_b32 v242, v240
  v_mov_b32 v243, v241
  v_add_u32 v254, s84, v255
  v_permlane32_swap_b32 v240, v242
  v_permlane32_swap_b32 v241, v243
  v_pk_add_f32 v[240:241], v[240:241], v[242:243]
  v_cvt_pk_bf16_f32 v242, v240, v241
  v_lshlrev_b32 v243, 16, v242
  v_and_b32 v242, s82, v242
  v_sub_f32 v243, v240, v243
  v_sub_f32 v242, v241, v242
  v_cvt_pk_bf16_f32 v240, v240, v243
  v_cvt_pk_bf16_f32 v242, v241, v242
  v_mov_b32 v241, v240
  v_mov_b32 v243, v242
  ds_write_b128 v254, v[240:243]
  buffer_store_dwordx4 a[220:223], v255, s[4:7], s46 offen offset:0 sc1
  buffer_store_dwordx4 a[220:223], v255, s[4:7], s46 offen offset:1024 sc1
  s_cmp_eq_u32 s64, 0
  s_cbranch_scc1 L_pad9
  s_cmp_eq_u32 s64, 1
  s_cbranch_scc1 L_pad10
L_ret_B0:
  s_waitcnt vmcnt(2)
  v_cmp_ne_u64 vcc, v[248:249], s[38:39]
  s_nop 4
  s_cbranch_vccnz SLOW_7
BACK_8:
  s_waitcnt lgkmcnt(0)
  s_barrier
  s_add_u32 m0, s85, 0
  s_add_u32 s43, s95, s24
  buffer_load_dwordx4 v255, s[4:7], s43 offen offset:0 sc1 lds
  buffer_load_dwordx4 v255, s[4:7], s43 offen offset:1024 sc1 lds
  buffer_load_dwordx4 v255, s[4:7], s43 offen offset:2048 sc1 lds
  buffer_load_dwordx4 v255, s[4:7], s43 offen offset:3072 sc1 lds
  s_add_u32 m0, s85, 4096
  s_add_u32 s43, s95, s25
  buffer_load_dwordx4 v255, s[4:7], s43 offen offset:0 sc1 lds
  buffer_load_dwordx4 v255, s[4:7], s43 offen offset:1024 sc1 lds
  buffer_load_dwordx4 v255, s[4:7], s43 offen offset:2048 sc1 lds
  buffer_load_dwordx4 v255, s[4:7], s43 offen offset:3072 sc1 lds
  s_add_u32 m0, s85, 8192
  s_add_u32 s43, s95, s26
  buffer_load_dwordx4 v255, s[4:7], s43 offen offset:0 sc1 lds
  buffer_load_dwordx4 v255, s[4:7], s43 offen offset:1024 sc1 lds
  buffer_load_dwordx4 v255, s[4:7], s43 offen offset:2048 sc1 lds
  buffer_load_dwordx4 v255, s[4:7], s43 offen offset:3072 sc1 lds
  s_add_u32 m0, s85, 12288
  s_add_u32 s43, s95, s27
  buffer_load_dwordx4 v255, s[4:7], s43 offen offset:0 sc1 lds
  buffer_load_dwordx4 v255, s[4:7], s43 offen offset:1024 sc1 lds
  buffer_load_dwordx4 v255, s[4:7], s43 offen offset:2048 sc1 lds
  buffer_load_dwordx4 v255, s[4:7], s43 offen offset:3072 sc1 lds
  v_mov_b32 v250, v0
  v_lshlrev_b32 v249, 6, v253
  s_waitcnt vmcnt(12)
  s_barrier
  ds_read_b64_tr_b16 a[240:241], v244 offset:0
  ds_read_b64_tr_b16 a[242:243], v244 offset:256
  ds_read_b64_tr_b16 a[244:245], v244 offset:512
  ds_read_b64_tr_b16 a[246:247], v244 offset:768
  ds_read_b64_tr_b16 a[248:249], v244 offset:1024
  ds_read_b64_tr_b16 a[250:251], v244 offset:1280
  ds_read_b64_tr_b16 a[252:253], v244 offset:1536
  ds_read_b64_tr_b16 a[254:255], v244 offset:1792
  s_waitcnt lgkmcnt(6)
  v_mfma_f32_32x32x16_bf16 v[0:15], a[240:243], v[224:227], v[0:15]
  ds_read_b64_tr_b16 a[240:241], v245 offset:0
  ds_read_b64_tr_b16 a[242:243], v245 offset:256
  s_add_u32 m0, s85, 16384
  s_add_u32 s43, s95, s28
  buffer_load_dwordx4 v255, s[4:7], s43 offen offset:0 sc1 lds
  s_waitcnt lgkmcnt(6)
  v_mfma_f32_32x32x16_bf16 v[0:15], a[244:247], v[228:231], v[0:15]
  ds_read_b64_tr_b16 a[244:245], v245 offset:512
  ds_read_b64_tr_b16 a[246:247], v245 offset:768
  s_waitcnt lgkmcnt(4)
  v_mfma_f32_32x32x16_bf16 v[0:15], a[248:251], v[232:235], v[0:15]
  ds_read_b64_tr_b16 a[248:249], v245 offset:1024
  ds_read_b64_tr_b16 a[250:251], v245 offset:1280
  buffer_load_dwordx4 v255, s[4:7], s43 offen offset:1024 sc1 lds
  v_mfma_f32_32x32x16_bf16 v[0:15], a[252:255], v[236:239], v[0:15]
  ds_read_b64_tr_b16 a[252:253], v245 offset:1536
  ds_read_b64_tr_b16 a[254:255], v245 offset:1792
  s_add_u32 s40, s83, 17563648
  buffer_store_dwordx4 a[216:219], v255, s[4:7], s40 offen sc1
  s_waitcnt vmcnt(11)
  s_barrier
  s_waitcnt lgkmcnt(4)
  v_mfma_f32_32x32x16_bf16 v[16:31], a[240:243], a[224:227], v[16:31]
  ds_read_b64_tr_b16 a[240:241], v244 offset:4096
  ds_read_b64_tr_b16 a[242:243], v244 offset:4352
  buffer_load_dwordx4 v255, s[4:7], s43 offen offset:2048 sc1 lds
  v_mfma_f32_32x32x16_bf16 v[16:31], a[244:247], a[228:231], v[16:31]
  ds_read_b64_tr_b16 a[244:245], v244 offset:4608
  ds_read_b64_tr_b16 a[246:247], v244 offset:4864
  s_waitcnt lgkmcnt(4)
  v_mfma_f32_32x32x16_bf16 v[16:31], a[248:251], a[232:235], v[16:31]
  ds_read_b64_tr_b16 a[248:249], v244 offset:5120
  ds_read_b64_tr_b16 a[250:251], v244 offset:5376
  buffer_load_dwordx4 v255, s[4:7], s43 offen offset:3072 sc1 lds
  s_cmp_eq_u32 s24, 0
  s_cselect_b32 s88, -1, 0
  v_cndmask_b32_e64 v0, v0, v250, s[88:89]
  v_mov_b32 v250, v32
  v_mfma_f32_32x32x16_bf16 v[16:31], a[252:255], a[236:239], v[16:31]
  ds_read_b64_tr_b16 a[252:253], v244 offset:5632
  ds_read_b64_tr_b16 a[254:255], v244 offset:5888
  v_mov_b32 v240, v0
  v_mul_f32 v241, v0, v0
  v_mov_b32 v242, v1
  v_mul_f32 v243, v1, v1
  s_waitcnt lgkmcnt(4)
  v_mfma_f32_32x32x16_bf16 v[32:47], a[240:243], v[224:227], v[32:47]
  ds_read_b64_tr_b16 a[240:241], v245 offset:4096
  ds_read_b64_tr_b16 a[242:243], v245 offset:4352
  s_add_u32 m0, s85, 20480
  s_add_u32 s43, s95, s29
  buffer_load_dwordx4 v255, s[4:7], s43 offen offset:0 sc1 lds
  v_add_f32 v240, v240, v2
  v_fmac_f32 v241, v2, v2
  v_add_f32 v242, v242, v3
  v_fmac_f32 v243, v3, v3
  buffer_store_dwordx4 a[220:223], v255, s[4:7], s46 offen offset:2048 sc1
  v_mfma_f32_32x32x16_bf16 v[32:47], a[244:247], v[228:231], v[32:47]
  ds_read_b64_tr_b16 a[244:245], v245 offset:4608
  ds_read_b64_tr_b16 a[246:247], v245 offset:4864
  v_add_f32 v240, v240, v4
  v_fmac_f32 v241, v4, v4
  v_add_f32 v242, v242, v5
  v_fmac_f32 v243, v5, v5
  s_waitcnt lgkmcnt(4)
  v_mfma_f32_32x32x16_bf16 v[32:47], a[248:251], v[232:235], v[32:47]
  ds_read_b64_tr_b16 a[248:249], v245 offset:5120
  ds_read_b64_tr_b16 a[250:251], v245 offset:5376
  buffer_load_dwordx4 v255, s[4:7], s43 offen offset:1024 sc1 lds
  v_add_f32 v240, v240, v6
  v_fmac_f32 v241, v6, v6
  v_add_f32 v242, v242, v7
  v_fmac_f32 v243, v7, v7
  v_mfma_f32_32x32x16_bf16 v[32:47], a[252:255], v[236:239], v[32:47]
  ds_read_b64_tr_b16 a[252:253], v245 offset:5632
  ds_read_b64_tr_b16 a[254:255], v245 offset:5888
  v_add_f32 v240, v240, v8
  v_fmac_f32 v241, v8, v8
  v_add_f32 v242, v242, v9
  v_fmac_f32 v243, v9, v9
  s_waitcnt vmcnt(12)
  s_barrier
  s_waitcnt lgkmcnt(4)
  v_mfma_f32_32x32x16_bf16 v[48:63], a[240:243], a[224:227], v[48:63]
  ds_read_b64_tr_b16 a[240:241], v244 offset:8192
  ds_read_b64_tr_b16 a[242:243], v244 offset:8448
  buffer_load_dwordx4 v255, s[4:7], s43 offen offset:2048 sc1 lds
  v_add_f32 v240, v240, v10
  v_fmac_f32 v241, v10, v10
  v_add_f32 v242, v242, v11
  v_fmac_f32 v243, v11, v11
  v_mfma_f32_32x32x16_bf16 v[48:63], a[244:247], a[228:231], v[48:63]
  ds_read_b64_tr_b16 a[244:245], v244 offset:8704
  ds_read_b64_tr_b16 a[246:247], v244 offset:8960
  v_add_f32 v240, v240, v12
  v_fmac_f32 v241, v12, v12
  v_add_f32 v242, v242, v13
  v_fmac_f32 v243, v13, v13
  s_waitcnt lgkmcnt(4)
  v_mfma_f32_32x32x16_bf16 v[48:63], a[248:251], a[232:235], v[48:63]
  ds_read_b64_tr_b16 a[248:249], v244 offset:9216
  ds_read_b64_tr_b16 a[250:251], v244 offset:9472
  buffer_load_dwordx4 v255, s[4:7], s43 offen offset:3072 sc1 lds
  s_cmp_eq_u32 s25, 0
  s_cselect_b32 s88, -1, 0
  v_cndmask_b32_e64 v32, v32, v250, s[88:89]
  v_mov_b32 v250, v64
  v_add_f32 v240, v240, v14
  v_fmac_f32 v241, v14, v14
  v_add_f32 v242, v242, v15
  v_fmac_f32 v243, v15, v15
  v_mfma_f32_32x32x16_bf16 v[48:63], a[252:255], a[236:239], v[48:63]
  ds_read_b64_tr_b16 a[252:253], v244 offset:9728
  ds_read_b64_tr_b16 a[254:255], v244 offset:9984
  s_add_u32 s40, s83, 17577984
  buffer_store_dwordx4 a[216:219], v255, s[4:7], s40 offen sc1
  v_add_f32 v240, v240, v16
  v_fmac_f32 v241, v16, v16
  v_add_f32 v242, v242, v17
  v_fmac_f32 v243, v17, v17
  s_waitcnt lgkmcnt(4)
  v_mfma_f32_32x32x16_bf16 v[64:79], a[240:243], v[224:227], v[64:79]
  ds_read_b64_tr_b16 a[240:241], v245 offset:8192
  ds_read_b64_tr_b16 a[242:243], v245 offset:8448
  s_add_u32 m0, s85, 24576
  s_add_u32 s43, s95, s30
  buffer_load_dwordx4 v255, s[4:7], s43 offen offset:0 sc1 lds
  v_add_f32 v240, v240, v18
  v_fmac_f32 v241, v18, v18
  v_add_f32 v242, v242, v19
  v_fmac_f32 v243, v19, v19
  v_mfma_f32_32x32x16_bf16 v[64:79], a[244:247], v[228:231], v[64:79]
  ds_read_b64_tr_b16 a[244:245], v245 offset:8704
  ds_read_b64_tr_b16 a[246:247], v245 offset:8960
  v_add_f32 v240, v240, v20
  v_fmac_f32 v241, v20, v20
  v_add_f32 v242, v242, v21
  v_fmac_f32 v243, v21, v21
  s_waitcnt lgkmcnt(4)
  v_mfma_f32_32x32x16_bf16 v[64:79], a[248:251], v[232:235], v[64:79]
  ds_read_b64_tr_b16 a[248:249], v245 offset:9216
  ds_read_b64_tr_b16 a[250:251], v245 offset:9472
  buffer_load_dwordx4 v255, s[4:7], s43 offen offset:1024 sc1 lds
  v_add_f32 v240, v240, v22
  v_fmac_f32 v241, v22, v22
  v_add_f32 v242, v242, v23
  v_fmac_f32 v243, v23, v23
  v_mfma_f32_32x32x16_bf16 v[64:79], a[252:255], v[236:239], v[64:79]
  ds_read_b64_tr_b16 a[252:253], v245 offset:9728
  ds_read_b64_tr_b16 a[254:255], v245 offset:9984
  v_add_f32 v240, v240, v24
  v_fmac_f32 v241, v24, v24
  v_add_f32 v242, v242, v25
  v_fmac_f32 v243, v25, v25
  s_waitcnt vmcnt(13)
  s_barrier
  s_waitcnt lgkmcnt(4)
  v_mfma_f32_32x32x16_bf16 v[80:95], a[240:243], a[224:227], v[80:95]
  ds_read_b64_tr_b16 a[240:241], v244 offset:12288
  ds_read_b64_tr_b16 a[242:243], v244 offset:12544
  buffer_load_dwordx4 v255, s[4:7], s43 offen offset:2048 sc1 lds
  v_add_f32 v240, v240, v26
  v_fmac_f32 v241, v26, v26
  v_add_f32 v242, v242, v27
  v_fmac_f32 v243, v27, v27
  v_mfma_f32_32x32x16_bf16 v[80:95], a[244:247], a[228:231], v[80:95]
  ds_read_b64_tr_b16 a[244:245], v244 offset:12800
  ds_read_b64_tr_b16 a[246:247], v244 offset:13056
  v_add_f32 v240, v240, v28
  v_fmac_f32 v241, v28, v28
  v_add_f32 v242, v242, v29
  v_fmac_f32 v243, v29, v29
  s_waitcnt lgkmcnt(4)
  v_mfma_f32_32x32x16_bf16 v[80:95], a[248:251], a[232:235], v[80:95]
  ds_read_b64_tr_b16 a[248:249], v244 offset:13312
  ds_read_b64_tr_b16 a[250:251], v244 offset:13568
  buffer_load_dwordx4 v255, s[4:7], s43 offen offset:3072 sc1 lds
  s_cmp_eq_u32 s26, 0
  s_cselect_b32 s88, -1, 0
  v_cndmask_b32_e64 v64, v64, v250, s[88:89]
  v_mov_b32 v250, v96
  v_add_f32 v240, v240, v30
  v_fmac_f32 v241, v30, v30
  v_add_f32 v242, v242, v31
  v_fmac_f32 v243, v31, v31
  buffer_store_dwordx4 a[220:223], v255, s[4:7], s46 offen offset:3072 sc1
  v_mfma_f32_32x32x16_bf16 v[80:95], a[252:255], a[236:239], v[80:95]
  ds_read_b64_tr_b16 a[252:253], v244 offset:13824
  ds_read_b64_tr_b16 a[254:255], v244 offset:14080
  v_add_f32 v240, v240, v242
  v_add_f32 v241, v241, v243
  v_mov_b32 v242, v240
  v_mov_b32 v243, v241
  s_waitcnt lgkmcnt(4)
  v_mfma_f32_32x32x16_bf16 v[96:111], a[240:243], v[224:227], v[96:111]
  ds_read_b64_tr_b16 a[240:241], v245 offset:12288
  ds_read_b64_tr_b16 a[242:243], v245 offset:12544
  s_add_u32 m0, s85, 0
  s_add_u32 s43, s32, 32768
  buffer_load_dwordx4 v255, s[4:7], s43 offen offset:0 sc1 lds
  s_lshl_b32 s96, s67, 2
  s_add_u32 s96, s96, s64
  s_lshl_b32 s96, s96, 12
  s_add_u32 s96, s96, 13893632
  v_permlane32_swap_b32 v240, v242
  v_permlane32_swap_b32 v241, v243
  v_mfma_f32_32x32x16_bf16 v[96:111], a[244:247], v[228:231], v[96:111]
  ds_read_b64_tr_b16 a[244:245], v245 offset:12800
  ds_read_b64_tr_b16 a[246:247], v245 offset:13056
  v_add_f32 v240, v240, v242
  v_add_f32 v241, v241, v243
  v_mov_b32 v242, s38
  v_mov_b32 v243, s39
  s_waitcnt lgkmcnt(4)
  v_mfma_f32_32x32x16_bf16 v[96:111], a[248:251], v[232:235], v[96:111]
  ds_read_b64_tr_b16 a[248:249], v245 offset:13312
  ds_read_b64_tr_b16 a[250:251], v245 offset:13568
  buffer_load_dwordx4 v255, s[4:7], s43 offen offset:1024 sc1 lds
  s_lshl_b32 s40, s65, 9
  s_add_u32 s40, s40, s96
  s_mov_b64 exec, s[78:79]
  buffer_store_dwordx4 v[240:243], v255, s[4:7], s40 offen sc1
  s_mov_b64 exec, -1
  v_cvt_pk_bf16_f32 v0, v0, v1
  v_cvt_pk_bf16_f32 v1, v2, v3
  v_mfma_f32_32x32x16_bf16 v[96:111], a[252:255], v[236:239], v[96:111]
  ds_read_b64_tr_b16 a[252:253], v245 offset:13824
  ds_read_b64_tr_b16 a[254:255], v245 offset:14080
  v_cvt_pk_bf16_f32 v2, v4, v5
  v_cvt_pk_bf16_f32 v3, v6, v7
  v_cvt_pk_bf16_f32 v4, v8, v9
  v_cvt_pk_bf16_f32 v5, v10, v11
  s_waitcnt vmcnt(14)
  s_barrier
  s_waitcnt lgkmcnt(4)
  v_mfma_f32_32x32x16_bf16 v[112:127], a[240:243], a[224:227], v[112:127]
  ds_read_b64_tr_b16 a[240:241], v244 offset:16384
  ds_read_b64_tr_b16 a[242:243], v244 offset:16640
  buffer_load_dwordx4 v255, s[4:7], s43 offen offset:2048 sc1 lds
  v_cvt_pk_bf16_f32 v6, v12, v13
  v_cvt_pk_bf16_f32 v7, v14, v15
  v_cvt_pk_bf16_f32 v8, v16, v17
  v_cvt_pk_bf16_f32 v9, v18, v19
  v_mfma_f32_32x32x16_bf16 v[112:127], a[244:247], a[228:231], v[112:127]
  ds_read_b64_tr_b16 a[244:245], v244 offset:16896
  ds_read_b64_tr_b16 a[246:247], v244 offset:17152
  s_add_u32 s40, s31, 15728640
  buffer_store_dwordx4 a[216:219], v255, s[4:7], s40 offen sc1
  v_cvt_pk_bf16_f32 v10, v20, v21
  v_cvt_pk_bf16_f32 v11, v22, v23
  v_cvt_pk_bf16_f32 v12, v24, v25
  v_cvt_pk_bf16_f32 v13, v26, v27
  s_waitcnt lgkmcnt(4)
  v_mfma_f32_32x32x16_bf16 v[112:127], a[248:251], a[232:235], v[112:127]
  ds_read_b64_tr_b16 a[248:249], v244 offset:17408
  ds_read_b64_tr_b16 a[250:251], v244 offset:17664
  buffer_load_dwordx4 v255, s[4:7], s43 offen offset:3072 sc1 lds
  s_cmp_eq_u32 s27, 0
  s_cselect_b32 s88, -1, 0
  v_cndmask_b32_e64 v96, v96, v250, s[88:89]
  v_mov_b32 v250, v128
  v_cvt_pk_bf16_f32 v14, v28, v29
  v_cvt_pk_bf16_f32 v15, v30, v31
  ds_write_b128 v246, v[0:3] offset:0
  ds_write_b128 v246, v[4:7] offset:1024
  v_mfma_f32_32x32x16_bf16 v[112:127], a[252:255], a[236:239], v[112:127]
  ds_read_b64_tr_b16 a[252:253], v244 offset:17920
  ds_read_b64_tr_b16 a[254:255], v244 offset:18176
  ds_write_b128 v246, v[8:11] offset:2048
  ds_write_b128 v246, v[12:15] offset:3072
  v_cvt_pk_bf16_f32 v16, v32, v33
  v_cvt_pk_bf16_f32 v17, v34, v35
  s_waitcnt lgkmcnt(8)
  v_mfma_f32_32x32x16_bf16 v[128:143], a[240:243], v[224:227], v[128:143]
  ds_read_b64_tr_b16 a[240:241], v245 offset:16384
  ds_read_b64_tr_b16 a[242:243], v245 offset:16640
  s_add_u32 m0, s85, 4096
  s_add_u32 s43, s32, 49152
  buffer_load_dwordx4 v255, s[4:7], s43 offen offset:0 sc1 lds
  v_cvt_pk_bf16_f32 v18, v36, v37
  v_cvt_pk_bf16_f32 v19, v38, v39
  v_cvt_pk_bf16_f32 v20, v40, v41
  v_cvt_pk_bf16_f32 v21, v42, v43
  v_mfma_f32_32x32x16_bf16 v[128:143], a[244:247], v[228:231], v[128:143]
  ds_read_b64_tr_b16 a[244:245], v245 offset:16896
  ds_read_b64_tr_b16 a[246:247], v245 offset:17152
  v_cvt_pk_bf16_f32 v22, v44, v45
  v_cvt_pk_bf16_f32 v23, v46, v47
  v_cvt_pk_bf16_f32 v24, v48, v49
  v_cvt_pk_bf16_f32 v25, v50, v51
  s_waitcnt lgkmcnt(6)
  v_mfma_f32_32x32x16_bf16 v[128:143], a[248:251], v[232:235], v[128:143]
  ds_read_b64_tr_b16 a[248:249], v245 offset:17408
  ds_read_b64_tr_b16 a[250:251], v245 offset:17664
  buffer_load_dwordx4 v255, s[4:7], s43 offen offset:1024 sc1 lds
  v_cvt_pk_bf16_f32 v26, v52, v53
  v_cvt_pk_bf16_f32 v27, v54, v55
  v_cvt_pk_bf16_f32 v28, v56, v57
  v_cvt_pk_bf16_f32 v29, v58, v59
  v_mfma_f32_32x32x16_bf16 v[128:143], a[252:255], v[236:239], v[128:143]
  ds_read_b64_tr_b16 a[252:253], v245 offset:17920
  ds_read_b64_tr_b16 a[254:255], v245 offset:18176
  v_cvt_pk_bf16_f32 v30, v60, v61
  v_cvt_pk_bf16_f32 v31, v62, v63
  v_cvt_pk_bf16_f32 v32, v64, v65
  v_cvt_pk_bf16_f32 v33, v66, v67
  s_waitcnt vmcnt(14)
  s_barrier
  s_waitcnt lgkmcnt(4)
  v_mfma_f32_32x32x16_bf16 v[144:159], a[240:243], a[224:227], v[144:159]
  ds_read_b64_tr_b16 a[240:241], v244 offset:20480
  ds_read_b64_tr_b16 a[242:243], v244 offset:20736
  buffer_load_dwordx4 v255, s[4:7], s43 offen offset:2048 sc1 lds
  v_cvt_pk_bf16_f32 v34, v68, v69
  v_cvt_pk_bf16_f32 v35, v70, v71
  v_cvt_pk_bf16_f32 v36, v72, v73
  v_cvt_pk_bf16_f32 v37, v74, v75
  buffer_store_dwordx4 a[220:223], v255, s[4:7], s47 offen offset:0 sc1
  v_mfma_f32_32x32x16_bf16 v[144:159], a[244:247], a[228:231], v[144:159]
  ds_read_b64_tr_b16 a[244:245], v244 offset:20992
  ds_read_b64_tr_b16 a[246:247], v244 offset:21248
  v_cvt_pk_bf16_f32 v38, v76, v77
  v_cvt_pk_bf16_f32 v39, v78, v79
  v_cvt_pk_bf16_f32 v40, v80, v81
  v_cvt_pk_bf16_f32 v41, v82, v83
  s_waitcnt lgkmcnt(4)
  v_mfma_f32_32x32x16_bf16 v[144:159], a[248:251], a[232:235], v[144:159]
  ds_read_b64_tr_b16 a[248:249], v244 offset:21504
  ds_read_b64_tr_b16 a[250:251], v244 offset:21760
  buffer_load_dwordx4 v255, s[4:7], s43 offen offset:3072 sc1 lds
  s_cmp_eq_u32 s28, 0
  s_cselect_b32 s88, -1, 0
  v_cndmask_b32_e64 v128, v128, v250, s[88:89]
  v_mov_b32 v250, v160
  v_cvt_pk_bf16_f32 v42, v84, v85
  v_cvt_pk_bf16_f32 v43, v86, v87
  v_cvt_pk_bf16_f32 v44, v88, v89
  v_cvt_pk_bf16_f32 v45, v90, v91
  v_mfma_f32_32x32x16_bf16 v[144:159], a[252:255], a[236:239], v[144:159]
  ds_read_b64_tr_b16 a[252:253], v244 offset:22016
  ds_read_b64_tr_b16 a[254:255], v244 offset:22272
  v_cvt_pk_bf16_f32 v46, v92, v93
  v_cvt_pk_bf16_f32 v47, v94, v95
  v_cvt_pk_bf16_f32 v48, v96, v97
  v_cvt_pk_bf16_f32 v49, v98, v99
  s_waitcnt lgkmcnt(4)
  v_mfma_f32_32x32x16_bf16 v[160:175], a[240:243], v[224:227], v[160:175]
  ds_read_b64_tr_b16 a[240:241], v245 offset:20480
  ds_read_b64_tr_b16 a[242:243], v245 offset:20736
  s_add_u32 m0, s85, 8192
  s_add_u32 s43, s32, 65536
  buffer_load_dwordx4 v255, s[4:7], s43 offen offset:0 sc1 lds
  v_cvt_pk_bf16_f32 v50, v100, v101
  v_cvt_pk_bf16_f32 v51, v102, v103
  v_cvt_pk_bf16_f32 v52, v104, v105
  v_cvt_pk_bf16_f32 v53, v106, v107
  v_mfma_f32_32x32x16_bf16 v[160:175], a[244:247], v[228:231], v[160:175]
  ds_read_b64_tr_b16 a[244:245], v245 offset:20992
  ds_read_b64_tr_b16 a[246:247], v245 offset:21248
  v_cvt_pk_bf16_f32 v54, v108, v109
  v_cvt_pk_bf16_f32 v55, v110, v111
  v_cvt_pk_bf16_f32 v56, v112, v113
  v_cvt_pk_bf16_f32 v57, v114, v115
  s_waitcnt lgkmcnt(4)
  v_mfma_f32_32x32x16_bf16 v[160:175], a[248:251], v[232:235], v[160:175]
  ds_read_b64_tr_b16 a[248:249], v245 offset:21504
  ds_read_b64_tr_b16 a[250:251], v245 offset:21760
  buffer_load_dwordx4 v255, s[4:7], s43 offen offset:1024 sc1 lds
  v_cvt_pk_bf16_f32 v58, v116, v117
  v_cvt_pk_bf16_f32 v59, v118, v119
  v_cvt_pk_bf16_f32 v60, v120, v121
  v_cvt_pk_bf16_f32 v61, v122, v123
  v_mfma_f32_32x32x16_bf16 v[160:175], a[252:255], v[236:239], v[160:175]
  ds_read_b64_tr_b16 a[252:253], v245 offset:22016
  ds_read_b64_tr_b16 a[254:255], v245 offset:22272
  s_add_u32 s40, s31, 15728640
  buffer_store_dwordx4 a[216:219], v255, s[4:7], s40 offen offset:2048 sc1
  v_cvt_pk_bf16_f32 v62, v124, v125
  v_cvt_pk_bf16_f32 v63, v126, v127
  v_cvt_pk_bf16_f32 v64, v128, v129
  v_cvt_pk_bf16_f32 v65, v130, v131
  s_waitcnt vmcnt(15)
  s_barrier
  s_waitcnt lgkmcnt(4)
  v_mfma_f32_32x32x16_bf16 v[176:191], a[240:243], a[224:227], v[176:191]
  ds_read_b64_tr_b16 a[240:241], v244 offset:24576
  ds_read_b64_tr_b16 a[242:243], v244 offset:24832
  buffer_load_dwordx4 v255, s[4:7], s43 offen offset:2048 sc1 lds
  v_cvt_pk_bf16_f32 v66, v132, v133
  v_cvt_pk_bf16_f32 v67, v134, v135
  v_cvt_pk_bf16_f32 v68, v136, v137
  v_cvt_pk_bf16_f32 v69, v138, v139
  v_mfma_f32_32x32x16_bf16 v[176:191], a[244:247], a[228:231], v[176:191]
  ds_read_b64_tr_b16 a[244:245], v244 offset:25088
  ds_read_b64_tr_b16 a[246:247], v244 offset:25344
  v_lshlrev_b32 v249, 2, v253
  buffer_store_dword a216, v249, s[4:7], s44 offen sc1
  v_cvt_pk_bf16_f32 v70, v140, v141
  v_cvt_pk_bf16_f32 v71, v142, v143
  v_cvt_pk_bf16_f32 v72, v144, v145
  v_cvt_pk_bf16_f32 v73, v146, v147
  s_waitcnt lgkmcnt(4)
  v_mfma_f32_32x32x16_bf16 v[176:191], a[248:251], a[232:235], v[176:191]
  ds_read_b64_tr_b16 a[248:249], v244 offset:25600
  ds_read_b64_tr_b16 a[250:251], v244 offset:25856
  buffer_load_dwordx4 v255, s[4:7], s43 offen offset:3072 sc1 lds
  s_cmp_eq_u32 s29, 0
  s_cselect_b32 s88, -1, 0
  v_cndmask_b32_e64 v160, v160, v250, s[88:89]
  v_mov_b32 v250, v192
  v_cvt_pk_bf16_f32 v74, v148, v149
  v_cvt_pk_bf16_f32 v75, v150, v151
  v_cvt_pk_bf16_f32 v76, v152, v153
  v_cvt_pk_bf16_f32 v77, v154, v155
  v_mfma_f32_32x32x16_bf16 v[176:191], a[252:255], a[236:239], v[176:191]
  ds_read_b64_tr_b16 a[252:253], v244 offset:26112
  ds_read_b64_tr_b16 a[254:255], v244 offset:26368
  v_cvt_pk_bf16_f32 v78, v156, v157
  v_cvt_pk_bf16_f32 v79, v158, v159
  v_cvt_pk_bf16_f32 v80, v160, v161
  v_cvt_pk_bf16_f32 v81, v162, v163
  s_waitcnt lgkmcnt(4)
  v_mfma_f32_32x32x16_bf16 v[192:207], a[240:243], v[224:227], v[192:207]
  ds_read_b64_tr_b16 a[240:241], v245 offset:24576
  ds_read_b64_tr_b16 a[242:243], v245 offset:24832
  s_add_u32 m0, s85, 12288
  s_add_u32 s43, s32, 81920
  buffer_load_dwordx4 v255, s[4:7], s43 offen offset:0 sc1 lds
  v_cvt_pk_bf16_f32 v82, v164, v165
  v_cvt_pk_bf16_f32 v83, v166, v167
  v_cvt_pk_bf16_f32 v84, v168, v169
  v_cvt_pk_bf16_f32 v85, v170, v171
  v_mfma_f32_32x32x16_bf16 v[192:207], a[244:247], v[228:231], v[192:207]
  ds_read_b64_tr_b16 a[244:245], v245 offset:25088
  ds_read_b64_tr_b16 a[246:247], v245 offset:25344
  v_cvt_pk_bf16_f32 v86, v172, v173
  v_cvt_pk_bf16_f32 v87, v174, v175
  s_waitcnt lgkmcnt(4)
  v_mfma_f32_32x32x16_bf16 v[192:207], a[248:251], v[232:235], v[192:207]
  ds_read_b64_tr_b16 a[248:249], v245 offset:25600
  ds_read_b64_tr_b16 a[250:251], v245 offset:25856
  buffer_load_dwordx4 v255, s[4:7], s43 offen offset:1024 sc1 lds
  v_cvt_pk_bf16_f32 v88, v176, v177
  v_cvt_pk_bf16_f32 v89, v178, v179
  v_cvt_pk_bf16_f32 v90, v180, v181
  v_cvt_pk_bf16_f32 v91, v182, v183
  buffer_store_dwordx4 a[220:223], v255, s[4:7], s47 offen offset:1024 sc1
  v_mfma_f32_32x32x16_bf16 v[192:207], a[252:255], v[236:239], v[192:207]
  ds_read_b64_tr_b16 a[252:253], v245 offset:26112
  ds_read_b64_tr_b16 a[254:255], v245 offset:26368
  v_cvt_pk_bf16_f32 v92, v184, v185
  v_cvt_pk_bf16_f32 v93, v186, v187
  v_cvt_pk_bf16_f32 v94, v188, v189
  v_cvt_pk_bf16_f32 v95, v190, v191
  s_barrier
  s_waitcnt lgkmcnt(4)
  v_mfma_f32_32x32x16_bf16 v[208:223], a[240:243], a[224:227], v[208:223]
  buffer_load_dwordx4 v255, s[4:7], s43 offen offset:2048 sc1 lds
  v_mov_b32 v156, 0
  v_mov_b32 v157, 0
  v_mov_b32 v158, s38
  v_mov_b32 v159, s39
  v_mfma_f32_32x32x16_bf16 v[208:223], a[244:247], a[228:231], v[208:223]
  buffer_load_dwordx4 v[144:147], v255, s[4:7], s96 offen offset:0 sc1
  buffer_load_dwordx4 v[148:151], v255, s[4:7], s96 offen offset:1024 sc1
  buffer_load_dwordx4 v[152:155], v255, s[4:7], s96 offen offset:2048 sc1
  s_mov_b64 exec, s[78:79]
  buffer_load_dwordx4 v[156:159], v255, s[4:7], s96 offen offset:3072 sc1
  s_mov_b64 exec, -1
  s_waitcnt lgkmcnt(0)
  v_mfma_f32_32x32x16_bf16 v[208:223], a[248:251], a[232:235], v[208:223]
  buffer_load_dwordx4 v255, s[4:7], s43 offen offset:3072 sc1 lds
  s_cmp_eq_u32 s30, 0
  s_cselect_b32 s88, -1, 0
  v_cndmask_b32_e64 v192, v192, v250, s[88:89]
  v_mfma_f32_32x32x16_bf16 v[208:223], a[252:255], a[236:239], v[208:223]
  v_cvt_pk_bf16_f32 v96, v192, v193
  v_cvt_pk_bf16_f32 v97, v194, v195
  v_cvt_pk_bf16_f32 v98, v196, v197
  v_cvt_pk_bf16_f32 v99, v198, v199
  v_add_u32 v244, 0x10000, v255
  v_add_u32 v245, 0x20000, v255
  ds_read_b128 a[224:227], v244 offset:53248
  ds_read_b128 a[228:231], v244 offset:54272
  ds_read_b128 a[232:235], v244 offset:55296
  ds_read_b128 a[236:239], v244 offset:56320
  ds_read_b128 a[240:243], v244 offset:57344
  ds_read_b128 a[244:247], v244 offset:58368
  s_waitcnt lgkmcnt(4)
  v_mfma_f32_32x32x16_bf16 v[112:127], a[224:227], v[0:3], 0
  ds_read_b128 a[248:251], v244 offset:59392
  v_mov_b32 v234, v251
  v_mov_b32 v232, s38
  v_mov_b32 v233, s39
  s_mul_i32 s50, s67, 114688
  s_add_u32 s50, s50, 6553600
  s_branch L_over3
L_pad3:
  s_branch L_pad7
L_over3:
  v_mfma_f32_32x32x16_bf16 v[112:127], a[228:231], v[4:7], v[112:127]
  ds_read_b128 a[252:255], v244 offset:60416
  s_add_u32 m0, s85, 16384
  s_add_u32 s43, s32, 98304
  buffer_load_dwordx4 v255, s[4:7], s43 offen offset:0 sc1 lds
  s_waitcnt lgkmcnt(4)
  v_mfma_f32_32x32x16_bf16 v[112:127], a[232:235], v[8:11], v[112:127]
  ds_read_b128 a[224:227], v244 offset:61440
  buffer_load_dwordx4 v255, s[4:7], s43 offen offset:1024 sc1 lds
  s_lshl_b32 s53, s86, 10
  s_add_u32 s53, s53, s50
  v_mfma_f32_32x32x16_bf16 v[112:127], a[236:239], v[12:15], v[112:127]
  ds_read_b128 a[228:231], v244 offset:62464
  buffer_load_dwordx4 v255, s[4:7], s43 offen offset:2048 sc1 lds
  s_mul_i32 s51, s74, 3670016
  s_waitcnt lgkmcnt(4)
  v_mfma_f32_32x32x16_bf16 v[112:127], a[240:243], v[16:19], v[112:127]
  ds_read_b128 a[232:235], v244 offset:63488
  s_sub_u32 s54, 3670016, s51
  s_lshl3_add_u32 s51, s84, s51
  s_lshl3_add_u32 s54, s84, s54
  v_cvt_pk_bf16_f32 v100, v200, v201
  v_cvt_pk_bf16_f32 v101, v202, v203
  v_mfma_f32_32x32x16_bf16 v[112:127], a[244:247], v[20:23], v[112:127]
  ds_read_b128 a[236:239], v244 offset:64512
  v_cvt_pk_bf16_f32 v102, v204, v205
  v_cvt_pk_bf16_f32 v103, v206, v207
  v_cvt_pk_bf16_f32 v104, v208, v209
  v_cvt_pk_bf16_f32 v105, v210, v211
  s_waitcnt lgkmcnt(4)
  v_mfma_f32_32x32x16_bf16 v[112:127], a[248:251], v[24:27], v[112:127]
  ds_read_b128 a[240:243], v245 offset:0
  buffer_store_dwordx4 a[220:223], v255, s[4:7], s47 offen offset:2048 sc1
  v_mfma_f32_32x32x16_bf16 v[112:127], a[252:255], v[28:31], v[112:127]
  ds_read_b128 a[244:247], v245 offset:1024
  buffer_load_dwordx4 v255, s[4:7], s43 offen offset:3072 sc1 lds
  v_cvt_pk_bf16_f32 v106, v212, v213
  s_waitcnt lgkmcnt(4)
  v_mfma_f32_32x32x16_bf16 v[112:127], a[224:227], v[32:35], v[112:127]
  ds_read_b128 a[248:251], v245 offset:2048
  v_cvt_pk_bf16_f32 v107, v214, v215
  v_cvt_pk_bf16_f32 v108, v216, v217
  v_cvt_pk_bf16_f32 v109, v218, v219
  v_cvt_pk_bf16_f32 v110, v220, v221
  v_cvt_pk_bf16_f32 v111, v222, v223
  v_mfma_f32_32x32x16_bf16 v[112:127], a[228:231], v[36:39], v[112:127]
  ds_read_b128 a[252:255], v245 offset:3072
  s_lshl4_add_u32 s48, s70, s69
  s_lshl_b32 s48, s48, 7
  s_add_u32 s48, s48, 262144
  s_mov_b32 s55, 262144
  s_waitcnt lgkmcnt(4)
  v_mfma_f32_32x32x16_bf16 v[112:127], a[232:235], v[40:43], v[112:127]
  ds_read_b128 a[224:227], v245 offset:4096
  s_add_u32 m0, s85, 20480
  s_add_u32 s43, s32, 114688
  buffer_load_dwordx4 v255, s[4:7], s43 offen offset:0 sc1 lds
  v_mfma_f32_32x32x16_bf16 v[112:127], a[236:239], v[44:47], v[112:127]
  ds_read_b128 a[228:231], v245 offset:5120
  v_and_b32 v240, 3, v253
  v_lshl_add_u32 v240, v240, 2, s64
  v_lshrrev_b32 v241, 2, v253
  v_and_b32 v241, 2, v241
  s_waitcnt lgkmcnt(4)
  v_mfma_f32_32x32x16_bf16 v[112:127], a[240:243], v[48:51], v[112:127]
  ds_read_b128 a[232:235], v245 offset:6144
  buffer_load_dwordx4 v255, s[4:7], s43 offen offset:1024 sc1 lds
  v_sub_u32 v240, v240, v241
  v_med3_i32 v240, v240, 0, 13
  v_mfma_f32_32x32x16_bf16 v[112:127], a[244:247], v[52:55], v[112:127]
  ds_read_b128 a[236:239], v245 offset:7168
  v_and_b32 v241, 4, v253
  v_lshlrev_b32 v241, 3, v241
  v_xor_b32 v241, s71, v241
  v_lshl_add_u32 v240, v241, 4, v240
  s_waitcnt lgkmcnt(4)
  v_mfma_f32_32x32x16_bf16 v[112:127], a[248:251], v[56:59], v[112:127]
  ds_read_b128 a[240:243], v245 offset:8192
  v_lshlrev_b32 v240, 7, v240
  v_mfma_f32_32x32x16_bf16 v[112:127], a[252:255], v[60:63], v[112:127]
  ds_read_b128 a[244:247], v245 offset:9216
  buffer_load_dwordx4 v255, s[4:7], s43 offen offset:2048 sc1 lds
  s_waitcnt lgkmcnt(4)
  v_mfma_f32_32x32x16_bf16 v[112:127], a[224:227], v[64:67], v[112:127]
  ds_read_b128 a[248:251], v245 offset:10240
  s_add_u32 s99, s49, 34816
  buffer_load_dwordx4 a[32:35], v234, s[4:7], s99 offen offset:0 sc1
  v_add_u32 v242, s51, v255
  v_mfma_f32_32x32x16_bf16 v[112:127], a[228:231], v[68:71], v[112:127]
  ds_read_b128 a[252:255], v245 offset:11264
  s_waitcnt vmcnt(13)
  v_cmp_ne_u64 vcc, v[146:147], s[38:39]
  s_waitcnt vmcnt(12)
  v_cmp_ne_u64 s[88:89], v[150:151], s[38:39]
  s_waitcnt vmcnt(11)
  v_cmp_ne_u64 s[92:93], v[154:155], s[38:39]
  s_waitcnt vmcnt(10)
  v_cmp_ne_u64 s[94:95], v[158:159], s[38:39]
  s_or_b64 s[88:89], s[88:89], vcc
  s_or_b64 s[92:93], s[92:93], s[94:95]
  s_or_b64 s[88:89], s[88:89], s[92:93]
  s_cbranch_scc1 SLOW_49
BACK_50:
  s_waitcnt lgkmcnt(4)
  v_mfma_f32_32x32x16_bf16 v[112:127], a[232:235], v[72:75], v[112:127]
  ds_read_b128 a[224:227], v245 offset:12288
  v_add_f32 v144, v144, v148
  v_add_f32 v145, v145, v149
  v_add_f32 v152, v152, v156
  buffer_store_dwordx4 a[220:223], v255, s[4:7], s47 offen offset:3072 sc1
  v_mfma_f32_32x32x16_bf16 v[112:127], a[236:239], v[76:79], v[112:127]
  ds_read_b128 a[228:231], v245 offset:13312
  v_add_f32 v153, v153, v157
  v_add_f32 v248, v144, v152
  v_add_f32 v250, v145, v153
  v_mov_b32 v251, 0
  s_waitcnt lgkmcnt(4)
  v_mfma_f32_32x32x16_bf16 v[112:127], a[240:243], v[80:83], v[112:127]
  ds_read_b128 a[232:235], v245 offset:14336
  v_permlane32_swap_b32 v248, v250
  v_add_f32 v248, v248, v250
  v_mul_f32 v248, 0x3b124925, v248
  v_mov_b32 v250, v248
  v_mfma_f32_32x32x16_bf16 v[112:127], a[244:247], v[84:87], v[112:127]
  ds_read_b128 a[236:239], v245 offset:15360
  v_permlane32_swap_b32 v248, v250
  v_fma_f32 v250, -v248, v248, v250
  v_cvt_pk_bf16_f32 v249, -v248, -v248
  s_waitcnt lgkmcnt(4)
  v_mfma_f32_32x32x16_bf16 v[112:127], a[248:251], v[88:91], v[112:127]
  ds_read_b64 a[240:241], v255 offset:0
  buffer_load_dwordx4 v255, s[4:7], s43 offen offset:3072 sc1 lds
  v_max_f32 v250, 0, v250
  v_add_f32 v254, 0x3727c5ac, v250
  v_mfma_f32_32x32x16_bf16 v[112:127], a[252:255], v[92:95], v[112:127]
  ds_read_b128 a[244:247], v245 offset:16384
  buffer_load_dwordx4 a[36:39], v234, s[4:7], s99 offen offset:1024 sc1
  v_lshlrev_b32 v250, 16, v249
  s_waitcnt lgkmcnt(4)
  v_mfma_f32_32x32x16_bf16 v[112:127], a[224:227], v[96:99], v[112:127]
  ds_read_b128 a[248:251], v245 offset:17408
  v_rsq_f32 v247, v254
  v_sub_f32 v250, -v248, v250
  v_cndmask_b32_e64 v248, 0, v249, s[78:79]
  v_cvt_pk_bf16_f32 v249, v250, v250
  v_mfma_f32_32x32x16_bf16 v[112:127], a[228:231], v[100:103], v[112:127]
  ds_read_b128 a[252:255], v245 offset:18432
  v_mov_b32 v250, 0
  v_cndmask_b32_e64 v249, 0, v249, s[78:79]
  v_mul_f32 v247, 0xbfb8aa3b, v247
  v_add_u32 v246, s54, v255
  s_waitcnt lgkmcnt(4)
  v_mfma_f32_32x32x16_bf16 v[112:127], a[232:235], v[104:107], v[112:127]
  ds_read_b128 a[224:227], v245 offset:19456
  s_add_u32 s99, s49, 100352
  buffer_load_dwordx4 a[40:43], v234, s[4:7], s99 offen offset:0 sc1
  s_waitcnt vmcnt(13)
  s_barrier
  v_mfma_f32_32x32x16_bf16 v[112:127], a[236:239], v[108:111], v[112:127]
  ds_read_b128 a[228:231], v255 offset:4096
  buffer_load_dwordx4 a[44:47], v234, s[4:7], s99 offen offset:1024 sc1
  s_waitcnt lgkmcnt(4)
  v_mfma_f32_32x32x16_bf16 v[112:127], a[240:243], v[248:251], v[112:127]
  ds_read_b128 a[232:235], v255 offset:5120
  s_add_u32 m0, s85, 24576
  s_add_u32 s43, s32, 131072
  buffer_load_dwordx4 v255, s[4:7], s43 offen offset:0 sc1 lds
  v_mfma_f32_32x32x16_bf16 v[128:143], a[244:247], v[0:3], 0
  ds_read_b128 a[236:239], v255 offset:6144
  s_waitcnt lgkmcnt(4)
  v_mfma_f32_32x32x16_bf16 v[128:143], a[248:251], v[4:7], v[128:143]
  ds_read_b128 a[240:243], v255 offset:7168
  buffer_load_dwordx4 v255, s[4:7], s43 offen offset:1024 sc1 lds
  v_mul_f32 v120, v120, v112
  v_mul_f32 v112, v247, v112
  v_mfma_f32_32x32x16_bf16 v[128:143], a[252:255], v[8:11], v[128:143]
  ds_read_b128 a[244:247], v255 offset:32768
  v_exp_f32 v112, v112
  v_mul_f32 v121, v121, v113
  v_mul_f32 v113, v247, v113
  s_waitcnt lgkmcnt(4)
  v_mfma_f32_32x32x16_bf16 v[128:143], a[224:227], v[12:15], v[128:143]
  ds_read_b128 a[248:251], v255 offset:33792
  s_add_u32 s99, s49, 165888
  buffer_load_dwordx4 a[48:51], v234, s[4:7], s99 offen offset:0 sc1
  v_fma_f32 v112, v112, v254, v254
  v_mfma_f32_32x32x16_bf16 v[128:143], a[228:231], v[16:19], v[128:143]
  ds_read_b128 a[252:255], v255 offset:34816
  v_exp_f32 v113, v113
  v_rcp_f32 v112, v112
  s_waitcnt lgkmcnt(4)
  v_mfma_f32_32x32x16_bf16 v[128:143], a[232:235], v[20:23], v[128:143]
  ds_read_b128 a[224:227], v255 offset:35840
  buffer_load_dwordx4 a[52:55], v234, s[4:7], s99 offen offset:1024 sc1
  v_mul_f32 v122, v122, v114
  v_mul_f32 v114, v247, v114
  v_mfma_f32_32x32x16_bf16 v[128:143], a[236:239], v[24:27], v[128:143]
  ds_read_b128 a[228:231], v255 offset:61440
  v_fma_f32 v113, v113, v254, v254
  v_exp_f32 v114, v114
  v_mul_f32 v120, v120, v112
  s_waitcnt lgkmcnt(4)
  v_mfma_f32_32x32x16_bf16 v[128:143], a[240:243], v[28:31], v[128:143]
  ds_read_b128 a[232:235], v255 offset:62464
  buffer_load_dwordx4 v255, s[4:7], s43 offen offset:2048 sc1 lds
  v_rcp_f32 v113, v113
  v_mfma_f32_32x32x16_bf16 v[128:143], a[244:247], v[32:35], v[128:143]
  ds_read_b128 a[236:239], v255 offset:63488
  v_mul_f32 v123, v123, v115
  v_mul_f32 v115, v247, v115
  v_fma_f32 v114, v114, v254, v254
  s_waitcnt lgkmcnt(4)
  v_mfma_f32_32x32x16_bf16 v[128:143], a[248:251], v[36:39], v[128:143]
  ds_read_b128 a[240:243], v255 offset:64512
  s_add_u32 s99, s49, 4096
  buffer_load_dwordx4 a[56:59], v234, s[4:7], s99 offen offset:0 sc1
  v_mfma_f32_32x32x16_bf16 v[128:143], a[252:255], v[40:43], v[128:143]
  ds_read_b128 a[244:247], v244 offset:24576
  v_exp_f32 v115, v115
  v_mul_f32 v121, v121, v113
  s_waitcnt lgkmcnt(4)
  v_mfma_f32_32x32x16_bf16 v[128:143], a[224:227], v[44:47], v[128:143]
  ds_read_b128 a[248:251], v244 offset:25600
  buffer_load_dwordx4 v255, s[4:7], s43 offen offset:3072 sc1 lds
  v_rcp_f32 v114, v114
  v_mfma_f32_32x32x16_bf16 v[128:143], a[228:231], v[48:51], v[128:143]
  ds_read_b128 a[252:255], v244 offset:26624
  buffer_load_dwordx4 a[60:63], v234, s[4:7], s99 offen offset:1024 sc1
  v_cvt_pk_bf16_f32 v112, v120, v121
  s_waitcnt lgkmcnt(4)
  v_mfma_f32_32x32x16_bf16 v[128:143], a[232:235], v[52:55], v[128:143]
  ds_read_b128 a[224:227], v244 offset:27648
  v_mul_f32 v124, v124, v116
  v_mul_f32 v116, v247, v116
  v_fma_f32 v115, v115, v254, v254
  v_exp_f32 v116, v116
  v_mfma_f32_32x32x16_bf16 v[128:143], a[236:239], v[56:59], v[128:143]
  ds_read_b128 a[228:231], v255 offset:8192
  v_mul_f32 v122, v122, v114
  v_rcp_f32 v115, v115
  v_and_b32 v112, -2, v112
  s_waitcnt lgkmcnt(4)
  v_mfma_f32_32x32x16_bf16 v[128:143], a[240:243], v[60:63], v[128:143]
  ds_read_b128 a[232:235], v255 offset:9216
  s_add_u32 s99, s49, 69632
  buffer_load_dwordx4 a[64:67], v234, s[4:7], s99 offen offset:0 sc1
  v_mul_f32 v125, v125, v117
  v_mfma_f32_32x32x16_bf16 v[128:143], a[244:247], v[64:67], v[128:143]
  ds_read_b128 a[236:239], v255 offset:10240
  v_mul_f32 v117, v247, v117
  v_fma_f32 v116, v116, v254, v254
  v_exp_f32 v117, v117
  s_waitcnt lgkmcnt(4)
  v_mfma_f32_32x32x16_bf16 v[128:143], a[248:251], v[68:71], v[128:143]
  ds_read_b128 a[240:243], v255 offset:11264
  s_add_u32 m0, s33, 0
  s_add_u32 s43, s32, 147456
  buffer_load_dwordx4 v255, s[4:7], s43 offen offset:0 sc1 lds
  v_mfma_f32_32x32x16_bf16 v[128:143], a[252:255], v[72:75], v[128:143]
  ds_read_b128 a[244:247], v255 offset:36864
  buffer_load_dwordx4 a[68:71], v234, s[4:7], s99 offen offset:1024 sc1
  v_mul_f32 v123, v123, v115
  s_waitcnt lgkmcnt(4)
  v_mfma_f32_32x32x16_bf16 v[128:143], a[224:227], v[76:79], v[128:143]
  ds_read_b128 a[248:251], v255 offset:37888
  v_rcp_f32 v116, v116
  v_cvt_pk_bf16_f32 v113, v122, v123
  v_mul_f32 v126, v126, v118
  v_mul_f32 v118, v247, v118
  v_mfma_f32_32x32x16_bf16 v[128:143], a[228:231], v[80:83], v[128:143]
  ds_read_b128 a[252:255], v255 offset:38912
  v_fma_f32 v117, v117, v254, v254
  v_exp_f32 v118, v118
  v_mul_f32 v124, v124, v116
  s_waitcnt lgkmcnt(4)
  v_mfma_f32_32x32x16_bf16 v[128:143], a[232:235], v[84:87], v[128:143]
  ds_read_b128 a[224:227], v255 offset:39936
  buffer_load_dwordx4 v255, s[4:7], s43 offen offset:1024 sc1 lds
  s_add_u32 s99, s49, 135168
  buffer_load_dwordx4 a[72:75], v234, s[4:7], s99 offen offset:0 sc1
  v_mfma_f32_32x32x16_bf16 v[128:143], a[236:239], v[88:91], v[128:143]
  ds_read_b64 a[228:229], v255 offset:8
  v_rcp_f32 v117, v117
  v_mul_f32 v127, v127, v119
  v_mul_f32 v119, v247, v119
  s_waitcnt lgkmcnt(4)
  v_mfma_f32_32x32x16_bf16 v[128:143], a[240:243], v[92:95], v[128:143]
  ds_read_b128 a[232:235], v244 offset:0
  v_fma_f32 v118, v118, v254, v254
  v_exp_f32 v119, v119
  v_mul_f32 v125, v125, v117
  v_mfma_f32_32x32x16_bf16 v[128:143], a[244:247], v[96:99], v[128:143]
  ds_read_b128 a[236:239], v244 offset:1024
  v_rcp_f32 v118, v118
  v_cvt_pk_bf16_f32 v114, v124, v125
  v_fma_f32 v119, v119, v254, v254
  buffer_load_dwordx4 a[76:79], v234, s[4:7], s99 offen offset:1024 sc1
  s_waitcnt lgkmcnt(4)
  v_mfma_f32_32x32x16_bf16 v[128:143], a[248:251], v[100:103], v[128:143]
  ds_read_b128 a[240:243], v244 offset:2048
  v_mul_f32 v126, v126, v118
  v_rcp_f32 v119, v119
  s_nop 0
  v_mul_f32 v127, v127, v119
  s_waitcnt vmcnt(18)
  s_mov_b64 exec, 1
  buffer_store_dwordx2 v[232:233], v255, s[4:7], s48 offen sc1
  s_mov_b64 exec, -1
  v_mfma_f32_32x32x16_bf16 v[128:143], a[252:255], v[104:107], v[128:143]
  ds_read_b128 a[244:247], v244 offset:3072
  v_cvt_pk_bf16_f32 v115, v126, v127
  buffer_load_dwordx4 v255, s[4:7], s43 offen offset:2048 sc1 lds
  s_waitcnt lgkmcnt(4)
  v_mfma_f32_32x32x16_bf16 v[128:143], a[224:227], v[108:111], v[128:143]
  ds_read_b128 a[248:251], v244 offset:28672
  buffer_store_dwordx4 v[112:115], v255, s[4:7], s46 offen offset:0 sc1
  s_add_u32 s99, s52, 4096
  buffer_load_dwordx4 a[80:83], v234, s[4:7], s99 offen offset:0 sc1
  v_mfma_f32_32x32x16_bf16 v[128:143], a[228:231], v[248:251], v[128:143]
  ds_read_b128 a[252:255], v244 offset:29696
  s_waitcnt lgkmcnt(4)
  v_mfma_f32_32x32x16_bf16 v[112:127], a[232:235], v[0:3], 0
  ds_read_b128 a[224:227], v244 offset:30720
  s_lshl_b32 s40, s74, 12
  s_lshl_b32 s41, s73, 10
  s_add_u32 s40, s40, s41
  s_add_u32 s40, s40, 155648
  v_add_u32 v243, s40, v255
  v_mfma_f32_32x32x16_bf16 v[112:127], a[236:239], v[4:7], v[112:127]
  ds_read_b128 a[228:231], v244 offset:31744
  buffer_load_dwordx4 v255, s[4:7], s43 offen offset:3072 sc1 lds
  buffer_load_dwordx4 a[84:87], v234, s[4:7], s99 offen offset:1024 sc1
  s_waitcnt lgkmcnt(4)
  v_mfma_f32_32x32x16_bf16 v[112:127], a[240:243], v[8:11], v[112:127]
  ds_read_b128 a[232:235], v255 offset:12288
  v_mul_f32 v136, v136, v128
  v_mul_f32 v128, v247, v128
  v_exp_f32 v128, v128
  v_mul_f32 v137, v137, v129
  v_mfma_f32_32x32x16_bf16 v[112:127], a[244:247], v[12:15], v[112:127]
  ds_read_b128 a[236:239], v255 offset:13312
  v_mul_f32 v129, v247, v129
  v_fma_f32 v128, v128, v254, v254
  v_exp_f32 v129, v129
  s_waitcnt lgkmcnt(4)
  v_mfma_f32_32x32x16_bf16 v[112:127], a[248:251], v[16:19], v[112:127]
  ds_read_b128 a[240:243], v255 offset:14336
  s_add_u32 s99, s49, 38912
  buffer_load_dwordx4 a[88:91], v234, s[4:7], s99 offen offset:0 sc1
  v_mfma_f32_32x32x16_bf16 v[112:127], a[252:255], v[20:23], v[112:127]
  ds_read_b128 a[244:247], v255 offset:15360
  v_rcp_f32 v128, v128
  v_mul_f32 v138, v138, v130
  v_mul_f32 v130, v247, v130
  s_waitcnt lgkmcnt(4)
  v_mfma_f32_32x32x16_bf16 v[112:127], a[224:227], v[24:27], v[112:127]
  ds_read_b128 a[248:251], v255 offset:40960
  v_fma_f32 v129, v129, v254, v254
  v_exp_f32 v130, v130
  v_mul_f32 v136, v136, v128
  v_mfma_f32_32x32x16_bf16 v[112:127], a[228:231], v[28:31], v[112:127]
  ds_read_b128 a[252:255], v255 offset:41984
  buffer_load_dwordx4 a[92:95], v234, s[4:7], s99 offen offset:1024 sc1
  s_waitcnt lgkmcnt(4)
  v_mfma_f32_32x32x16_bf16 v[112:127], a[232:235], v[32:35], v[112:127]
  ds_read_b128 a[224:227], v255 offset:43008
  v_rcp_f32 v129, v129
  v_mul_f32 v139, v139, v131
  v_mul_f32 v131, v247, v131
  v_fma_f32 v130, v130, v254, v254
  v_mfma_f32_32x32x16_bf16 v[112:127], a[236:239], v[36:39], v[112:127]
  ds_read_b128 a[228:231], v255 offset:44032
  v_exp_f32 v131, v131
  v_mul_f32 v137, v137, v129
  s_waitcnt lgkmcnt(4)
  v_mfma_f32_32x32x16_bf16 v[112:127], a[240:243], v[40:43], v[112:127]
  ds_read_b128 a[232:235], v244 offset:4096
  s_add_u32 s99, s49, 104448
  buffer_load_dwordx4 a[96:99], v234, s[4:7], s99 offen offset:0 sc1
  v_mfma_f32_32x32x16_bf16 v[112:127], a[244:247], v[44:47], v[112:127]
  ds_read_b128 a[236:239], v244 offset:5120
  v_rcp_f32 v130, v130
  v_cvt_pk_bf16_f32 v128, v136, v137
  v_mul_f32 v140, v140, v132
  s_waitcnt lgkmcnt(4)
  v_mfma_f32_32x32x16_bf16 v[112:127], a[248:251], v[48:51], v[112:127]
  ds_read_b128 a[240:243], v244 offset:6144
  v_mul_f32 v132, v247, v132
  v_fma_f32 v131, v131, v254, v254
  v_exp_f32 v132, v132
  v_mul_f32 v138, v138, v130
  v_mfma_f32_32x32x16_bf16 v[112:127], a[252:255], v[52:55], v[112:127]
  ds_read_b128 a[244:247], v244 offset:7168
  buffer_load_dwordx4 a[100:103], v234, s[4:7], s99 offen offset:1024 sc1
  s_waitcnt lgkmcnt(4)
  v_mfma_f32_32x32x16_bf16 v[112:127], a[224:227], v[56:59], v[112:127]
  ds_read_b128 a[248:251], v244 offset:32768
  v_rcp_f32 v131, v131
  v_and_b32 v128, -2, v128
  v_mul_f32 v141, v141, v133
  v_mul_f32 v133, v247, v133
  v_mfma_f32_32x32x16_bf16 v[112:127], a[228:231], v[60:63], v[112:127]
  ds_read_b128 a[252:255], v244 offset:33792
  v_fma_f32 v132, v132, v254, v254
  v_exp_f32 v133, v133
  v_mul_f32 v139, v139, v131
  s_waitcnt lgkmcnt(4)
  v_mfma_f32_32x32x16_bf16 v[112:127], a[232:235], v[64:67], v[112:127]
  ds_read_b128 a[224:227], v244 offset:34816
  s_add_u32 s99, s49, 169984
  buffer_load_dwordx4 a[104:107], v234, s[4:7], s99 offen offset:0 sc1
  v_mfma_f32_32x32x16_bf16 v[112:127], a[236:239], v[68:71], v[112:127]
  ds_read_b128 a[228:231], v244 offset:35840
  v_rcp_f32 v132, v132
  v_cvt_pk_bf16_f32 v129, v138, v139
  v_mul_f32 v142, v142, v134
  s_waitcnt lgkmcnt(4)
  v_mfma_f32_32x32x16_bf16 v[112:127], a[240:243], v[72:75], v[112:127]
  ds_read_b128 a[232:235], v255 offset:16384
  buffer_load_dwordx4 a[108:111], v234, s[4:7], s99 offen offset:1024 sc1
  v_mul_f32 v134, v247, v134
  v_fma_f32 v133, v133, v254, v254
  v_mfma_f32_32x32x16_bf16 v[112:127], a[244:247], v[76:79], v[112:127]
  ds_read_b128 a[236:239], v255 offset:17408
  v_exp_f32 v134, v134
  v_mul_f32 v140, v140, v132
  s_waitcnt lgkmcnt(4)
  v_mfma_f32_32x32x16_bf16 v[112:127], a[248:251], v[80:83], v[112:127]
  ds_read_b128 a[240:243], v255 offset:18432
  v_rcp_f32 v133, v133
  v_mul_f32 v143, v143, v135
  v_mul_f32 v135, v247, v135
  v_fma_f32 v134, v134, v254, v254
  v_mfma_f32_32x32x16_bf16 v[112:127], a[252:255], v[84:87], v[112:127]
  ds_read_b128 a[244:247], v255 offset:19456
  s_add_u32 s99, s49, 8192
  buffer_load_dwordx4 a[112:115], v234, s[4:7], s99 offen offset:0 sc1
  s_waitcnt lgkmcnt(4)
  v_mfma_f32_32x32x16_bf16 v[112:127], a[224:227], v[88:91], v[112:127]
  ds_read_b64 a[248:249], v255 offset:1024
  v_exp_f32 v135, v135
  v_mul_f32 v141, v141, v133
  v_rcp_f32 v134, v134
  v_mfma_f32_32x32x16_bf16 v[112:127], a[228:231], v[92:95], v[112:127]
  ds_read_b128 a[252:255], v255 offset:45056
  v_cvt_pk_bf16_f32 v130, v140, v141
  v_fma_f32 v135, v135, v254, v254
  v_mul_f32 v142, v142, v134
  s_waitcnt lgkmcnt(4)
  v_mfma_f32_32x32x16_bf16 v[112:127], a[232:235], v[96:99], v[112:127]
  ds_read_b128 a[224:227], v255 offset:46080
  v_rcp_f32 v135, v135
  s_nop 0
  v_mul_f32 v143, v143, v135
  v_cvt_pk_bf16_f32 v131, v142, v143
  v_mfma_f32_32x32x16_bf16 v[112:127], a[236:239], v[100:103], v[112:127]
  ds_read_b128 a[228:231], v255 offset:47104
  buffer_load_dwordx4 a[116:119], v234, s[4:7], s99 offen offset:1024 sc1
  s_waitcnt lgkmcnt(4)
  v_mfma_f32_32x32x16_bf16 v[112:127], a[240:243], v[104:107], v[112:127]
  ds_read_b128 a[232:235], v255 offset:48128
  buffer_store_dwordx4 v[128:131], v255, s[4:7], s46 offen offset:1024 sc1
  v_mfma_f32_32x32x16_bf16 v[112:127], a[244:247], v[108:111], v[112:127]
  ds_read_b128 a[236:239], v244 offset:8192
  s_add_u32 s99, s49, 73728
  buffer_load_dwordx4 a[120:123], v234, s[4:7], s99 offen offset:0 sc1
  s_waitcnt lgkmcnt(4)
  v_mfma_f32_32x32x16_bf16 v[112:127], a[248:251], v[248:251], v[112:127]
  ds_read_b128 a[240:243], v244 offset:9216
  v_mfma_f32_32x32x16_bf16 v[128:143], a[252:255], v[0:3], 0
  ds_read_b128 a[244:247], v244 offset:10240
  buffer_load_dwordx4 a[124:127], v234, s[4:7], s99 offen offset:1024 sc1
  s_waitcnt lgkmcnt(4)
  v_mfma_f32_32x32x16_bf16 v[128:143], a[224:227], v[4:7], v[128:143]
  ds_read_b128 a[248:251], v244 offset:11264
  v_mul_f32 v120, v120, v112
  v_mul_f32 v112, v247, v112
  v_exp_f32 v112, v112
  v_mul_f32 v121, v121, v113
  v_mfma_f32_32x32x16_bf16 v[128:143], a[228:231], v[8:11], v[128:143]
  ds_read_b128 a[252:255], v244 offset:36864
  v_mul_f32 v113, v247, v113
  v_fma_f32 v112, v112, v254, v254
  v_exp_f32 v113, v113
  s_waitcnt lgkmcnt(4)
  v_mfma_f32_32x32x16_bf16 v[128:143], a[232:235], v[12:15], v[128:143]
  ds_read_b128 a[224:227], v244 offset:37888
  v_rcp_f32 v112, v112
  v_mul_f32 v122, v122, v114
  v_mul_f32 v114, v247, v114
  v_fma_f32 v113, v113, v254, v254
  v_mfma_f32_32x32x16_bf16 v[128:143], a[236:239], v[16:19], v[128:143]
  ds_read_b128 a[228:231], v244 offset:38912
  v_exp_f32 v114, v114
  v_mul_f32 v120, v120, v112
  s_waitcnt lgkmcnt(4)
  v_mfma_f32_32x32x16_bf16 v[128:143], a[240:243], v[20:23], v[128:143]
  ds_read_b128 a[232:235], v244 offset:39936
  v_rcp_f32 v113, v113
  v_mul_f32 v123, v123, v115
  s_waitcnt vmcnt(12)
  s_barrier
  v_mfma_f32_32x32x16_bf16 v[128:143], a[244:247], v[24:27], v[128:143]
  ds_read_b128 a[236:239], v255 offset:20480
  v_mul_f32 v115, v247, v115
  v_fma_f32 v114, v114, v254, v254
  v_exp_f32 v115, v115
  s_waitcnt lgkmcnt(4)
  v_mfma_f32_32x32x16_bf16 v[128:143], a[248:251], v[28:31], v[128:143]
  ds_read_b128 a[240:243], v255 offset:21504
  s_add_u32 m0, s33, 16384
  s_add_u32 s43, s32, 163840
  buffer_load_dwordx4 v255, s[4:7], s43 offen offset:0 sc1 lds
  v_mfma_f32_32x32x16_bf16 v[128:143], a[252:255], v[32:35], v[128:143]
  ds_read_b128 a[244:247], v255 offset:22528
  buffer_load_dwordx4 v255, s[4:7], s43 offen offset:1024 sc1 lds
  v_mul_f32 v121, v121, v113
  s_waitcnt lgkmcnt(4)
  v_mfma_f32_32x32x16_bf16 v[128:143], a[224:227], v[36:39], v[128:143]
  ds_read_b128 a[248:251], v255 offset:23552
  buffer_load_dwordx4 v255, s[4:7], s43 offen offset:2048 sc1 lds
  v_rcp_f32 v114, v114
  v_mfma_f32_32x32x16_bf16 v[128:143], a[228:231], v[40:43], v[128:143]
  ds_read_b128 a[252:255], v255 offset:49152
  v_cvt_pk_bf16_f32 v112, v120, v121
  v_mul_f32 v124, v124, v116
  v_mul_f32 v116, v247, v116
  v_fma_f32 v115, v115, v254, v254
  s_waitcnt lgkmcnt(4)
  v_mfma_f32_32x32x16_bf16 v[128:143], a[232:235], v[44:47], v[128:143]
  ds_read_b128 a[224:227], v255 offset:50176
  buffer_load_dwordx4 v255, s[4:7], s43 offen offset:3072 sc1 lds
  v_exp_f32 v116, v116
  v_mfma_f32_32x32x16_bf16 v[128:143], a[236:239], v[48:51], v[128:143]
  ds_read_b128 a[228:231], v255 offset:51200
  v_mul_f32 v122, v122, v114
  v_rcp_f32 v115, v115
  v_and_b32 v112, -2, v112
  s_waitcnt lgkmcnt(4)
  v_mfma_f32_32x32x16_bf16 v[128:143], a[240:243], v[52:55], v[128:143]
  ds_read_b128 a[232:235], v255 offset:52224
  s_add_u32 m0, s85, 0
  s_add_u32 s43, s32, 180224
  buffer_load_dwordx4 v255, s[4:7], s43 offen offset:0 sc1 lds
  v_mfma_f32_32x32x16_bf16 v[128:143], a[244:247], v[56:59], v[128:143]
  ds_read_b128 a[236:239], v244 offset:12288
  v_mul_f32 v125, v125, v117
  v_mul_f32 v117, v247, v117
  v_fma_f32 v116, v116, v254, v254
  s_waitcnt lgkmcnt(4)
  v_mfma_f32_32x32x16_bf16 v[128:143], a[248:251], v[60:63], v[128:143]
  ds_read_b128 a[240:243], v244 offset:13312
  buffer_load_dwordx4 v255, s[4:7], s43 offen offset:1024 sc1 lds
  v_exp_f32 v117, v117
  v_mfma_f32_32x32x16_bf16 v[128:143], a[252:255], v[64:67], v[128:143]
  ds_read_b128 a[244:247], v244 offset:14336
  v_mul_f32 v123, v123, v115
  v_rcp_f32 v116, v116
  v_cvt_pk_bf16_f32 v113, v122, v123
  s_waitcnt lgkmcnt(4)
  v_mfma_f32_32x32x16_bf16 v[128:143], a[224:227], v[68:71], v[128:143]
  ds_read_b128 a[248:251], v244 offset:15360
  v_mul_f32 v126, v126, v118
  v_mul_f32 v118, v247, v118
  v_fma_f32 v117, v117, v254, v254
  v_exp_f32 v118, v118
  v_mfma_f32_32x32x16_bf16 v[128:143], a[228:231], v[72:75], v[128:143]
  ds_read_b128 a[252:255], v244 offset:40960
  v_mul_f32 v124, v124, v116
  buffer_load_dwordx4 v255, s[4:7], s43 offen offset:2048 sc1 lds
  s_waitcnt lgkmcnt(4)
  v_mfma_f32_32x32x16_bf16 v[128:143], a[232:235], v[76:79], v[128:143]
  ds_read_b128 a[224:227], v244 offset:41984
  v_rcp_f32 v117, v117
  v_mul_f32 v127, v127, v119
  v_mul_f32 v119, v247, v119
  v_fma_f32 v118, v118, v254, v254
  v_mfma_f32_32x32x16_bf16 v[128:143], a[236:239], v[80:83], v[128:143]
  ds_read_b128 a[228:231], v244 offset:43008
  v_exp_f32 v119, v119
  v_mul_f32 v125, v125, v117
  s_waitcnt lgkmcnt(4)
  v_mfma_f32_32x32x16_bf16 v[128:143], a[240:243], v[84:87], v[128:143]
  ds_read_b128 a[232:235], v244 offset:44032
  buffer_load_dwordx4 v255, s[4:7], s43 offen offset:3072 sc1 lds
  v_rcp_f32 v118, v118
  v_mfma_f32_32x32x16_bf16 v[128:143], a[244:247], v[88:91], v[128:143]
  ds_read_b64 a[236:237], v255 offset:1032
  v_cvt_pk_bf16_f32 v114, v124, v125
  v_fma_f32 v119, v119, v254, v254
  v_mul_f32 v126, v126, v118
  s_waitcnt lgkmcnt(4)
  v_mfma_f32_32x32x16_bf16 v[128:143], a[248:251], v[92:95], v[128:143]
  ds_read_b128 a[240:243], v255 offset:24576
  v_rcp_f32 v119, v119
  s_nop 0
  v_mul_f32 v127, v127, v119
  v_cvt_pk_bf16_f32 v115, v126, v127
  v_mfma_f32_32x32x16_bf16 v[128:143], a[252:255], v[96:99], v[128:143]
  ds_read_b128 a[244:247], v255 offset:25600
  s_waitcnt lgkmcnt(4)
  v_mfma_f32_32x32x16_bf16 v[128:143], a[224:227], v[100:103], v[128:143]
  ds_read_b128 a[248:251], v255 offset:26624
  buffer_load_dwordx2 v[236:237], v240, s[4:7], s55 offen sc1
  v_mfma_f32_32x32x16_bf16 v[128:143], a[228:231], v[104:107], v[128:143]
  ds_read_b128 a[252:255], v255 offset:27648
  s_add_u32 m0, s85, 4096
  s_add_u32 s43, s32, 196608
  buffer_load_dwordx4 v255, s[4:7], s43 offen offset:0 sc1 lds
  s_waitcnt lgkmcnt(4)
  v_mfma_f32_32x32x16_bf16 v[128:143], a[232:235], v[108:111], v[128:143]
  ds_read_b128 a[224:227], v255 offset:53248
  buffer_store_dwordx4 v[112:115], v255, s[4:7], s46 offen offset:2048 sc1
  v_mfma_f32_32x32x16_bf16 v[128:143], a[236:239], v[248:251], v[128:143]
  ds_read_b128 a[228:231], v255 offset:54272
  buffer_load_dwordx4 v255, s[4:7], s43 offen offset:1024 sc1 lds
  s_waitcnt lgkmcnt(4)
  v_mfma_f32_32x32x16_bf16 v[112:127], a[240:243], v[0:3], 0
  ds_read_b128 a[232:235], v255 offset:55296
  v_mfma_f32_32x32x16_bf16 v[112:127], a[244:247], v[4:7], v[112:127]
  ds_read_b128 a[236:239], v255 offset:56320
  buffer_load_dwordx4 v255, s[4:7], s43 offen offset:2048 sc1 lds
  v_mul_f32 v136, v136, v128
  s_waitcnt lgkmcnt(4)
  v_mfma_f32_32x32x16_bf16 v[112:127], a[248:251], v[8:11], v[112:127]
  ds_read_b128 a[240:243], v244 offset:16384
  v_mul_f32 v128, v247, v128
  v_exp_f32 v128, v128
  v_mul_f32 v137, v137, v129
  v_mul_f32 v129, v247, v129
  v_mfma_f32_32x32x16_bf16 v[112:127], a[252:255], v[12:15], v[112:127]
  ds_read_b128 a[244:247], v244 offset:17408
  buffer_load_dwordx4 v255, s[4:7], s43 offen offset:3072 sc1 lds
  s_branch L_over4
L_pad4:
  s_branch L_pad8
L_over4:
  v_fma_f32 v128, v128, v254, v254
  s_waitcnt lgkmcnt(4)
  v_mfma_f32_32x32x16_bf16 v[112:127], a[224:227], v[16:19], v[112:127]
  ds_read_b128 a[248:251], v244 offset:18432
  v_exp_f32 v129, v129
  v_rcp_f32 v128, v128
  v_mul_f32 v138, v138, v130
  v_mfma_f32_32x32x16_bf16 v[112:127], a[228:231], v[20:23], v[112:127]
  ds_read_b128 a[252:255], v244 offset:19456
  v_mul_f32 v130, v247, v130
  v_fma_f32 v129, v129, v254, v254
  v_exp_f32 v130, v130
  s_waitcnt lgkmcnt(4)
  v_mfma_f32_32x32x16_bf16 v[112:127], a[232:235], v[24:27], v[112:127]
  ds_read_b128 a[224:227], v244 offset:45056
  s_add_u32 m0, s85, 8192
  s_add_u32 s43, s32, 212992
  buffer_load_dwordx4 v255, s[4:7], s43 offen offset:0 sc1 lds
  v_mfma_f32_32x32x16_bf16 v[112:127], a[236:239], v[28:31], v[112:127]
  ds_read_b128 a[228:231], v244 offset:46080
  buffer_load_dwordx4 v255, s[4:7], s43 offen offset:1024 sc1 lds
  v_mul_f32 v136, v136, v128
  s_waitcnt lgkmcnt(4)
  v_mfma_f32_32x32x16_bf16 v[112:127], a[240:243], v[32:35], v[112:127]
  ds_read_b128 a[232:235], v244 offset:47104
  v_rcp_f32 v129, v129
  v_mul_f32 v139, v139, v131
  v_mul_f32 v131, v247, v131
  v_fma_f32 v130, v130, v254, v254
  v_mfma_f32_32x32x16_bf16 v[112:127], a[244:247], v[36:39], v[112:127]
  ds_read_b128 a[236:239], v244 offset:48128
  buffer_load_dwordx4 v255, s[4:7], s43 offen offset:2048 sc1 lds
  s_waitcnt lgkmcnt(4)
  v_mfma_f32_32x32x16_bf16 v[112:127], a[248:251], v[40:43], v[112:127]
  ds_read_b128 a[240:243], v255 offset:28672
  v_exp_f32 v131, v131
  v_mul_f32 v137, v137, v129
  v_rcp_f32 v130, v130
  v_mfma_f32_32x32x16_bf16 v[112:127], a[252:255], v[44:47], v[112:127]
  ds_read_b128 a[244:247], v255 offset:29696
  buffer_load_dwordx4 v255, s[4:7], s43 offen offset:3072 sc1 lds
  v_cvt_pk_bf16_f32 v128, v136, v137
  s_waitcnt lgkmcnt(4)
  v_mfma_f32_32x32x16_bf16 v[112:127], a[224:227], v[48:51], v[112:127]
  ds_read_b128 a[248:251], v255 offset:30720
  v_mul_f32 v140, v140, v132
  v_mul_f32 v132, v247, v132
  v_fma_f32 v131, v131, v254, v254
  v_exp_f32 v132, v132
  v_mfma_f32_32x32x16_bf16 v[112:127], a[228:231], v[52:55], v[112:127]
  ds_read_b128 a[252:255], v255 offset:31744
  v_mul_f32 v138, v138, v130
  v_rcp_f32 v131, v131
  v_and_b32 v128, -2, v128
  s_waitcnt lgkmcnt(4)
  v_mfma_f32_32x32x16_bf16 v[112:127], a[232:235], v[56:59], v[112:127]
  ds_read_b128 a[224:227], v255 offset:57344
  s_add_u32 s99, s49, 139264
  buffer_load_dwordx4 a[128:131], v234, s[4:7], s99 offen offset:0 sc1
  v_mul_f32 v141, v141, v133
  v_mfma_f32_32x32x16_bf16 v[112:127], a[236:239], v[60:63], v[112:127]
  ds_read_b128 a[228:231], v255 offset:58368
  s_waitcnt vmcnt(10)
  v_cmp_ne_u64 s[92:93], v[236:237], s[38:39]
  v_mul_f32 v133, v247, v133
  v_fma_f32 v132, v132, v254, v254
  s_waitcnt lgkmcnt(4)
  v_mfma_f32_32x32x16_bf16 v[112:127], a[240:243], v[64:67], v[112:127]
  ds_read_b128 a[232:235], v255 offset:59392
  s_cmp_lg_u64 s[92:93], 0
  s_cbranch_scc1 SLOW_29
BACK_30:
  v_exp_f32 v133, v133
  v_mul_f32 v139, v139, v131
  v_mfma_f32_32x32x16_bf16 v[112:127], a[244:247], v[68:71], v[112:127]
  ds_read_b128 a[236:239], v255 offset:60416
  s_add_u32 s42, s50, 0
  buffer_load_dwordx4 v[148:151], v246, s[4:7], s42 offen sc1
  s_waitcnt lgkmcnt(4)
  v_mfma_f32_32x32x16_bf16 v[112:127], a[248:251], v[72:75], v[112:127]
  ds_read_b128 a[240:243], v244 offset:20480
  v_rcp_f32 v132, v132
  v_cvt_pk_bf16_f32 v129, v138, v139
  v_mul_f32 v142, v142, v134
  v_mul_f32 v134, v247, v134
  v_mfma_f32_32x32x16_bf16 v[112:127], a[252:255], v[76:79], v[112:127]
  ds_read_b128 a[244:247], v244 offset:21504
  buffer_load_dwordx4 v[144:147], v242, s[4:7], s42 offen sc1
  v_fma_f32 v133, v133, v254, v254
  s_waitcnt lgkmcnt(4)
  v_mfma_f32_32x32x16_bf16 v[112:127], a[224:227], v[80:83], v[112:127]
  ds_read_b128 a[248:251], v244 offset:22528
  v_exp_f32 v134, v134
  v_mul_f32 v140, v140, v132
  v_rcp_f32 v133, v133
  v_mfma_f32_32x32x16_bf16 v[112:127], a[228:231], v[84:87], v[112:127]
  ds_read_b128 a[252:255], v244 offset:23552
  v_mul_f32 v143, v143, v135
  v_mul_f32 v135, v247, v135
  v_fma_f32 v134, v134, v254, v254
  s_waitcnt lgkmcnt(4)
  v_mfma_f32_32x32x16_bf16 v[112:127], a[232:235], v[88:91], v[112:127]
  ds_read_b64 a[224:225], v255 offset:2048
  v_exp_f32 v135, v135
  v_mul_f32 v141, v141, v133
  v_rcp_f32 v134, v134
  v_mfma_f32_32x32x16_bf16 v[112:127], a[236:239], v[92:95], v[112:127]
  ds_read_b128 a[228:231], v244 offset:49152
  s_add_u32 s42, s50, 32768
  buffer_load_dwordx4 v[156:159], v246, s[4:7], s42 offen sc1
  buffer_load_dwordx4 a[132:135], v234, s[4:7], s99 offen offset:1024 sc1
  s_waitcnt lgkmcnt(4)
  v_mfma_f32_32x32x16_bf16 v[112:127], a[240:243], v[96:99], v[112:127]
  ds_read_b128 a[232:235], v244 offset:50176
  v_cvt_pk_bf16_f32 v130, v140, v141
  v_fma_f32 v135, v135, v254, v254
  v_mul_f32 v142, v142, v134
  v_rcp_f32 v135, v135
  v_mfma_f32_32x32x16_bf16 v[112:127], a[244:247], v[100:103], v[112:127]
  ds_read_b128 a[236:239], v244 offset:51200
  v_mul_f32 v143, v143, v135
  v_cvt_pk_bf16_f32 v131, v142, v143
  s_waitcnt lgkmcnt(4)
  v_mfma_f32_32x32x16_bf16 v[112:127], a[248:251], v[104:107], v[112:127]
  ds_read_b128 a[240:243], v244 offset:52224
  buffer_load_dwordx4 v[152:155], v242, s[4:7], s42 offen sc1
  v_mfma_f32_32x32x16_bf16 v[112:127], a[252:255], v[108:111], v[112:127]
  ds_read_b128 a[244:247], v244 offset:53248
  buffer_store_dwordx4 v[128:131], v255, s[4:7], s46 offen offset:3072 sc1
  s_waitcnt lgkmcnt(4)
  v_mfma_f32_32x32x16_bf16 v[112:127], a[224:227], v[248:251], v[112:127]
  ds_read_b128 a[248:251], v244 offset:54272
  v_mfma_f32_32x32x16_bf16 v[128:143], a[228:231], v[0:3], 0
  ds_read_b128 a[252:255], v244 offset:55296
  s_add_u32 s42, s50, 65536
  buffer_load_dwordx4 v[164:167], v246, s[4:7], s42 offen sc1
  s_waitcnt lgkmcnt(4)
  v_mfma_f32_32x32x16_bf16 v[128:143], a[232:235], v[4:7], v[128:143]
  ds_read_b128 a[224:227], v244 offset:56320
  s_add_u32 s99, s52, 8192
  buffer_load_dwordx4 a[136:139], v234, s[4:7], s99 offen offset:0 sc1
  v_mul_f32 v120, v120, v112
  v_mfma_f32_32x32x16_bf16 v[128:143], a[236:239], v[8:11], v[128:143]
  ds_read_b128 a[228:231], v244 offset:57344
  v_mul_f32 v112, v247, v112
  v_exp_f32 v112, v112
  v_mul_f32 v121, v121, v113
  s_waitcnt lgkmcnt(4)
  v_mfma_f32_32x32x16_bf16 v[128:143], a[240:243], v[12:15], v[128:143]
  ds_read_b128 a[232:235], v244 offset:58368
  buffer_load_dwordx4 v[160:163], v242, s[4:7], s42 offen sc1
  v_mul_f32 v113, v247, v113
  v_fma_f32 v112, v112, v254, v254
  v_mfma_f32_32x32x16_bf16 v[128:143], a[244:247], v[16:19], v[128:143]
  ds_read_b128 a[236:239], v244 offset:59392
  v_exp_f32 v113, v113
  v_rcp_f32 v112, v112
  s_waitcnt lgkmcnt(4)
  v_mfma_f32_32x32x16_bf16 v[128:143], a[248:251], v[20:23], v[128:143]
  ds_read_b128 a[240:243], v244 offset:60416
  v_mul_f32 v122, v122, v114
  v_mul_f32 v114, v247, v114
  v_fma_f32 v113, v113, v254, v254
  v_exp_f32 v114, v114
  v_mfma_f32_32x32x16_bf16 v[128:143], a[252:255], v[24:27], v[128:143]
  ds_read_b128 a[244:247], v244 offset:61440
  s_add_u32 s42, s53, 0
  buffer_load_dwordx4 v[172:175], v246, s[4:7], s42 offen sc1
  s_waitcnt lgkmcnt(4)
  v_mfma_f32_32x32x16_bf16 v[128:143], a[224:227], v[28:31], v[128:143]
  ds_read_b128 a[248:251], v244 offset:62464
  v_mul_f32 v120, v120, v112
  v_rcp_f32 v113, v113
  v_mul_f32 v123, v123, v115
  v_mul_f32 v115, v247, v115
  v_mfma_f32_32x32x16_bf16 v[128:143], a[228:231], v[32:35], v[128:143]
  ds_read_b128 a[252:255], v244 offset:63488
  buffer_load_dwordx4 a[140:143], v234, s[4:7], s99 offen offset:1024 sc1
  v_fma_f32 v114, v114, v254, v254
  s_waitcnt lgkmcnt(4)
  v_mfma_f32_32x32x16_bf16 v[128:143], a[232:235], v[36:39], v[128:143]
  ds_read_b128 a[224:227], v244 offset:64512
  buffer_load_dwordx4 v[168:171], v242, s[4:7], s42 offen sc1
  v_exp_f32 v115, v115
  v_mfma_f32_32x32x16_bf16 v[128:143], a[236:239], v[40:43], v[128:143]
  ds_read_b128 a[228:231], v245 offset:0
  v_mul_f32 v121, v121, v113
  v_rcp_f32 v114, v114
  v_cvt_pk_bf16_f32 v112, v120, v121
  s_waitcnt lgkmcnt(4)
  v_mfma_f32_32x32x16_bf16 v[128:143], a[240:243], v[44:47], v[128:143]
  ds_read_b128 a[232:235], v245 offset:1024
  v_mul_f32 v124, v124, v116
  v_mul_f32 v116, v247, v116
  v_fma_f32 v115, v115, v254, v254
  v_exp_f32 v116, v116
  v_mfma_f32_32x32x16_bf16 v[128:143], a[244:247], v[48:51], v[128:143]
  ds_read_b128 a[236:239], v245 offset:2048
  s_add_u32 s42, s50, 17408
  buffer_load_dwordx4 v[180:183], v246, s[4:7], s42 offen sc1
  s_waitcnt lgkmcnt(4)
  v_mfma_f32_32x32x16_bf16 v[128:143], a[248:251], v[52:55], v[128:143]
  ds_read_b128 a[240:243], v245 offset:3072
  v_mul_f32 v122, v122, v114
  v_rcp_f32 v115, v115
  s_waitcnt vmcnt(14)
  s_barrier
  v_mfma_f32_32x32x16_bf16 v[128:143], a[252:255], v[56:59], v[128:143]
  ds_read_b128 a[244:247], v245 offset:4096
  buffer_load_dwordx4 v[176:179], v242, s[4:7], s42 offen sc1
  v_and_b32 v112, -2, v112
  s_waitcnt lgkmcnt(4)
  v_mfma_f32_32x32x16_bf16 v[128:143], a[224:227], v[60:63], v[128:143]
  ds_read_b128 a[248:251], v245 offset:5120
  s_add_u32 s99, s49, 43008
  buffer_load_dwordx4 a[144:147], v234, s[4:7], s99 offen offset:0 sc1
  v_mul_f32 v125, v125, v117
  v_mfma_f32_32x32x16_bf16 v[128:143], a[228:231], v[64:67], v[128:143]
  ds_read_b128 a[252:255], v245 offset:6144
  v_mul_f32 v117, v247, v117
  v_fma_f32 v116, v116, v254, v254
  v_exp_f32 v117, v117
  s_waitcnt lgkmcnt(4)
  v_mfma_f32_32x32x16_bf16 v[128:143], a[232:235], v[68:71], v[128:143]
  ds_read_b128 a[224:227], v245 offset:7168
  v_mul_f32 v123, v123, v115
  v_rcp_f32 v116, v116
  v_cvt_pk_bf16_f32 v113, v122, v123
  v_mul_f32 v126, v126, v118
  v_mfma_f32_32x32x16_bf16 v[128:143], a[236:239], v[72:75], v[128:143]
  ds_read_b128 a[228:231], v245 offset:8192
  s_add_u32 s42, s50, 50176
  buffer_load_dwordx4 v[188:191], v246, s[4:7], s42 offen sc1
  s_waitcnt lgkmcnt(4)
  v_mfma_f32_32x32x16_bf16 v[128:143], a[240:243], v[76:79], v[128:143]
  ds_read_b128 a[232:235], v245 offset:9216
  v_mul_f32 v118, v247, v118
  v_fma_f32 v117, v117, v254, v254
  v_exp_f32 v118, v118
  v_mul_f32 v124, v124, v116
  v_mfma_f32_32x32x16_bf16 v[128:143], a[244:247], v[80:83], v[128:143]
  ds_read_b128 a[236:239], v245 offset:10240
  buffer_load_dwordx4 v[184:187], v242, s[4:7], s42 offen sc1
  s_waitcnt lgkmcnt(4)
  v_mfma_f32_32x32x16_bf16 v[128:143], a[248:251], v[84:87], v[128:143]
  ds_read_b128 a[240:243], v245 offset:11264
  v_rcp_f32 v117, v117
  v_mul_f32 v127, v127, v119
  v_mul_f32 v119, v247, v119
  v_fma_f32 v118, v118, v254, v254
  v_mfma_f32_32x32x16_bf16 v[128:143], a[252:255], v[88:91], v[128:143]
  ds_read_b64 a[244:245], v255 offset:2056
  buffer_load_dwordx4 a[148:151], v234, s[4:7], s99 offen offset:1024 sc1
  s_waitcnt lgkmcnt(4)
  v_mfma_f32_32x32x16_bf16 v[128:143], a[224:227], v[92:95], v[128:143]
  ds_read_b128 a[248:251], v245 offset:12288
  v_exp_f32 v119, v119
  v_mul_f32 v125, v125, v117
  v_rcp_f32 v118, v118
  v_mfma_f32_32x32x16_bf16 v[128:143], a[228:231], v[96:99], v[128:143]
  ds_read_b128 a[252:255], v245 offset:13312
  v_cvt_pk_bf16_f32 v114, v124, v125
  v_fma_f32 v119, v119, v254, v254
  s_add_u32 s42, s50, 82944
  buffer_load_dwordx4 v[196:199], v246, s[4:7], s42 offen sc1
  s_waitcnt lgkmcnt(4)
  v_mfma_f32_32x32x16_bf16 v[128:143], a[232:235], v[100:103], v[128:143]
  ds_read_b128 a[224:227], v245 offset:14336
  v_mul_f32 v126, v126, v118
  v_rcp_f32 v119, v119
  s_nop 0
  v_mul_f32 v127, v127, v119
  v_cvt_pk_bf16_f32 v115, v126, v127
  v_mfma_f32_32x32x16_bf16 v[128:143], a[236:239], v[104:107], v[128:143]
  ds_read_b128 a[228:231], v245 offset:15360
  buffer_load_dwordx4 v[192:195], v242, s[4:7], s42 offen sc1
  s_waitcnt lgkmcnt(4)
  v_mfma_f32_32x32x16_bf16 v[128:143], a[240:243], v[108:111], v[128:143]
  ds_read_b128 a[232:235], v245 offset:16384
  buffer_store_dwordx4 v[112:115], v255, s[4:7], s47 offen offset:0 sc1
  v_mfma_f32_32x32x16_bf16 v[128:143], a[244:247], v[248:251], v[128:143]
  ds_read_b128 a[236:239], v245 offset:17408
  s_waitcnt lgkmcnt(4)
  v_mfma_f32_32x32x16_bf16 v[112:127], a[248:251], v[0:3], 0
  ds_read_b128 a[240:243], v245 offset:18432
  s_add_u32 s99, s49, 108544
  buffer_load_dwordx4 a[152:155], v234, s[4:7], s99 offen offset:0 sc1
  v_mfma_f32_32x32x16_bf16 v[112:127], a[252:255], v[4:7], v[112:127]
  ds_read_b128 a[244:247], v245 offset:19456
  s_add_u32 s42, s50, 2048
  buffer_load_dwordx4 v[204:207], v246, s[4:7], s42 offen sc1
  s_waitcnt lgkmcnt(4)
  v_mfma_f32_32x32x16_bf16 v[112:127], a[224:227], v[8:11], v[112:127]
  ds_read_b128 a[248:251], v255 offset:4096
  v_mul_f32 v136, v136, v128
  v_mul_f32 v128, v247, v128
  v_exp_f32 v128, v128
  v_mul_f32 v137, v137, v129
  v_mfma_f32_32x32x16_bf16 v[112:127], a[228:231], v[12:15], v[112:127]
  ds_read_b128 a[252:255], v255 offset:5120
  v_mul_f32 v129, v247, v129
  v_fma_f32 v128, v128, v254, v254
  v_exp_f32 v129, v129
  s_waitcnt lgkmcnt(4)
  v_mfma_f32_32x32x16_bf16 v[112:127], a[232:235], v[16:19], v[112:127]
  ds_read_b128 a[224:227], v255 offset:6144
  buffer_load_dwordx4 v[200:203], v242, s[4:7], s42 offen sc1
  v_rcp_f32 v128, v128
  v_mfma_f32_32x32x16_bf16 v[112:127], a[236:239], v[20:23], v[112:127]
  ds_read_b128 a[228:231], v255 offset:7168
  v_mul_f32 v138, v138, v130
  v_mul_f32 v130, v247, v130
  v_fma_f32 v129, v129, v254, v254
  s_waitcnt lgkmcnt(4)
  v_mfma_f32_32x32x16_bf16 v[112:127], a[240:243], v[24:27], v[112:127]
  ds_read_b128 a[232:235], v255 offset:32768
  v_exp_f32 v130, v130
  v_mul_f32 v136, v136, v128
  v_rcp_f32 v129, v129
  v_mfma_f32_32x32x16_bf16 v[112:127], a[244:247], v[28:31], v[112:127]
  ds_read_b128 a[236:239], v255 offset:33792
  s_add_u32 s42, s50, 34816
  buffer_load_dwordx4 v[212:215], v246, s[4:7], s42 offen sc1
  buffer_load_dwordx4 a[156:159], v234, s[4:7], s99 offen offset:1024 sc1
  s_waitcnt lgkmcnt(4)
  v_mfma_f32_32x32x16_bf16 v[112:127], a[248:251], v[32:35], v[112:127]
  ds_read_b128 a[240:243], v255 offset:34816
  v_mul_f32 v139, v139, v131
  v_mul_f32 v131, v247, v131
  v_fma_f32 v130, v130, v254, v254
  v_exp_f32 v131, v131
  v_mfma_f32_32x32x16_bf16 v[112:127], a[252:255], v[36:39], v[112:127]
  ds_read_b128 a[244:247], v255 offset:35840
  v_mul_f32 v137, v137, v129
  v_rcp_f32 v130, v130
  v_cvt_pk_bf16_f32 v128, v136, v137
  s_waitcnt lgkmcnt(4)
  v_mfma_f32_32x32x16_bf16 v[112:127], a[224:227], v[40:43], v[112:127]
  ds_read_b128 a[248:251], v255 offset:61440
  buffer_load_dwordx4 v[208:211], v242, s[4:7], s42 offen sc1
  v_mul_f32 v140, v140, v132
  v_mul_f32 v132, v247, v132
  v_mfma_f32_32x32x16_bf16 v[112:127], a[228:231], v[44:47], v[112:127]
  ds_read_b128 a[252:255], v255 offset:62464
  v_fma_f32 v131, v131, v254, v254
  v_exp_f32 v132, v132
  v_mul_f32 v138, v138, v130
  s_waitcnt lgkmcnt(4)
  v_mfma_f32_32x32x16_bf16 v[112:127], a[232:235], v[48:51], v[112:127]
  ds_read_b128 a[224:227], v255 offset:63488
  v_rcp_f32 v131, v131
  v_and_b32 v128, -2, v128
  v_mul_f32 v141, v141, v133
  v_mul_f32 v133, v247, v133
  v_mfma_f32_32x32x16_bf16 v[112:127], a[236:239], v[52:55], v[112:127]
  ds_read_b128 a[228:231], v255 offset:64512
  s_add_u32 s42, s50, 67584
  buffer_load_dwordx4 v[220:223], v246, s[4:7], s42 offen sc1
  s_waitcnt lgkmcnt(4)
  v_mfma_f32_32x32x16_bf16 v[112:127], a[240:243], v[56:59], v[112:127]
  ds_read_b128 a[232:235], v244 offset:24576
  s_add_u32 s99, s49, 174080
  buffer_load_dwordx4 a[160:163], v234, s[4:7], s99 offen offset:0 sc1
  v_fma_f32 v132, v132, v254, v254
  v_mfma_f32_32x32x16_bf16 v[112:127], a[244:247], v[60:63], v[112:127]
  ds_read_b128 a[236:239], v244 offset:25600
  v_exp_f32 v133, v133
  v_mul_f32 v139, v139, v131
  s_waitcnt lgkmcnt(4)
  v_mfma_f32_32x32x16_bf16 v[112:127], a[248:251], v[64:67], v[112:127]
  ds_read_b128 a[240:243], v244 offset:26624
  buffer_load_dwordx4 v[216:219], v242, s[4:7], s42 offen sc1
  v_rcp_f32 v132, v132
  v_mfma_f32_32x32x16_bf16 v[112:127], a[252:255], v[68:71], v[112:127]
  ds_read_b128 a[244:247], v244 offset:27648
  v_cvt_pk_bf16_f32 v129, v138, v139
  v_mul_f32 v142, v142, v134
  v_mul_f32 v134, v247, v134
  v_fma_f32 v133, v133, v254, v254
  s_waitcnt lgkmcnt(4)
  v_mfma_f32_32x32x16_bf16 v[112:127], a[224:227], v[72:75], v[112:127]
  ds_read_b128 a[248:251], v255 offset:8192
  v_exp_f32 v134, v134
  v_mul_f32 v140, v140, v132
  v_rcp_f32 v133, v133
  v_mfma_f32_32x32x16_bf16 v[112:127], a[228:231], v[76:79], v[112:127]
  ds_read_b128 a[252:255], v255 offset:9216
  s_add_u32 s42, s53, 2048
  buffer_load_dwordx4 v[228:231], v246, s[4:7], s42 offen sc1
  s_waitcnt lgkmcnt(4)
  v_mfma_f32_32x32x16_bf16 v[112:127], a[232:235], v[80:83], v[112:127]
  ds_read_b128 a[224:227], v255 offset:10240
  v_mul_f32 v143, v143, v135
  v_mul_f32 v135, v247, v135
  v_fma_f32 v134, v134, v254, v254
  v_exp_f32 v135, v135
  v_mfma_f32_32x32x16_bf16 v[112:127], a[236:239], v[84:87], v[112:127]
  ds_read_b128 a[228:231], v255 offset:11264
  buffer_load_dwordx4 a[164:167], v234, s[4:7], s99 offen offset:1024 sc1
  v_mul_f32 v141, v141, v133
  s_waitcnt lgkmcnt(4)
  v_mfma_f32_32x32x16_bf16 v[112:127], a[240:243], v[88:91], v[112:127]
  ds_read_b64 a[232:233], v255 offset:3072
  buffer_load_dwordx4 v[224:227], v242, s[4:7], s42 offen sc1
  v_rcp_f32 v134, v134
  v_mfma_f32_32x32x16_bf16 v[112:127], a[244:247], v[92:95], v[112:127]
  ds_read_b128 a[236:239], v255 offset:36864
  v_cvt_pk_bf16_f32 v130, v140, v141
  v_fma_f32 v135, v135, v254, v254
  v_mul_f32 v142, v142, v134
  s_waitcnt lgkmcnt(4)
  v_mfma_f32_32x32x16_bf16 v[112:127], a[248:251], v[96:99], v[112:127]
  ds_read_b128 a[240:243], v255 offset:37888
  v_rcp_f32 v135, v135
  s_nop 0
  v_mul_f32 v143, v143, v135
  v_cvt_pk_bf16_f32 v131, v142, v143
  v_mfma_f32_32x32x16_bf16 v[112:127], a[252:255], v[100:103], v[112:127]
  ds_read_b128 a[244:247], v255 offset:38912
  s_add_u32 s99, s49, 12288
  buffer_load_dwordx4 a[168:171], v234, s[4:7], s99 offen offset:0 sc1
  s_waitcnt lgkmcnt(4)
  v_mfma_f32_32x32x16_bf16 v[112:127], a[224:227], v[104:107], v[112:127]
  ds_read_b128 a[248:251], v255 offset:39936
  v_mfma_f32_32x32x16_bf16 v[112:127], a[228:231], v[108:111], v[112:127]
  ds_read_b128 a[252:255], v244 offset:0
  buffer_store_dwordx4 v[128:131], v255, s[4:7], s47 offen offset:1024 sc1
  s_waitcnt lgkmcnt(4)
  v_mfma_f32_32x32x16_bf16 v[112:127], a[232:235], v[248:251], v[112:127]
  ds_read_b128 a[224:227], v244 offset:1024
  v_mfma_f32_32x32x16_bf16 v[128:143], a[236:239], v[0:3], 0
  ds_read_b128 a[228:231], v244 offset:2048
  s_waitcnt lgkmcnt(4)
  v_mfma_f32_32x32x16_bf16 v[128:143], a[240:243], v[4:7], v[128:143]
  ds_read_b128 a[232:235], v244 offset:3072
  v_mul_f32 v120, v120, v112
  v_mul_f32 v112, v247, v112
  v_exp_f32 v112, v112
  v_mul_f32 v121, v121, v113
  v_mfma_f32_32x32x16_bf16 v[128:143], a[244:247], v[8:11], v[128:143]
  ds_read_b128 a[236:239], v244 offset:28672
  buffer_load_dwordx4 a[172:175], v234, s[4:7], s99 offen offset:1024 sc1
  v_mul_f32 v113, v247, v113
  s_waitcnt lgkmcnt(4)
  v_mfma_f32_32x32x16_bf16 v[128:143], a[248:251], v[12:15], v[128:143]
  ds_read_b128 a[240:243], v244 offset:29696
  v_fma_f32 v112, v112, v254, v254
  v_exp_f32 v113, v113
  v_rcp_f32 v112, v112
  v_mfma_f32_32x32x16_bf16 v[128:143], a[252:255], v[16:19], v[128:143]
  ds_read_b128 a[244:247], v244 offset:30720
  v_mul_f32 v122, v122, v114
  v_mul_f32 v114, v247, v114
  v_fma_f32 v113, v113, v254, v254
  s_waitcnt lgkmcnt(4)
  v_mfma_f32_32x32x16_bf16 v[128:143], a[224:227], v[20:23], v[128:143]
  ds_read_b128 a[248:251], v244 offset:31744
  v_exp_f32 v114, v114
  v_mul_f32 v120, v120, v112
  v_rcp_f32 v113, v113
  v_mfma_f32_32x32x16_bf16 v[128:143], a[228:231], v[24:27], v[128:143]
  ds_read_b128 a[252:255], v255 offset:12288
  v_mul_f32 v123, v123, v115
  v_mul_f32 v115, v247, v115
  v_fma_f32 v114, v114, v254, v254
  s_waitcnt lgkmcnt(4)
  v_mfma_f32_32x32x16_bf16 v[128:143], a[232:235], v[28:31], v[128:143]
  ds_read_b128 a[224:227], v255 offset:13312
  v_exp_f32 v115, v115
  v_mul_f32 v121, v121, v113
  v_rcp_f32 v114, v114
  v_mfma_f32_32x32x16_bf16 v[128:143], a[236:239], v[32:35], v[128:143]
  ds_read_b128 a[228:231], v255 offset:14336
  v_cvt_pk_bf16_f32 v112, v120, v121
  v_mul_f32 v124, v124, v116
  v_mul_f32 v116, v247, v116
  v_fma_f32 v115, v115, v254, v254
  s_waitcnt lgkmcnt(4)
  v_mfma_f32_32x32x16_bf16 v[128:143], a[240:243], v[36:39], v[128:143]
  ds_read_b128 a[232:235], v255 offset:15360
  s_add_u32 s99, s49, 77824
  buffer_load_dwordx4 a[176:179], v234, s[4:7], s99 offen offset:0 sc1
  v_mfma_f32_32x32x16_bf16 v[128:143], a[244:247], v[40:43], v[128:143]
  ds_read_b128 a[236:239], v255 offset:40960
  s_add_u32 s42, s50, 19456
  buffer_load_dwordx4 v[36:39], v246, s[4:7], s42 offen sc1
  s_waitcnt lgkmcnt(4)
  v_mfma_f32_32x32x16_bf16 v[128:143], a[248:251], v[44:47], v[128:143]
  ds_read_b128 a[240:243], v255 offset:41984
  buffer_load_dwordx4 v[32:35], v242, s[4:7], s42 offen sc1
  v_exp_f32 v116, v116
  v_mfma_f32_32x32x16_bf16 v[128:143], a[252:255], v[48:51], v[128:143]
  ds_read_b128 a[244:247], v255 offset:43008
  v_mul_f32 v122, v122, v114
  v_rcp_f32 v115, v115
  v_and_b32 v112, -2, v112
  s_waitcnt lgkmcnt(4)
  v_mfma_f32_32x32x16_bf16 v[128:143], a[224:227], v[52:55], v[128:143]
  ds_read_b128 a[248:251], v255 offset:44032
  s_add_u32 s42, s50, 52224
  buffer_load_dwordx4 v[44:47], v246, s[4:7], s42 offen sc1
  v_mul_f32 v125, v125, v117
  v_mfma_f32_32x32x16_bf16 v[128:143], a[228:231], v[56:59], v[128:143]
  ds_read_b128 a[252:255], v244 offset:4096
  v_mul_f32 v117, v247, v117
  v_fma_f32 v116, v116, v254, v254
  v_exp_f32 v117, v117
  s_waitcnt lgkmcnt(4)
  v_mfma_f32_32x32x16_bf16 v[128:143], a[232:235], v[60:63], v[128:143]
  ds_read_b128 a[224:227], v244 offset:5120
  buffer_load_dwordx4 v[40:43], v242, s[4:7], s42 offen sc1
  v_mul_f32 v123, v123, v115
  v_mfma_f32_32x32x16_bf16 v[128:143], a[236:239], v[64:67], v[128:143]
  ds_read_b128 a[228:231], v244 offset:6144
  v_rcp_f32 v116, v116
  v_cvt_pk_bf16_f32 v113, v122, v123
  v_mul_f32 v126, v126, v118
  s_waitcnt lgkmcnt(4)
  v_mfma_f32_32x32x16_bf16 v[128:143], a[240:243], v[68:71], v[128:143]
  ds_read_b128 a[232:235], v244 offset:7168
  s_add_u32 s42, s50, 84992
  buffer_load_dwordx4 v[52:55], v246, s[4:7], s42 offen sc1
  v_mul_f32 v118, v247, v118
  v_mfma_f32_32x32x16_bf16 v[128:143], a[244:247], v[72:75], v[128:143]
  ds_read_b128 a[236:239], v244 offset:32768
  v_fma_f32 v117, v117, v254, v254
  v_exp_f32 v118, v118
  v_mul_f32 v124, v124, v116
  s_waitcnt lgkmcnt(4)
  v_mfma_f32_32x32x16_bf16 v[128:143], a[248:251], v[76:79], v[128:143]
  ds_read_b128 a[240:243], v244 offset:33792
  buffer_load_dwordx4 a[180:183], v234, s[4:7], s99 offen offset:1024 sc1
  v_rcp_f32 v117, v117
  v_mfma_f32_32x32x16_bf16 v[128:143], a[252:255], v[80:83], v[128:143]
  ds_read_b128 a[244:247], v244 offset:34816
  v_mul_f32 v127, v127, v119
  v_mul_f32 v119, v247, v119
  v_fma_f32 v118, v118, v254, v254
  s_waitcnt lgkmcnt(4)
  v_mfma_f32_32x32x16_bf16 v[128:143], a[224:227], v[84:87], v[128:143]
  ds_read_b128 a[248:251], v244 offset:35840
  buffer_load_dwordx4 v[48:51], v242, s[4:7], s42 offen sc1
  v_exp_f32 v119, v119
  v_mfma_f32_32x32x16_bf16 v[128:143], a[228:231], v[88:91], v[128:143]
  ds_read_b64 a[252:253], v255 offset:3080
  v_mul_f32 v125, v125, v117
  v_rcp_f32 v118, v118
  v_cvt_pk_bf16_f32 v114, v124, v125
  s_waitcnt lgkmcnt(4)
  v_mfma_f32_32x32x16_bf16 v[128:143], a[232:235], v[92:95], v[128:143]
  s_add_u32 s42, s50, 4096
  buffer_load_dwordx4 v[60:63], v246, s[4:7], s42 offen sc1
  v_fma_f32 v119, v119, v254, v254
  v_mul_f32 v126, v126, v118
  v_mfma_f32_32x32x16_bf16 v[128:143], a[236:239], v[96:99], v[128:143]
  v_rcp_f32 v119, v119
  s_nop 0
  v_mul_f32 v127, v127, v119
  v_cvt_pk_bf16_f32 v115, v126, v127
  s_waitcnt lgkmcnt(2)
  v_mfma_f32_32x32x16_bf16 v[128:143], a[240:243], v[100:103], v[128:143]
  buffer_load_dwordx4 v[56:59], v242, s[4:7], s42 offen sc1
  s_waitcnt vmcnt(43)
  v_bitop3_b32 v235, v148, v144, v156 bitop3:0xfe
  s_waitcnt vmcnt(39)
  v_bitop3_b32 v235, v152, v164, v235 bitop3:0xfe
  s_waitcnt vmcnt(37)
  v_bitop3_b32 v235, v160, v235, 1 bitop3:0xa8
  v_mfma_f32_32x32x16_bf16 v[128:143], a[244:247], v[104:107], v[128:143]
  v_cmp_ne_u32 vcc, 0, v235
  s_waitcnt lgkmcnt(0)
  v_mfma_f32_32x32x16_bf16 v[128:143], a[248:251], v[108:111], v[128:143]
  buffer_store_dwordx4 v[112:115], v255, s[4:7], s47 offen offset:2048 sc1
  s_add_u32 s42, s50, 36864
  buffer_load_dwordx4 v[68:71], v246, s[4:7], s42 offen sc1
  v_mfma_f32_32x32x16_bf16 v[128:143], a[252:255], v[248:251], v[128:143]
  s_cbranch_vccnz SLOW_31
BACK_32:
  v_mfma_f32_32x32x16_bf16 a[224:239], a[0:3], v[148:151], 0
  buffer_load_dwordx4 v[64:67], v242, s[4:7], s42 offen sc1
  v_mfma_f32_32x32x16_bf16 a[240:255], a[4:7], v[148:151], 0
  v_mul_f32 v136, v136, v128
  v_mul_f32 v128, v247, v128
  v_exp_f32 v128, v128
  v_mul_f32 v137, v137, v129
  v_mul_f32 v129, v247, v129
  v_mfma_f32_32x32x16_bf16 v[0:15], a[0:3], v[144:147], 0
  s_add_u32 s42, s50, 69632
  buffer_load_dwordx4 v[76:79], v246, s[4:7], s42 offen sc1
  v_fma_f32 v128, v128, v254, v254
  v_mfma_f32_32x32x16_bf16 v[16:31], a[4:7], v[144:147], 0
  v_exp_f32 v129, v129
  v_rcp_f32 v128, v128
  v_mul_f32 v138, v138, v130
  v_mul_f32 v130, v247, v130
  v_mfma_f32_32x32x16_bf16 a[224:239], a[8:11], v[156:159], a[224:239]
  buffer_load_dwordx4 v[72:75], v242, s[4:7], s42 offen sc1
  v_fma_f32 v129, v129, v254, v254
  v_exp_f32 v130, v130
  v_mfma_f32_32x32x16_bf16 a[240:255], a[12:15], v[156:159], a[240:255]
  v_mul_f32 v136, v136, v128
  v_rcp_f32 v129, v129
  v_mul_f32 v139, v139, v131
  v_mul_f32 v131, v247, v131
  v_fma_f32 v130, v130, v254, v254
  v_mfma_f32_32x32x16_bf16 v[0:15], a[8:11], v[152:155], v[0:15]
  v_exp_f32 v131, v131
  v_mul_f32 v137, v137, v129
  v_rcp_f32 v130, v130
  v_cvt_pk_bf16_f32 v128, v136, v137
  v_mfma_f32_32x32x16_bf16 v[16:31], a[12:15], v[152:155], v[16:31]
  v_mul_f32 v140, v140, v132
  v_mul_f32 v132, v247, v132
  v_fma_f32 v131, v131, v254, v254
  v_exp_f32 v132, v132
  v_mul_f32 v138, v138, v130
  v_mfma_f32_32x32x16_bf16 a[224:239], a[16:19], v[164:167], a[224:239]
  s_waitcnt vmcnt(38)
  v_bitop3_b32 v235, v172, v168, v180 bitop3:0xfe
  v_rcp_f32 v131, v131
  v_and_b32 v128, -2, v128
  v_mul_f32 v141, v141, v133
  v_mul_f32 v133, v247, v133
  v_mfma_f32_32x32x16_bf16 a[240:255], a[20:23], v[164:167], a[240:255]
  v_fma_f32 v132, v132, v254, v254
  s_waitcnt vmcnt(35)
  v_bitop3_b32 v235, v176, v188, v235 bitop3:0xfe
  s_waitcnt vmcnt(32)
  v_bitop3_b32 v235, v184, v196, v235 bitop3:0xfe
  s_waitcnt vmcnt(31)
  v_bitop3_b32 v235, v192, v235, 1 bitop3:0xa8
  v_cmp_ne_u32 vcc, 0, v235
  v_mfma_f32_32x32x16_bf16 v[0:15], a[16:19], v[160:163], v[0:15]
  v_exp_f32 v133, v133
  v_mul_f32 v139, v139, v131
  v_rcp_f32 v132, v132
  v_cvt_pk_bf16_f32 v129, v138, v139
  v_mfma_f32_32x32x16_bf16 v[16:31], a[20:23], v[160:163], v[16:31]
  s_cbranch_vccnz SLOW_33
BACK_34:
  v_mul_f32 v142, v142, v134
  v_mul_f32 v134, v247, v134
  v_fma_f32 v133, v133, v254, v254
  v_exp_f32 v134, v134
  v_mfma_f32_32x32x16_bf16 a[224:239], a[24:27], v[172:175], a[224:239]
  v_mul_f32 v140, v140, v132
  s_add_u32 s99, s49, 143360
  buffer_load_dwordx4 a[184:187], v234, s[4:7], s99 offen offset:0 sc1
  s_branch L_over5
L_pad5:
  s_branch L_ret_F
L_over5:
  v_mfma_f32_32x32x16_bf16 a[240:255], a[28:31], v[172:175], a[240:255]
  v_rcp_f32 v133, v133
  v_mul_f32 v143, v143, v135
  v_mul_f32 v135, v247, v135
  v_fma_f32 v134, v134, v254, v254
  v_mfma_f32_32x32x16_bf16 v[0:15], a[24:27], v[168:171], v[0:15]
  v_exp_f32 v135, v135
  v_mul_f32 v141, v141, v133
  v_rcp_f32 v134, v134
  v_cvt_pk_bf16_f32 v130, v140, v141
  v_fma_f32 v135, v135, v254, v254
  v_mfma_f32_32x32x16_bf16 v[16:31], a[28:31], v[168:171], v[16:31]
  v_mul_f32 v142, v142, v134
  v_rcp_f32 v135, v135
  s_nop 0
  v_mul_f32 v143, v143, v135
  v_cvt_pk_bf16_f32 v131, v142, v143
  buffer_load_dwordx4 a[188:191], v234, s[4:7], s99 offen offset:1024 sc1
  v_mfma_f32_32x32x16_bf16 a[224:239], a[32:35], v[180:183], a[224:239]
  buffer_store_dwordx4 v[128:131], v255, s[4:7], s47 offen offset:3072 sc1
  v_mfma_f32_32x32x16_bf16 a[240:255], a[36:39], v[180:183], a[240:255]
  s_add_u32 s99, s52, 12288
  buffer_load_dwordx4 a[192:195], v234, s[4:7], s99 offen offset:0 sc1
  v_mfma_f32_32x32x16_bf16 v[0:15], a[32:35], v[176:179], v[0:15]
  v_mfma_f32_32x32x16_bf16 v[16:31], a[36:39], v[176:179], v[16:31]
  s_add_u32 s42, s53, 4096
  buffer_load_dwordx4 v[84:87], v246, s[4:7], s42 offen sc1
  v_mfma_f32_32x32x16_bf16 a[224:239], a[40:43], v[188:191], a[224:239]
  s_barrier
  v_mfma_f32_32x32x16_bf16 a[240:255], a[44:47], v[188:191], a[240:255]
  buffer_load_dwordx4 v[80:83], v242, s[4:7], s42 offen sc1
  v_mfma_f32_32x32x16_bf16 v[0:15], a[40:43], v[184:187], v[0:15]
  buffer_load_dwordx4 a[196:199], v234, s[4:7], s99 offen offset:1024 sc1
  v_mfma_f32_32x32x16_bf16 v[16:31], a[44:47], v[184:187], v[16:31]
  s_add_u32 s42, s50, 21504
  buffer_load_dwordx4 v[92:95], v246, s[4:7], s42 offen sc1
  v_mfma_f32_32x32x16_bf16 a[224:239], a[48:51], v[196:199], a[224:239]
  s_waitcnt vmcnt(34)
  v_bitop3_b32 v235, v204, v200, v212 bitop3:0xfe
  s_waitcnt vmcnt(31)
  v_bitop3_b32 v235, v208, v220, v235 bitop3:0xfe
  s_waitcnt vmcnt(29)
  v_bitop3_b32 v235, v216, v235, 1 bitop3:0xa8
  v_cmp_ne_u32 vcc, 0, v235
  v_mfma_f32_32x32x16_bf16 a[240:255], a[52:55], v[196:199], a[240:255]
  buffer_load_dwordx4 v[88:91], v242, s[4:7], s42 offen sc1
  v_mfma_f32_32x32x16_bf16 v[0:15], a[48:51], v[192:195], v[0:15]
  s_add_u32 s99, s49, 47104
  buffer_load_dwordx4 a[200:203], v234, s[4:7], s99 offen offset:0 sc1
  v_mfma_f32_32x32x16_bf16 v[16:31], a[52:55], v[192:195], v[16:31]
  s_add_u32 s42, s50, 54272
  buffer_load_dwordx4 v[100:103], v246, s[4:7], s42 offen sc1
  s_cbranch_vccnz SLOW_35
BACK_36:
  v_mfma_f32_32x32x16_bf16 a[224:239], a[56:59], v[204:207], a[224:239]
  v_mfma_f32_32x32x16_bf16 a[240:255], a[60:63], v[204:207], a[240:255]
  buffer_load_dwordx4 v[96:99], v242, s[4:7], s42 offen sc1
  v_mfma_f32_32x32x16_bf16 v[0:15], a[56:59], v[200:203], v[0:15]
  buffer_load_dwordx4 a[204:207], v234, s[4:7], s99 offen offset:1024 sc1
  ds_read_b128 v[168:171], v243
  ds_read_b128 v[172:175], v243 offset:2048
  v_mfma_f32_32x32x16_bf16 v[16:31], a[60:63], v[200:203], v[16:31]
  s_add_u32 s42, s50, 87040
  buffer_load_dwordx4 v[108:111], v246, s[4:7], s42 offen sc1
  v_mfma_f32_32x32x16_bf16 a[224:239], a[64:67], v[212:215], a[224:239]
  v_mfma_f32_32x32x16_bf16 a[240:255], a[68:71], v[212:215], a[240:255]
  buffer_load_dwordx4 v[104:107], v242, s[4:7], s42 offen sc1
  s_add_u32 s99, s49, 112640
  buffer_load_dwordx4 a[208:211], v234, s[4:7], s99 offen offset:0 sc1
  v_mfma_f32_32x32x16_bf16 v[0:15], a[64:67], v[208:211], v[0:15]
  v_mfma_f32_32x32x16_bf16 v[16:31], a[68:71], v[208:211], v[16:31]
  v_mfma_f32_32x32x16_bf16 a[224:239], a[72:75], v[220:223], a[224:239]
  s_waitcnt vmcnt(29)
  v_bitop3_b32 v235, v228, v224, v36 bitop3:0xfe
  s_waitcnt vmcnt(27)
  v_bitop3_b32 v235, v32, v44, v235 bitop3:0xfe
  s_waitcnt vmcnt(25)
  v_bitop3_b32 v235, v40, v52, v235 bitop3:0xfe
  s_waitcnt vmcnt(23)
  v_bitop3_b32 v235, v48, v235, 1 bitop3:0xa8
  v_cmp_ne_u32 vcc, 0, v235
  s_waitcnt lgkmcnt(1)
  v_lshlrev_b32 v176, 16, v168
  v_mfma_f32_32x32x16_bf16 a[240:255], a[76:79], v[220:223], a[240:255]
  buffer_load_dwordx4 a[212:215], v234, s[4:7], s99 offen offset:1024 sc1
  v_and_b32 v177, s82, v168
  v_lshlrev_b32 v178, 16, v169
  v_and_b32 v179, s82, v169
  v_mfma_f32_32x32x16_bf16 v[0:15], a[72:75], v[216:219], v[0:15]
  v_lshlrev_b32 v180, 16, v170
  v_and_b32 v181, s82, v170
  v_lshlrev_b32 v182, 16, v171
  v_and_b32 v183, s82, v171
  s_waitcnt lgkmcnt(0)
  v_lshlrev_b32 v184, 16, v172
  v_and_b32 v185, s82, v172
  v_mfma_f32_32x32x16_bf16 v[16:31], a[76:79], v[216:219], v[16:31]
  s_cbranch_vccnz SLOW_37
BACK_38:
  v_lshlrev_b32 v186, 16, v173
  v_and_b32 v187, s82, v173
  v_lshlrev_b32 v188, 16, v174
  v_and_b32 v189, s82, v174
  v_lshlrev_b32 v190, 16, v175
  v_mfma_f32_32x32x16_bf16 a[224:239], a[80:83], v[228:231], a[224:239]
  s_add_u32 s99, s49, 178176
  buffer_load_dwordx4 a[216:219], v234, s[4:7], s99 offen offset:0 sc1
  v_and_b32 v191, s82, v175
  v_mfma_f32_32x32x16_bf16 a[240:255], a[84:87], v[228:231], a[240:255]
  s_xor_b32 s40, s64, 1
  s_mul_i32 s40, s40, 28672
  v_add_u32 v208, s40, v255
  s_xor_b32 s40, s64, 3
  s_mul_i32 s40, s40, 28672
  v_add_u32 v210, s40, v255
  v_mfma_f32_32x32x16_bf16 v[0:15], a[80:83], v[224:227], v[0:15]
  s_xor_b32 s40, s64, 2
  s_mul_i32 s40, s40, 28672
  v_add_u32 v209, s40, v255
  v_add_u32 v211, s85, v255
  v_mfma_f32_32x32x16_bf16 v[16:31], a[84:87], v[224:227], v[16:31]
  v_mfma_f32_32x32x16_bf16 a[224:239], a[88:91], v[36:39], a[224:239]
  buffer_load_dwordx4 a[220:223], v234, s[4:7], s99 offen offset:1024 sc1
  v_mfma_f32_32x32x16_bf16 a[240:255], a[92:95], v[36:39], a[240:255]
  v_mfma_f32_32x32x16_bf16 v[0:15], a[88:91], v[32:35], v[0:15]
  v_mfma_f32_32x32x16_bf16 v[16:31], a[92:95], v[32:35], v[16:31]
  v_mfma_f32_32x32x16_bf16 a[224:239], a[96:99], v[44:47], a[224:239]
  s_add_u32 s42, s50, 6144
  buffer_load_dwordx4 v[116:119], v246, s[4:7], s42 offen sc1
  v_mfma_f32_32x32x16_bf16 a[240:255], a[100:103], v[44:47], a[240:255]
  v_mfma_f32_32x32x16_bf16 v[0:15], a[96:99], v[40:43], v[0:15]
  buffer_load_dwordx4 v[112:115], v242, s[4:7], s42 offen sc1
  v_mfma_f32_32x32x16_bf16 v[16:31], a[100:103], v[40:43], v[16:31]
  v_mfma_f32_32x32x16_bf16 a[224:239], a[104:107], v[52:55], a[224:239]
  s_add_u32 s42, s50, 38912
  buffer_load_dwordx4 v[124:127], v246, s[4:7], s42 offen sc1
  s_waitcnt vmcnt(25)
  v_bitop3_b32 v235, v60, v56, v68 bitop3:0xfe
  s_waitcnt vmcnt(23)
  v_bitop3_b32 v235, v64, v76, v235 bitop3:0xfe
  v_mfma_f32_32x32x16_bf16 a[240:255], a[108:111], v[52:55], a[240:255]
  s_waitcnt vmcnt(22)
  v_bitop3_b32 v235, v72, v235, 1 bitop3:0xa8
  v_cmp_ne_u32 vcc, 0, v235
  v_mfma_f32_32x32x16_bf16 v[0:15], a[104:107], v[48:51], v[0:15]
  buffer_load_dwordx4 v[120:123], v242, s[4:7], s42 offen sc1
  v_mfma_f32_32x32x16_bf16 v[16:31], a[108:111], v[48:51], v[16:31]
  s_nop 1
  s_cbranch_vccnz SLOW_39
BACK_40:
  v_mfma_f32_32x32x16_bf16 a[224:239], a[112:115], v[60:63], a[224:239]
  s_add_u32 s42, s50, 71680
  buffer_load_dwordx4 v[132:135], v246, s[4:7], s42 offen sc1
  v_mfma_f32_32x32x16_bf16 a[240:255], a[116:119], v[60:63], a[240:255]
  v_mfma_f32_32x32x16_bf16 v[0:15], a[112:115], v[56:59], v[0:15]
  buffer_load_dwordx4 v[128:131], v242, s[4:7], s42 offen sc1
  v_mfma_f32_32x32x16_bf16 v[16:31], a[116:119], v[56:59], v[16:31]
  v_mfma_f32_32x32x16_bf16 a[224:239], a[120:123], v[68:71], a[224:239]
  v_mfma_f32_32x32x16_bf16 a[240:255], a[124:127], v[68:71], a[240:255]
  v_mfma_f32_32x32x16_bf16 v[0:15], a[120:123], v[64:67], v[0:15]
  v_mfma_f32_32x32x16_bf16 v[16:31], a[124:127], v[64:67], v[16:31]
  v_mfma_f32_32x32x16_bf16 a[224:239], a[128:131], v[76:79], a[224:239]
  s_waitcnt vmcnt(17)
  v_bitop3_b32 v235, v84, v80, v92 bitop3:0xfe
  s_waitcnt vmcnt(14)
  v_bitop3_b32 v235, v88, v100, v235 bitop3:0xfe
  s_waitcnt vmcnt(11)
  v_bitop3_b32 v235, v96, v108, v235 bitop3:0xfe
  s_waitcnt vmcnt(10)
  v_bitop3_b32 v235, v104, v235, 1 bitop3:0xa8
  v_cmp_ne_u32 vcc, 0, v235
  v_mfma_f32_32x32x16_bf16 a[240:255], a[132:135], v[76:79], a[240:255]
  v_mfma_f32_32x32x16_bf16 v[0:15], a[128:131], v[72:75], v[0:15]
  s_add_u32 s42, s53, 6144
  buffer_load_dwordx4 v[140:143], v246, s[4:7], s42 offen sc1
  v_mfma_f32_32x32x16_bf16 v[16:31], a[132:135], v[72:75], v[16:31]
  s_cbranch_vccnz SLOW_41
BACK_42:
  s_add_u32 s42, s50, 23552
  buffer_load_dwordx4 v[148:151], v246, s[4:7], s42 offen sc1
  v_mfma_f32_32x32x16_bf16 a[224:239], a[136:139], v[84:87], a[224:239]
  s_add_u32 s42, s50, 56320
  buffer_load_dwordx4 v[156:159], v246, s[4:7], s42 offen sc1
  v_mfma_f32_32x32x16_bf16 a[240:255], a[140:143], v[84:87], a[240:255]
  v_mfma_f32_32x32x16_bf16 v[0:15], a[136:139], v[80:83], v[0:15]
  s_add_u32 s42, s50, 89088
  buffer_load_dwordx4 v[164:167], v246, s[4:7], s42 offen sc1
  v_mfma_f32_32x32x16_bf16 v[16:31], a[140:143], v[80:83], v[16:31]
  v_mfma_f32_32x32x16_bf16 a[224:239], a[144:147], v[92:95], a[224:239]
  s_add_u32 s42, s53, 6144
  buffer_load_dwordx4 v[136:139], v242, s[4:7], s42 offen sc1
  v_mfma_f32_32x32x16_bf16 a[240:255], a[148:151], v[92:95], a[240:255]
  v_mfma_f32_32x32x16_bf16 v[0:15], a[144:147], v[88:91], v[0:15]
  s_add_u32 s42, s50, 23552
  buffer_load_dwordx4 v[144:147], v242, s[4:7], s42 offen sc1
  v_mfma_f32_32x32x16_bf16 v[16:31], a[148:151], v[88:91], v[16:31]
  v_mfma_f32_32x32x16_bf16 a[224:239], a[152:155], v[100:103], a[224:239]
  s_add_u32 s42, s50, 56320
  buffer_load_dwordx4 v[152:155], v242, s[4:7], s42 offen sc1
  v_mfma_f32_32x32x16_bf16 a[240:255], a[156:159], v[100:103], a[240:255]
  v_mfma_f32_32x32x16_bf16 v[0:15], a[152:155], v[96:99], v[0:15]
  s_add_u32 s42, s50, 89088
  buffer_load_dwordx4 v[160:163], v242, s[4:7], s42 offen sc1
  v_mfma_f32_32x32x16_bf16 v[16:31], a[156:159], v[96:99], v[16:31]
  v_mfma_f32_32x32x16_bf16 a[224:239], a[160:163], v[108:111], a[224:239]
  s_waitcnt vmcnt(11)
  v_bitop3_b32 v235, v116, v112, v124 bitop3:0xfe
  s_waitcnt vmcnt(9)
  v_bitop3_b32 v235, v120, v132, v235 bitop3:0xfe
  s_waitcnt vmcnt(8)
  v_bitop3_b32 v235, v128, v235, 1 bitop3:0xa8
  v_cmp_ne_u32 vcc, 0, v235
  v_mfma_f32_32x32x16_bf16 a[240:255], a[164:167], v[108:111], a[240:255]
  v_mfma_f32_32x32x16_bf16 v[0:15], a[160:163], v[104:107], v[0:15]
  s_add_u32 m0, s33, 0
  s_add_u32 s43, s32, 0
  buffer_load_dwordx4 v255, s[4:7], s43 offen offset:0 sc1 lds
  v_mfma_f32_32x32x16_bf16 v[16:31], a[164:167], v[104:107], v[16:31]
  s_cbranch_vccnz SLOW_43
BACK_44:
  v_mfma_f32_32x32x16_bf16 a[224:239], a[168:171], v[116:119], a[224:239]
  buffer_load_dwordx4 v255, s[4:7], s43 offen offset:1024 sc1 lds
  v_mfma_f32_32x32x16_bf16 a[240:255], a[172:175], v[116:119], a[240:255]
  v_mfma_f32_32x32x16_bf16 v[0:15], a[168:171], v[112:115], v[0:15]
  buffer_load_dwordx4 v255, s[4:7], s43 offen offset:2048 sc1 lds
  v_mfma_f32_32x32x16_bf16 v[16:31], a[172:175], v[112:115], v[16:31]
  v_mfma_f32_32x32x16_bf16 a[224:239], a[176:179], v[124:127], a[224:239]
  buffer_load_dwordx4 v255, s[4:7], s43 offen offset:3072 sc1 lds
  v_mfma_f32_32x32x16_bf16 a[240:255], a[180:183], v[124:127], a[240:255]
  v_mfma_f32_32x32x16_bf16 v[0:15], a[176:179], v[120:123], v[0:15]
  v_mfma_f32_32x32x16_bf16 v[16:31], a[180:183], v[120:123], v[16:31]
  s_add_u32 m0, s33, 16384
  s_add_u32 s43, s32, 16384
  buffer_load_dwordx4 v255, s[4:7], s43 offen offset:0 sc1 lds
  v_mfma_f32_32x32x16_bf16 a[224:239], a[184:187], v[132:135], a[224:239]
  s_waitcnt vmcnt(10)
  v_bitop3_b32 v235, v140, v148, v156 bitop3:0xfe
  s_waitcnt vmcnt(9)
  v_bitop3_b32 v235, v164, v235, 1 bitop3:0xa8
  v_cmp_ne_u32 vcc, 0, v235
  v_mfma_f32_32x32x16_bf16 a[240:255], a[188:191], v[132:135], a[240:255]
  buffer_load_dwordx4 v255, s[4:7], s43 offen offset:1024 sc1 lds
  v_mfma_f32_32x32x16_bf16 v[0:15], a[184:187], v[128:131], v[0:15]
  v_mfma_f32_32x32x16_bf16 v[16:31], a[188:191], v[128:131], v[16:31]
  s_nop 0
  s_cbranch_vccnz SLOW_45
BACK_46:
  buffer_load_dwordx4 v255, s[4:7], s43 offen offset:2048 sc1 lds
  v_mfma_f32_32x32x16_bf16 a[224:239], a[192:195], v[140:143], a[224:239]
  v_mfma_f32_32x32x16_bf16 a[240:255], a[196:199], v[140:143], a[240:255]
  buffer_load_dwordx4 v255, s[4:7], s43 offen offset:3072 sc1 lds
  v_add_f32 v0, v0, v176
  v_add_f32 v1, v1, v177
  v_add_f32 v2, v2, v178
  v_mfma_f32_32x32x16_bf16 a[224:239], a[200:203], v[148:151], a[224:239]
  v_add_f32 v3, v3, v179
  v_add_f32 v4, v4, v180
  v_add_f32 v5, v5, v181
  v_add_f32 v6, v6, v182
  v_add_f32 v7, v7, v183
  v_add_f32 v16, v16, v184
  v_mfma_f32_32x32x16_bf16 a[240:255], a[204:207], v[148:151], a[240:255]
  v_add_f32 v17, v17, v185
  v_add_f32 v18, v18, v186
  v_add_f32 v19, v19, v187
  v_add_f32 v20, v20, v188
  v_add_f32 v21, v21, v189
  v_add_f32 v22, v22, v190
  v_mfma_f32_32x32x16_bf16 a[224:239], a[208:211], v[156:159], a[224:239]
  s_waitcnt vmcnt(9)
  v_bitop3_b32 v235, v136, v144, v152 bitop3:0xfe
  s_waitcnt vmcnt(8)
  v_bitop3_b32 v235, v160, v235, 1 bitop3:0xa8
  v_cmp_ne_u32 vcc, 0, v235
  v_add_f32 v23, v23, v191
  v_mfma_f32_32x32x16_bf16 a[240:255], a[212:215], v[156:159], a[240:255]
  v_mfma_f32_32x32x16_bf16 a[224:239], a[216:219], v[164:167], a[224:239]
  v_mfma_f32_32x32x16_bf16 a[240:255], a[220:223], v[164:167], a[240:255]
  s_nop 0
  s_cbranch_vccnz SLOW_47
BACK_48:
  v_mfma_f32_32x32x16_bf16 v[0:15], a[192:195], v[136:139], v[0:15]
  v_mfma_f32_32x32x16_bf16 v[16:31], a[196:199], v[136:139], v[16:31]
  ds_write_b128 v208, a[224:227] offset:4096
  ds_write_b128 v208, a[228:231] offset:5120
  ds_write_b128 v208, a[240:243] offset:6144
  v_mfma_f32_32x32x16_bf16 v[0:15], a[200:203], v[144:147], v[0:15]
  ds_write_b128 v208, a[244:247] offset:7168
  ds_write_b128 v210, a[232:235] offset:12288
  ds_write_b128 v210, a[236:239] offset:13312
  v_mfma_f32_32x32x16_bf16 v[0:15], a[208:211], v[152:155], v[0:15]
  ds_write_b128 v210, a[248:251] offset:14336
  ds_write_b128 v210, a[252:255] offset:15360
  v_mfma_f32_32x32x16_bf16 v[0:15], a[216:219], v[160:163], v[0:15]
  v_mfma_f32_32x32x16_bf16 v[16:31], a[204:207], v[144:147], v[16:31]
  v_mfma_f32_32x32x16_bf16 v[16:31], a[212:215], v[152:155], v[16:31]
  v_mfma_f32_32x32x16_bf16 v[16:31], a[220:223], v[160:163], v[16:31]
  ds_write_b128 v209, v[8:11] offset:8192
  ds_write_b128 v209, v[12:15] offset:9216
  s_nop 9
  ds_write_b128 v209, v[24:27] offset:10240
  ds_write_b128 v209, v[28:31] offset:11264
  s_waitcnt lgkmcnt(0)
  s_barrier
  ds_read_b128 v[32:35], v211 offset:0
  ds_read_b128 v[48:51], v211 offset:4096
  ds_read_b128 v[64:67], v211 offset:8192
  ds_read_b128 v[36:39], v211 offset:1024
  ds_read_b128 v[52:55], v211 offset:5120
  ds_read_b128 v[68:71], v211 offset:9216
  ds_read_b128 v[40:43], v211 offset:2048
  ds_read_b128 v[56:59], v211 offset:6144
  ds_read_b128 v[72:75], v211 offset:10240
  ds_read_b128 v[44:47], v211 offset:3072
  ds_read_b128 v[60:63], v211 offset:7168
  ds_read_b128 v[76:79], v211 offset:11264
  s_waitcnt lgkmcnt(11)
  v_pk_add_f32 v[0:1], v[0:1], v[32:33]
  v_pk_add_f32 v[2:3], v[2:3], v[34:35]
  s_waitcnt lgkmcnt(9)
  v_pk_add_f32 v[48:49], v[48:49], v[64:65]
  v_pk_add_f32 v[50:51], v[50:51], v[66:67]
  v_pk_add_f32 v[0:1], v[0:1], v[48:49]
  v_pk_add_f32 v[2:3], v[2:3], v[50:51]
  s_waitcnt lgkmcnt(8)
  v_pk_add_f32 v[4:5], v[4:5], v[36:37]
  v_pk_add_f32 v[6:7], v[6:7], v[38:39]
  s_waitcnt lgkmcnt(6)
  v_pk_add_f32 v[52:53], v[52:53], v[68:69]
  v_pk_add_f32 v[54:55], v[54:55], v[70:71]
  v_pk_add_f32 v[4:5], v[4:5], v[52:53]
  v_pk_add_f32 v[6:7], v[6:7], v[54:55]
  s_waitcnt lgkmcnt(5)
  v_pk_add_f32 v[16:17], v[16:17], v[40:41]
  v_pk_add_f32 v[18:19], v[18:19], v[42:43]
  s_waitcnt lgkmcnt(3)
  v_pk_add_f32 v[56:57], v[56:57], v[72:73]
  v_pk_add_f32 v[58:59], v[58:59], v[74:75]
  v_pk_add_f32 v[16:17], v[16:17], v[56:57]
  v_pk_add_f32 v[18:19], v[18:19], v[58:59]
  s_waitcnt lgkmcnt(2)
  v_pk_add_f32 v[20:21], v[20:21], v[44:45]
  v_pk_add_f32 v[22:23], v[22:23], v[46:47]
  s_waitcnt lgkmcnt(0)
  v_pk_add_f32 v[60:61], v[60:61], v[76:77]
  v_pk_add_f32 v[62:63], v[62:63], v[78:79]
  v_pk_add_f32 v[20:21], v[20:21], v[60:61]
  v_pk_add_f32 v[22:23], v[22:23], v[62:63]
  v_add_f32 v32, v0, v16
  v_sub_f32 v40, v0, v16
  v_add_f32 v33, v1, v17
  v_sub_f32 v41, v1, v17
  v_add_f32 v34, v2, v18
  v_sub_f32 v42, v2, v18
  v_add_f32 v35, v3, v19
  v_sub_f32 v43, v3, v19
  v_add_f32 v36, v4, v20
  v_sub_f32 v44, v4, v20
  v_add_f32 v37, v5, v21
  v_sub_f32 v45, v5, v21
  v_add_f32 v38, v6, v22
  v_sub_f32 v46, v6, v22
  v_add_f32 v39, v7, v23
  v_sub_f32 v47, v7, v23
  v_add_f32 v64, v32, v33
  v_cndmask_b32_e64 v32, v32, v0, s[76:77]
  v_cndmask_b32_e64 v40, v40, v16, s[76:77]
  v_cvt_pk_bf16_f32 v48, v32, v33
  v_cvt_pk_bf16_f32 v49, v34, v35
  v_or_b32 v48, 1, v48
  v_cvt_pk_bf16_f32 v50, v36, v37
  v_cvt_pk_bf16_f32 v51, v38, v39
  s_add_u32 s40, s83, 17563648
  buffer_store_dwordx4 v[48:51], v255, s[4:7], s40 offen sc1
  v_cvt_pk_bf16_f32 v52, v40, v41
  v_cvt_pk_bf16_f32 v53, v42, v43
  v_or_b32 v52, 1, v52
  v_cvt_pk_bf16_f32 v54, v44, v45
  v_cvt_pk_bf16_f32 v55, v46, v47
  s_add_u32 s40, s83, 17577984
  buffer_store_dwordx4 v[52:55], v255, s[4:7], s40 offen sc1
  v_cvt_pk_bf16_f32 v56, v0, v1
  v_cvt_pk_bf16_f32 v57, v2, v3
  v_or_b32 v56, 1, v56
  v_cvt_pk_bf16_f32 v58, v4, v5
  v_cvt_pk_bf16_f32 v59, v6, v7
  s_add_u32 s40, s31, 15728640
  buffer_store_dwordx4 v[56:59], v255, s[4:7], s40 offen sc1
  v_cvt_pk_bf16_f32 v60, v16, v17
  v_cvt_pk_bf16_f32 v61, v18, v19
  v_or_b32 v60, 1, v60
  v_cvt_pk_bf16_f32 v62, v20, v21
  v_cvt_pk_bf16_f32 v63, v22, v23
  s_add_u32 s40, s31, 15728640
  buffer_store_dwordx4 v[60:63], v255, s[4:7], s40 offen offset:2048 sc1
  v_mul_f32 v65, v0, v0
  v_mul_f32 v66, v16, v16
  v_fmac_f32 v65, v1, v1
  v_fmac_f32 v66, v17, v17
  v_add_f32 v64, v64, v34
  v_fmac_f32 v65, v2, v2
  v_fmac_f32 v66, v18, v18
  v_add_f32 v64, v64, v35
  v_fmac_f32 v65, v3, v3
  v_fmac_f32 v66, v19, v19
  v_add_f32 v64, v64, v36
  v_fmac_f32 v65, v4, v4
  v_fmac_f32 v66, v20, v20
  v_add_f32 v64, v64, v37
  v_fmac_f32 v65, v5, v5
  v_fmac_f32 v66, v21, v21
  v_add_f32 v64, v64, v38
  v_fmac_f32 v65, v6, v6
  v_fmac_f32 v66, v22, v22
  v_add_f32 v64, v64, v39
  v_fmac_f32 v65, v7, v7
  v_fmac_f32 v66, v23, v23
  v_add_f32 v65, v65, v66
  v_lshlrev_b32 v66, 2, v253
  s_nop 0
  v_permlane32_swap_b32 v64, v65
  v_add_f32 v64, v64, v65
  v_or_b32 v64, 1, v64
  buffer_store_dword v64, v66, s[4:7], s44 offen sc1
  s_lshl1_add_u32 s97, s74, s73
  s_lshl_b32 s97, s97, 11
  s_add_u32 s97, s97, 155648
  v_add_u32 v246, s97, v255
  v_lshrrev_b32 v248, 5, v253
  v_add_u32 v247, 155648, v255
  v_and_b32 v244, 31, v253
  v_lshl_add_u32 v244, v244, 2, s97
  v_lshl_add_u32 v245, v248, 4, s97
  v_lshlrev_b32 v241, 2, v253
  s_mul_i32 s93, s71, 28672
  s_add_u32 s93, s93, 17577984
  s_cmp_eq_u32 s73, 0
  s_cselect_b32 s92, 14336, 0
  s_sub_u32 s92, s93, s92
  s_lshl_b32 s94, s71, 12
  s_add_u32 s94, s94, 15466496
  s_mul_i32 s95, s70, 28672
  s_add_u32 s95, s95, 15728640
  v_and_b32 v32, 3, v253
  v_bfe_u32 v33, v253, 3, 2
  v_lshl_add_u32 v32, v33, 2, v32
  v_bfe_u32 v33, v253, 2, 1
  v_lshl_add_u32 v32, v33, 4, v32
  s_lshl_b32 s40, s65, 5
  v_add_u32 v32, s40, v32
  v_cvt_f32_u32 v33, v32
  v_mul_f32 v33, 0x3b124925, v33
  v_cmp_eq_u32 vcc, 0, v32
  v_and_b32 v35, 32, v253
  v_cvt_f32_u32 v35, v35
  v_cndmask_b32_e64 v32, v33, 0.5, vcc
  v_mul_f32 v34, 0x42000000, v32
  v_cos_f32 v36, v32
  v_mul_f32 v33, 0.5, v32
  v_cos_f32 v34, v34
  s_mul_i32 s40, s73, 0x3e800000
  v_fma_f32 v33, v33, v35, s40
  v_mov_b32 v35, v33
  v_add_f32 v36, v36, v36
  v_add_f32 v34, v34, v34
  v_fmamk_f32 v0, v32, 0x00000000, v33
  v_fmamk_f32 v1, v32, 0x41000000, v35
  v_fmamk_f32 v2, v32, 0x3f800000, v33
  v_fmamk_f32 v3, v32, 0x41100000, v35
  v_fmamk_f32 v16, v32, 0x42000000, v33
  v_fmamk_f32 v17, v32, 0x42200000, v35
  v_fmamk_f32 v18, v32, 0x42040000, v33
  v_fmamk_f32 v19, v32, 0x42240000, v35
  v_cos_f32 v0, v0
  v_cos_f32 v1, v1
  v_cos_f32 v2, v2
  v_cos_f32 v3, v3
  v_cos_f32 v16, v16
  v_cos_f32 v17, v17
  v_cos_f32 v18, v18
  v_cos_f32 v19, v19
  v_pk_fma_f32 v[4:5], v[36:37], v[2:3], v[0:1] op_sel_hi:[0,1,1] neg_lo:[0,0,1] neg_hi:[0,0,1]
  v_pk_fma_f32 v[20:21], v[36:37], v[18:19], v[16:17] op_sel_hi:[0,1,1] neg_lo:[0,0,1] neg_hi:[0,0,1]
  v_pk_fma_f32 v[6:7], v[36:37], v[4:5], v[2:3] op_sel_hi:[0,1,1] neg_lo:[0,0,1] neg_hi:[0,0,1]
  v_pk_fma_f32 v[22:23], v[36:37], v[20:21], v[18:19] op_sel_hi:[0,1,1] neg_lo:[0,0,1] neg_hi:[0,0,1]
  v_pk_fma_f32 v[8:9], v[36:37], v[6:7], v[4:5] op_sel_hi:[0,1,1] neg_lo:[0,0,1] neg_hi:[0,0,1]
  v_pk_fma_f32 v[24:25], v[36:37], v[22:23], v[20:21] op_sel_hi:[0,1,1] neg_lo:[0,0,1] neg_hi:[0,0,1]
  v_pk_fma_f32 v[10:11], v[36:37], v[8:9], v[6:7] op_sel_hi:[0,1,1] neg_lo:[0,0,1] neg_hi:[0,0,1]
  v_pk_fma_f32 v[26:27], v[36:37], v[24:25], v[22:23] op_sel_hi:[0,1,1] neg_lo:[0,0,1] neg_hi:[0,0,1]
  v_pk_fma_f32 v[12:13], v[36:37], v[10:11], v[8:9] op_sel_hi:[0,1,1] neg_lo:[0,0,1] neg_hi:[0,0,1]
  v_pk_fma_f32 v[28:29], v[36:37], v[26:27], v[24:25] op_sel_hi:[0,1,1] neg_lo:[0,0,1] neg_hi:[0,0,1]
  v_pk_fma_f32 v[14:15], v[36:37], v[12:13], v[10:11] op_sel_hi:[0,1,1] neg_lo:[0,0,1] neg_hi:[0,0,1]
  v_pk_fma_f32 v[30:31], v[36:37], v[28:29], v[26:27] op_sel_hi:[0,1,1] neg_lo:[0,0,1] neg_hi:[0,0,1]
  v_cvt_pk_bf16_f32 v112, v0, v2
  v_cvt_pk_bf16_f32 v113, v4, v6
  v_cvt_pk_bf16_f32 v114, v8, v10
  v_cvt_pk_bf16_f32 v115, v12, v14
  v_cvt_pk_bf16_f32 v120, v1, v3
  v_cvt_pk_bf16_f32 v121, v5, v7
  v_cvt_pk_bf16_f32 v122, v9, v11
  v_cvt_pk_bf16_f32 v123, v13, v15
  v_cvt_pk_bf16_f32 v128, v16, v18
  v_cvt_pk_bf16_f32 v129, v20, v22
  v_cvt_pk_bf16_f32 v130, v24, v26
  v_cvt_pk_bf16_f32 v131, v28, v30
  v_cvt_pk_bf16_f32 v136, v17, v19
  v_cvt_pk_bf16_f32 v137, v21, v23
  v_cvt_pk_bf16_f32 v138, v25, v27
  v_cvt_pk_bf16_f32 v139, v29, v31
  v_pk_fma_f32 v[0:1], v[34:35], v[16:17], v[0:1] op_sel_hi:[0,1,1] neg_lo:[0,0,1] neg_hi:[0,0,1]
  v_pk_fma_f32 v[2:3], v[34:35], v[18:19], v[2:3] op_sel_hi:[0,1,1] neg_lo:[0,0,1] neg_hi:[0,0,1]
  v_pk_fma_f32 v[4:5], v[34:35], v[20:21], v[4:5] op_sel_hi:[0,1,1] neg_lo:[0,0,1] neg_hi:[0,0,1]
  v_pk_fma_f32 v[6:7], v[34:35], v[22:23], v[6:7] op_sel_hi:[0,1,1] neg_lo:[0,0,1] neg_hi:[0,0,1]
  v_pk_fma_f32 v[8:9], v[34:35], v[24:25], v[8:9] op_sel_hi:[0,1,1] neg_lo:[0,0,1] neg_hi:[0,0,1]
  v_pk_fma_f32 v[10:11], v[34:35], v[26:27], v[10:11] op_sel_hi:[0,1,1] neg_lo:[0,0,1] neg_hi:[0,0,1]
  v_pk_fma_f32 v[12:13], v[34:35], v[28:29], v[12:13] op_sel_hi:[0,1,1] neg_lo:[0,0,1] neg_hi:[0,0,1]
  v_pk_fma_f32 v[14:15], v[34:35], v[30:31], v[14:15] op_sel_hi:[0,1,1] neg_lo:[0,0,1] neg_hi:[0,0,1]
  v_cvt_pk_bf16_f32 v144, v0, v2
  v_cvt_pk_bf16_f32 v145, v4, v6
  v_cvt_pk_bf16_f32 v146, v8, v10
  v_cvt_pk_bf16_f32 v147, v12, v14
  v_cvt_pk_bf16_f32 v152, v1, v3
  v_cvt_pk_bf16_f32 v153, v5, v7
  v_cvt_pk_bf16_f32 v154, v9, v11
  v_cvt_pk_bf16_f32 v155, v13, v15
  v_pk_fma_f32 v[16:17], v[34:35], v[0:1], v[16:17] op_sel_hi:[0,1,1] neg_lo:[0,0,1] neg_hi:[0,0,1]
  v_pk_fma_f32 v[18:19], v[34:35], v[2:3], v[18:19] op_sel_hi:[0,1,1] neg_lo:[0,0,1] neg_hi:[0,0,1]
  v_pk_fma_f32 v[20:21], v[34:35], v[4:5], v[20:21] op_sel_hi:[0,1,1] neg_lo:[0,0,1] neg_hi:[0,0,1]
  v_pk_fma_f32 v[22:23], v[34:35], v[6:7], v[22:23] op_sel_hi:[0,1,1] neg_lo:[0,0,1] neg_hi:[0,0,1]
  v_pk_fma_f32 v[24:25], v[34:35], v[8:9], v[24:25] op_sel_hi:[0,1,1] neg_lo:[0,0,1] neg_hi:[0,0,1]
  v_pk_fma_f32 v[26:27], v[34:35], v[10:11], v[26:27] op_sel_hi:[0,1,1] neg_lo:[0,0,1] neg_hi:[0,0,1]
  v_pk_fma_f32 v[28:29], v[34:35], v[12:13], v[28:29] op_sel_hi:[0,1,1] neg_lo:[0,0,1] neg_hi:[0,0,1]
  v_pk_fma_f32 v[30:31], v[34:35], v[14:15], v[30:31] op_sel_hi:[0,1,1] neg_lo:[0,0,1] neg_hi:[0,0,1]
  v_cvt_pk_bf16_f32 v160, v16, v18
  v_cvt_pk_bf16_f32 v161, v20, v22
  v_cvt_pk_bf16_f32 v162, v24, v26
  v_cvt_pk_bf16_f32 v163, v28, v30
  v_cvt_pk_bf16_f32 v168, v17, v19
  v_cvt_pk_bf16_f32 v169, v21, v23
  v_cvt_pk_bf16_f32 v170, v25, v27
  v_cvt_pk_bf16_f32 v171, v29, v31
  v_pk_fma_f32 v[0:1], v[34:35], v[16:17], v[0:1] op_sel_hi:[0,1,1] neg_lo:[0,0,1] neg_hi:[0,0,1]
  v_pk_fma_f32 v[2:3], v[34:35], v[18:19], v[2:3] op_sel_hi:[0,1,1] neg_lo:[0,0,1] neg_hi:[0,0,1]
  v_pk_fma_f32 v[4:5], v[34:35], v[20:21], v[4:5] op_sel_hi:[0,1,1] neg_lo:[0,0,1] neg_hi:[0,0,1]
  v_pk_fma_f32 v[6:7], v[34:35], v[22:23], v[6:7] op_sel_hi:[0,1,1] neg_lo:[0,0,1] neg_hi:[0,0,1]
  v_pk_fma_f32 v[8:9], v[34:35], v[24:25], v[8:9] op_sel_hi:[0,1,1] neg_lo:[0,0,1] neg_hi:[0,0,1]
  v_pk_fma_f32 v[10:11], v[34:35], v[26:27], v[10:11] op_sel_hi:[0,1,1] neg_lo:[0,0,1] neg_hi:[0,0,1]
  v_pk_fma_f32 v[12:13], v[34:35], v[28:29], v[12:13] op_sel_hi:[0,1,1] neg_lo:[0,0,1] neg_hi:[0,0,1]
  v_pk_fma_f32 v[14:15], v[34:35], v[30:31], v[14:15] op_sel_hi:[0,1,1] neg_lo:[0,0,1] neg_hi:[0,0,1]
  v_cvt_pk_bf16_f32 v176, v0, v2
  v_cvt_pk_bf16_f32 v177, v4, v6
  v_cvt_pk_bf16_f32 v178, v8, v10
  v_cvt_pk_bf16_f32 v179, v12, v14
  v_cvt_pk_bf16_f32 v184, v1, v3
  v_cvt_pk_bf16_f32 v185, v5, v7
  v_cvt_pk_bf16_f32 v186, v9, v11
  v_cvt_pk_bf16_f32 v187, v13, v15
  v_pk_fma_f32 v[16:17], v[34:35], v[0:1], v[16:17] op_sel_hi:[0,1,1] neg_lo:[0,0,1] neg_hi:[0,0,1]
  v_pk_fma_f32 v[18:19], v[34:35], v[2:3], v[18:19] op_sel_hi:[0,1,1] neg_lo:[0,0,1] neg_hi:[0,0,1]
  v_pk_fma_f32 v[20:21], v[34:35], v[4:5], v[20:21] op_sel_hi:[0,1,1] neg_lo:[0,0,1] neg_hi:[0,0,1]
  v_pk_fma_f32 v[22:23], v[34:35], v[6:7], v[22:23] op_sel_hi:[0,1,1] neg_lo:[0,0,1] neg_hi:[0,0,1]
  v_pk_fma_f32 v[24:25], v[34:35], v[8:9], v[24:25] op_sel_hi:[0,1,1] neg_lo:[0,0,1] neg_hi:[0,0,1]
  v_pk_fma_f32 v[26:27], v[34:35], v[10:11], v[26:27] op_sel_hi:[0,1,1] neg_lo:[0,0,1] neg_hi:[0,0,1]
  v_pk_fma_f32 v[28:29], v[34:35], v[12:13], v[28:29] op_sel_hi:[0,1,1] neg_lo:[0,0,1] neg_hi:[0,0,1]
  v_pk_fma_f32 v[30:31], v[34:35], v[14:15], v[30:31] op_sel_hi:[0,1,1] neg_lo:[0,0,1] neg_hi:[0,0,1]
  v_cvt_pk_bf16_f32 v192, v16, v18
  v_cvt_pk_bf16_f32 v193, v20, v22
  v_cvt_pk_bf16_f32 v194, v24, v26
  v_cvt_pk_bf16_f32 v195, v28, v30
  v_cvt_pk_bf16_f32 v200, v17, v19
  v_cvt_pk_bf16_f32 v201, v21, v23
  v_cvt_pk_bf16_f32 v202, v25, v27
  v_cvt_pk_bf16_f32 v203, v29, v31
  v_pk_fma_f32 v[0:1], v[34:35], v[16:17], v[0:1] op_sel_hi:[0,1,1] neg_lo:[0,0,1] neg_hi:[0,0,1]
  v_pk_fma_f32 v[2:3], v[34:35], v[18:19], v[2:3] op_sel_hi:[0,1,1] neg_lo:[0,0,1] neg_hi:[0,0,1]
  v_pk_fma_f32 v[4:5], v[34:35], v[20:21], v[4:5] op_sel_hi:[0,1,1] neg_lo:[0,0,1] neg_hi:[0,0,1]
  v_pk_fma_f32 v[6:7], v[34:35], v[22:23], v[6:7] op_sel_hi:[0,1,1] neg_lo:[0,0,1] neg_hi:[0,0,1]
  v_pk_fma_f32 v[8:9], v[34:35], v[24:25], v[8:9] op_sel_hi:[0,1,1] neg_lo:[0,0,1] neg_hi:[0,0,1]
  v_pk_fma_f32 v[10:11], v[34:35], v[26:27], v[10:11] op_sel_hi:[0,1,1] neg_lo:[0,0,1] neg_hi:[0,0,1]
  v_pk_fma_f32 v[12:13], v[34:35], v[28:29], v[12:13] op_sel_hi:[0,1,1] neg_lo:[0,0,1] neg_hi:[0,0,1]
  v_pk_fma_f32 v[14:15], v[34:35], v[30:31], v[14:15] op_sel_hi:[0,1,1] neg_lo:[0,0,1] neg_hi:[0,0,1]
  v_cvt_pk_bf16_f32 v208, v0, v2
  v_cvt_pk_bf16_f32 v209, v4, v6
  v_cvt_pk_bf16_f32 v210, v8, v10
  v_cvt_pk_bf16_f32 v211, v12, v14
  v_cvt_pk_bf16_f32 v216, v1, v3
  v_cvt_pk_bf16_f32 v217, v5, v7
  v_cvt_pk_bf16_f32 v218, v9, v11
  v_cvt_pk_bf16_f32 v219, v13, v15
  v_and_b32 v36, 1, v253
  v_lshlrev_b32 v104, 15, v36
  v_or_b32 v104, 0x3f80, v104
  s_cmp_eq_u32 s73, 0
  s_cselect_b32 s88, -1, 0
  s_mov_b32 s89, 0
  v_cndmask_b32_e64 v104, 0, v104, s[88:89]
  v_mov_b32 v105, 0
  v_mov_b32 v106, 0
  v_mov_b32 v107, 0
  v_and_b32 v32, 15, v253
  s_lshl_b32 s40, s64, 4
  v_add_u32 v32, s40, v32
  v_cvt_f32_u32 v32, v32
  v_mul_f32 v32, 0x3c800000, v32
  v_and_b32 v35, 32, v253
  v_cos_f32 v36, v32
  v_cvt_f32_u32 v35, v35
  v_and_b32 v34, 16, v253
  v_cvt_f32_u32 v34, v34
  v_mul_f32 v34, 0x3c800000, v34
  v_mul_f32 v33, 0x3e800000, v32
  v_fma_f32 v33, v33, v35, v34
  v_add_f32 v36, v36, v36
  v_lshlrev_b32 v34, 31, v253
  v_lshrrev_b32 v35, 16, v34
  v_or_b32 v34, v34, v35
  v_fmamk_f32 v0, v32, 0x00000000, v33
  v_fmamk_f32 v2, v32, 0x3f800000, v33
  v_fmamk_f32 v16, v32, 0x41800000, v33
  v_fmamk_f32 v18, v32, 0x41880000, v33
  s_branch L_over6
L_pad6:
  s_branch L_ret_F
L_over6:
  v_sin_f32 v1, v0
  v_cos_f32 v0, v0
  v_sin_f32 v3, v2
  v_cos_f32 v2, v2
  v_sin_f32 v17, v16
  v_cos_f32 v16, v16
  v_sin_f32 v19, v18
  v_cos_f32 v18, v18
  v_pk_fma_f32 v[4:5], v[36:37], v[2:3], v[0:1] op_sel_hi:[0,1,1] neg_lo:[0,0,1] neg_hi:[0,0,1]
  v_pk_fma_f32 v[20:21], v[36:37], v[18:19], v[16:17] op_sel_hi:[0,1,1] neg_lo:[0,0,1] neg_hi:[0,0,1]
  v_pk_fma_f32 v[6:7], v[36:37], v[4:5], v[2:3] op_sel_hi:[0,1,1] neg_lo:[0,0,1] neg_hi:[0,0,1]
  v_pk_fma_f32 v[22:23], v[36:37], v[20:21], v[18:19] op_sel_hi:[0,1,1] neg_lo:[0,0,1] neg_hi:[0,0,1]
  v_pk_fma_f32 v[8:9], v[36:37], v[6:7], v[4:5] op_sel_hi:[0,1,1] neg_lo:[0,0,1] neg_hi:[0,0,1]
  v_pk_fma_f32 v[24:25], v[36:37], v[22:23], v[20:21] op_sel_hi:[0,1,1] neg_lo:[0,0,1] neg_hi:[0,0,1]
  v_pk_fma_f32 v[10:11], v[36:37], v[8:9], v[6:7] op_sel_hi:[0,1,1] neg_lo:[0,0,1] neg_hi:[0,0,1]
  v_pk_fma_f32 v[26:27], v[36:37], v[24:25], v[22:23] op_sel_hi:[0,1,1] neg_lo:[0,0,1] neg_hi:[0,0,1]
  v_pk_fma_f32 v[12:13], v[36:37], v[10:11], v[8:9] op_sel_hi:[0,1,1] neg_lo:[0,0,1] neg_hi:[0,0,1]
  v_pk_fma_f32 v[28:29], v[36:37], v[26:27], v[24:25] op_sel_hi:[0,1,1] neg_lo:[0,0,1] neg_hi:[0,0,1]
  v_pk_fma_f32 v[14:15], v[36:37], v[12:13], v[10:11] op_sel_hi:[0,1,1] neg_lo:[0,0,1] neg_hi:[0,0,1]
  v_pk_fma_f32 v[30:31], v[36:37], v[28:29], v[26:27] op_sel_hi:[0,1,1] neg_lo:[0,0,1] neg_hi:[0,0,1]
  v_cvt_pk_bf16_f32 v72, v0, v4
  v_cvt_pk_bf16_f32 v73, v8, v12
  v_cvt_pk_bf16_f32 v74, v16, v20
  v_cvt_pk_bf16_f32 v75, v24, v28
  v_xor_b32 v76, v34, v72
  v_xor_b32 v77, v34, v73
  v_xor_b32 v78, v34, v74
  v_xor_b32 v79, v34, v75
  v_cvt_pk_bf16_f32 v80, v2, v6
  v_cvt_pk_bf16_f32 v81, v10, v14
  v_cvt_pk_bf16_f32 v82, v18, v22
  v_cvt_pk_bf16_f32 v83, v26, v30
  v_xor_b32 v84, v34, v80
  v_xor_b32 v85, v34, v81
  v_xor_b32 v86, v34, v82
  v_xor_b32 v87, v34, v83
  v_cvt_pk_bf16_f32 v88, v1, v5
  v_cvt_pk_bf16_f32 v89, v9, v13
  v_cvt_pk_bf16_f32 v90, v17, v21
  v_cvt_pk_bf16_f32 v91, v25, v29
  v_xor_b32 v92, v34, v88
  v_xor_b32 v93, v34, v89
  v_xor_b32 v94, v34, v90
  v_xor_b32 v95, v34, v91
  v_cvt_pk_bf16_f32 v96, v3, v7
  v_cvt_pk_bf16_f32 v97, v11, v15
  v_cvt_pk_bf16_f32 v98, v19, v23
  v_cvt_pk_bf16_f32 v99, v27, v31
  v_xor_b32 v100, v34, v96
  v_xor_b32 v101, v34, v97
  v_xor_b32 v102, v34, v98
  v_xor_b32 v103, v34, v99
  buffer_load_dwordx4 v[108:111], v255, s[4:7], s93 offen sc1
  s_add_u32 s41, s92, 0
  buffer_load_dwordx4 v[116:119], v255, s[4:7], s41 offen offset:0 sc1
  s_add_u32 s41, s92, 0
  buffer_load_dwordx4 v[124:127], v255, s[4:7], s41 offen offset:1024 sc1
  s_add_u32 s41, s92, 0
  buffer_load_dwordx4 v[132:135], v255, s[4:7], s41 offen offset:2048 sc1
  s_add_u32 s41, s92, 0
  buffer_load_dwordx4 v[140:143], v255, s[4:7], s41 offen offset:3072 sc1
  s_add_u32 s41, s92, 4096
  buffer_load_dwordx4 v[148:151], v255, s[4:7], s41 offen offset:0 sc1
  s_add_u32 s41, s92, 4096
  buffer_load_dwordx4 v[156:159], v255, s[4:7], s41 offen offset:1024 sc1
  s_add_u32 s41, s92, 4096
  buffer_load_dwordx4 v[164:167], v255, s[4:7], s41 offen offset:2048 sc1
  s_add_u32 s41, s92, 4096
  buffer_load_dwordx4 v[172:175], v255, s[4:7], s41 offen offset:3072 sc1
  s_add_u32 s41, s92, 8192
  buffer_load_dwordx4 v[180:183], v255, s[4:7], s41 offen offset:0 sc1
  s_add_u32 s41, s92, 8192
  buffer_load_dwordx4 v[188:191], v255, s[4:7], s41 offen offset:1024 sc1
  s_add_u32 s41, s92, 8192
  buffer_load_dwordx4 v[196:199], v255, s[4:7], s41 offen offset:2048 sc1
  s_add_u32 s41, s92, 8192
  buffer_load_dwordx4 v[204:207], v255, s[4:7], s41 offen offset:3072 sc1
  s_add_u32 s41, s92, 12288
  buffer_load_dwordx4 v[212:215], v255, s[4:7], s41 offen offset:0 sc1
  s_add_u32 s41, s92, 12288
  buffer_load_dwordx4 v[220:223], v255, s[4:7], s41 offen offset:1024 sc1
  buffer_load_dword v56, v241, s[4:7], s94 offen offset:0 sc1
  buffer_load_dword v57, v241, s[4:7], s94 offen offset:256 sc1
  buffer_load_dword v58, v241, s[4:7], s94 offen offset:512 sc1
  buffer_load_dword v59, v241, s[4:7], s94 offen offset:768 sc1
  buffer_load_dword v60, v241, s[4:7], s94 offen offset:1024 sc1
  buffer_load_dword v61, v241, s[4:7], s94 offen offset:1280 sc1
  buffer_load_dword v62, v241, s[4:7], s94 offen offset:1536 sc1
  buffer_load_dword v63, v241, s[4:7], s94 offen offset:1792 sc1
  buffer_load_dword v64, v241, s[4:7], s94 offen offset:2048 sc1
  buffer_load_dword v65, v241, s[4:7], s94 offen offset:2304 sc1
  buffer_load_dword v66, v241, s[4:7], s94 offen offset:2560 sc1
  buffer_load_dword v67, v241, s[4:7], s94 offen offset:2816 sc1
  buffer_load_dword v68, v241, s[4:7], s94 offen offset:3072 sc1
  buffer_load_dword v69, v241, s[4:7], s94 offen offset:3328 sc1
  s_waitcnt vmcnt(26)
  v_bitop3_b32 v40, v116, v124, v108 bitop3:0x80
  s_waitcnt vmcnt(24)
  v_bitop3_b32 v41, v132, v140, 1 bitop3:0x80
  s_waitcnt vmcnt(22)
  v_bitop3_b32 v42, v148, v156, 1 bitop3:0x80
  s_waitcnt vmcnt(20)
  v_bitop3_b32 v43, v164, v172, 1 bitop3:0x80
  s_waitcnt vmcnt(18)
  v_bitop3_b32 v44, v180, v188, 1 bitop3:0x80
  s_waitcnt vmcnt(16)
  v_bitop3_b32 v45, v196, v204, 1 bitop3:0x80
  s_waitcnt vmcnt(14)
  v_bitop3_b32 v46, v212, v220, 1 bitop3:0x80
  v_and_b32 v40, 1, v40
  s_waitcnt vmcnt(12)
  v_bitop3_b32 v40, v56, v57, v40 bitop3:0x80
  s_waitcnt vmcnt(10)
  v_bitop3_b32 v41, v58, v59, v41 bitop3:0x80
  s_waitcnt vmcnt(8)
  v_bitop3_b32 v42, v60, v61, v42 bitop3:0x80
  s_waitcnt vmcnt(6)
  v_bitop3_b32 v43, v62, v63, v43 bitop3:0x80
  s_waitcnt vmcnt(4)
  v_bitop3_b32 v44, v64, v65, v44 bitop3:0x80
  s_waitcnt vmcnt(2)
  v_bitop3_b32 v45, v66, v67, v45 bitop3:0x80
  s_waitcnt vmcnt(0)
  v_bitop3_b32 v46, v68, v69, v46 bitop3:0x80
  v_cmp_eq_u32 s[8:9], 0, v40
  v_cmp_eq_u32 s[10:11], 0, v41
  v_cmp_eq_u32 s[12:13], 0, v42
  v_cmp_eq_u32 s[14:15], 0, v43
  v_cmp_eq_u32 s[16:17], 0, v44
  v_cmp_eq_u32 s[18:19], 0, v45
  v_cmp_eq_u32 s[56:57], 0, v46
  s_or_b64 s[58:59], s[8:9], s[10:11]
  s_or_b64 s[60:61], s[12:13], s[14:15]
  s_or_b64 s[62:63], s[16:17], s[18:19]
  s_or_b64 s[58:59], s[58:59], s[60:61]
  s_or_b64 s[62:63], s[62:63], s[56:57]
  s_or_b64 s[58:59], s[58:59], s[62:63]
  s_cbranch_scc0 BACK_52
SLOW_51:
  s_mov_b64 exec, s[8:9]
  s_add_u32 s41, s92, 0
  buffer_load_dwordx4 v[116:119], v255, s[4:7], s41 offen offset:0 sc1
  buffer_load_dwordx4 v[124:127], v255, s[4:7], s41 offen offset:1024 sc1
  buffer_load_dword v56, v241, s[4:7], s94 offen offset:0 sc1
  buffer_load_dword v57, v241, s[4:7], s94 offen offset:256 sc1
  buffer_load_dwordx4 v[108:111], v255, s[4:7], s93 offen sc1
  s_mov_b64 exec, s[10:11]
  s_add_u32 s41, s92, 0
  buffer_load_dwordx4 v[132:135], v255, s[4:7], s41 offen offset:2048 sc1
  buffer_load_dwordx4 v[140:143], v255, s[4:7], s41 offen offset:3072 sc1
  buffer_load_dword v58, v241, s[4:7], s94 offen offset:512 sc1
  buffer_load_dword v59, v241, s[4:7], s94 offen offset:768 sc1
  s_mov_b64 exec, s[12:13]
  s_add_u32 s41, s92, 4096
  buffer_load_dwordx4 v[148:151], v255, s[4:7], s41 offen offset:0 sc1
  buffer_load_dwordx4 v[156:159], v255, s[4:7], s41 offen offset:1024 sc1
  buffer_load_dword v60, v241, s[4:7], s94 offen offset:1024 sc1
  buffer_load_dword v61, v241, s[4:7], s94 offen offset:1280 sc1
  s_mov_b64 exec, s[14:15]
  s_add_u32 s41, s92, 4096
  buffer_load_dwordx4 v[164:167], v255, s[4:7], s41 offen offset:2048 sc1
  buffer_load_dwordx4 v[172:175], v255, s[4:7], s41 offen offset:3072 sc1
  buffer_load_dword v62, v241, s[4:7], s94 offen offset:1536 sc1
  buffer_load_dword v63, v241, s[4:7], s94 offen offset:1792 sc1
  s_mov_b64 exec, s[16:17]
  s_add_u32 s41, s92, 8192
  buffer_load_dwordx4 v[180:183], v255, s[4:7], s41 offen offset:0 sc1
  buffer_load_dwordx4 v[188:191], v255, s[4:7], s41 offen offset:1024 sc1
  buffer_load_dword v64, v241, s[4:7], s94 offen offset:2048 sc1
  buffer_load_dword v65, v241, s[4:7], s94 offen offset:2304 sc1
  s_mov_b64 exec, s[18:19]
  s_add_u32 s41, s92, 8192
  buffer_load_dwordx4 v[196:199], v255, s[4:7], s41 offen offset:2048 sc1
  buffer_load_dwordx4 v[204:207], v255, s[4:7], s41 offen offset:3072 sc1
  buffer_load_dword v66, v241, s[4:7], s94 offen offset:2560 sc1
  buffer_load_dword v67, v241, s[4:7], s94 offen offset:2816 sc1
  s_mov_b64 exec, s[56:57]
  s_add_u32 s41, s92, 12288
  buffer_load_dwordx4 v[212:215], v255, s[4:7], s41 offen offset:0 sc1
  buffer_load_dwordx4 v[220:223], v255, s[4:7], s41 offen offset:1024 sc1
  buffer_load_dword v68, v241, s[4:7], s94 offen offset:3072 sc1
  buffer_load_dword v69, v241, s[4:7], s94 offen offset:3328 sc1
  s_mov_b64 exec, -1
  s_add_u32 s75, s75, 1
  s_cmp_gt_u32 s75, 300000
  s_cbranch_scc1 L_end
  s_waitcnt vmcnt(0)
  v_bitop3_b32 v40, v116, v124, v108 bitop3:0x80
  v_bitop3_b32 v41, v132, v140, 1 bitop3:0x80
  v_bitop3_b32 v42, v148, v156, 1 bitop3:0x80
  v_bitop3_b32 v43, v164, v172, 1 bitop3:0x80
  v_bitop3_b32 v44, v180, v188, 1 bitop3:0x80
  v_bitop3_b32 v45, v196, v204, 1 bitop3:0x80
  v_bitop3_b32 v46, v212, v220, 1 bitop3:0x80
  v_and_b32 v40, 1, v40
  v_bitop3_b32 v40, v56, v57, v40 bitop3:0x80
  v_bitop3_b32 v41, v58, v59, v41 bitop3:0x80
  v_bitop3_b32 v42, v60, v61, v42 bitop3:0x80
  v_bitop3_b32 v43, v62, v63, v43 bitop3:0x80
  v_bitop3_b32 v44, v64, v65, v44 bitop3:0x80
  v_bitop3_b32 v45, v66, v67, v45 bitop3:0x80
  v_bitop3_b32 v46, v68, v69, v46 bitop3:0x80
  v_cmp_eq_u32 s[8:9], 0, v40
  v_cmp_eq_u32 s[10:11], 0, v41
  v_cmp_eq_u32 s[12:13], 0, v42
  v_cmp_eq_u32 s[14:15], 0, v43
  v_cmp_eq_u32 s[16:17], 0, v44
  v_cmp_eq_u32 s[18:19], 0, v45
  v_cmp_eq_u32 s[56:57], 0, v46
  s_nop 1
  s_or_b64 s[58:59], s[8:9], s[10:11]
  s_or_b64 s[60:61], s[12:13], s[14:15]
  s_or_b64 s[62:63], s[16:17], s[18:19]
  s_or_b64 s[58:59], s[58:59], s[60:61]
  s_or_b64 s[62:63], s[62:63], s[56:57]
  s_or_b64 s[58:59], s[58:59], s[62:63]
  s_cbranch_scc1 SLOW_51
BACK_52:
  v_add_f32 v56, v56, v63
  v_add_f32 v57, v57, v64
  v_add_f32 v58, v58, v65
  v_add_f32 v59, v59, v66
  v_add_f32 v60, v60, v67
  v_add_f32 v61, v61, v68
  v_add_f32 v62, v62, v69
  v_add_f32 v56, v56, v57
  v_add_f32 v58, v58, v59
  v_add_f32 v60, v60, v61
  v_add_f32 v56, v56, v58
  v_add_f32 v60, v60, v62
  v_add_f32 v56, v56, v60
  v_mul_f32 v56, 0x3b124925, v56
  v_mov_b32 v57, v56
  v_mfma_f32_32x32x16_bf16 v[40:55], v[108:111], v[104:107], 0
  s_nop 0
  v_permlane32_swap_b32 v56, v57
  v_fma_f32 v57, -v56, v56, v57
  v_max_f32 v57, 0, v57
  v_add_f32 v57, 0x3727c5ac, v57
  v_rsq_f32 v57, v57
  v_mfma_f32_32x32x16_bf16 v[40:55], v[116:119], v[112:115], v[40:55]
  ds_write_b32 v244, v57
  ds_read_b128 v[24:27], v245 offset:0
  ds_read_b128 v[28:31], v245 offset:32
  ds_read_b128 v[32:35], v245 offset:64
  ds_read_b128 v[36:39], v245 offset:96
  v_mfma_f32_32x32x16_bf16 v[40:55], v[124:127], v[120:123], v[40:55]
  v_mfma_f32_32x32x16_bf16 v[40:55], v[132:135], v[128:131], v[40:55]
  s_add_u32 s98, s95, s24
  buffer_load_dwordx4 v[112:115], v255, s[4:7], s98 offen offset:0 sc1
  v_mfma_f32_32x32x16_bf16 v[40:55], v[140:143], v[136:139], v[40:55]
  buffer_load_dwordx4 v[116:119], v255, s[4:7], s98 offen offset:1024 sc1
  v_mfma_f32_32x32x16_bf16 v[40:55], v[148:151], v[144:147], v[40:55]
  buffer_load_dwordx4 v[120:123], v255, s[4:7], s98 offen offset:2048 sc1
  v_mfma_f32_32x32x16_bf16 v[40:55], v[156:159], v[152:155], v[40:55]
  buffer_load_dwordx4 v[124:127], v255, s[4:7], s98 offen offset:3072 sc1
  v_mfma_f32_32x32x16_bf16 v[40:55], v[164:167], v[160:163], v[40:55]
  s_add_u32 s98, s95, s25
  buffer_load_dwordx4 v[128:131], v255, s[4:7], s98 offen offset:0 sc1
  v_mfma_f32_32x32x16_bf16 v[40:55], v[172:175], v[168:171], v[40:55]
  buffer_load_dwordx4 v[132:135], v255, s[4:7], s98 offen offset:1024 sc1
  v_mfma_f32_32x32x16_bf16 v[40:55], v[180:183], v[176:179], v[40:55]
  buffer_load_dwordx4 v[136:139], v255, s[4:7], s98 offen offset:2048 sc1
  v_mfma_f32_32x32x16_bf16 v[40:55], v[188:191], v[184:187], v[40:55]
  buffer_load_dwordx4 v[140:143], v255, s[4:7], s98 offen offset:3072 sc1
  v_mfma_f32_32x32x16_bf16 v[40:55], v[196:199], v[192:195], v[40:55]
  s_add_u32 s98, s95, s26
  buffer_load_dwordx4 v[144:147], v255, s[4:7], s98 offen offset:0 sc1
  v_mfma_f32_32x32x16_bf16 v[40:55], v[204:207], v[200:203], v[40:55]
  buffer_load_dwordx4 v[148:151], v255, s[4:7], s98 offen offset:1024 sc1
  v_mfma_f32_32x32x16_bf16 v[40:55], v[212:215], v[208:211], v[40:55]
  buffer_load_dwordx4 v[152:155], v255, s[4:7], s98 offen offset:2048 sc1
  v_mfma_f32_32x32x16_bf16 v[40:55], v[220:223], v[216:219], v[40:55]
  buffer_load_dwordx4 v[156:159], v255, s[4:7], s98 offen offset:3072 sc1
  s_waitcnt lgkmcnt(3)
  s_nop 9
  v_pk_mul_f32 v[40:41], v[40:41], v[24:25]
  v_pk_mul_f32 v[42:43], v[42:43], v[26:27]
  v_cvt_pk_bf16_f32 v24, v40, v41
  s_waitcnt lgkmcnt(2)
  v_pk_mul_f32 v[44:45], v[44:45], v[28:29]
  v_cvt_pk_bf16_f32 v25, v42, v43
  v_pk_mul_f32 v[46:47], v[46:47], v[30:31]
  v_cvt_pk_bf16_f32 v26, v44, v45
  s_waitcnt lgkmcnt(1)
  v_pk_mul_f32 v[48:49], v[48:49], v[32:33]
  v_cvt_pk_bf16_f32 v27, v46, v47
  ds_write_b128 v246, v[24:27]
  v_pk_mul_f32 v[50:51], v[50:51], v[34:35]
  v_cvt_pk_bf16_f32 v28, v48, v49
  s_waitcnt lgkmcnt(1)
  v_pk_mul_f32 v[52:53], v[52:53], v[36:37]
  v_cvt_pk_bf16_f32 v29, v50, v51
  v_pk_mul_f32 v[54:55], v[54:55], v[38:39]
  v_cvt_pk_bf16_f32 v30, v52, v53
  v_cvt_pk_bf16_f32 v31, v54, v55
  ds_write_b128 v246, v[28:31] offset:1024
  v_bfe_u32 v250, v253, 4, 1
  v_lshl_add_u32 v248, v250, 1, v248
  v_lshlrev_b32 v248, 1, v248
  v_and_b32 v249, 7, v253
  v_xor_b32 v248, v248, v249
  v_and_b32 v250, 15, v253
  s_waitcnt lgkmcnt(0)
  s_barrier
  ds_read_b128 v[0:3], v247 offset:0
  ds_read_b128 v[4:7], v247 offset:1024
  ds_read_b128 v[8:11], v247 offset:4096
  ds_read_b128 v[12:15], v247 offset:5120
  ds_read_b128 v[16:19], v247 offset:2048
  ds_read_b128 v[20:23], v247 offset:3072
  ds_read_b128 v[24:27], v247 offset:6144
  ds_read_b128 v[28:31], v247 offset:7168
  v_lshl_add_u32 v248, v250, 3, v248
  v_lshl_add_u32 v248, v248, 4, s85
  v_lshrrev_b32 v250, 3, v253
  v_xor_b32 v251, v250, v253
  v_and_b32 v251, 7, v251
  v_lshl_add_u32 v251, v250, 3, v251
  v_lshl_add_u32 v251, v251, 4, s85
  v_mul_u32_u24 v250, 28672, v250
  v_lshl_add_u32 v249, v249, 4, v250
  v_xor_b32 v250, 16, v248
  s_mul_i32 s96, s64, 458752
  s_add_u32 s96, s96, s24
  s_waitcnt lgkmcnt(7)
  v_mfma_f32_32x32x16_bf16 v[40:55], v[0:3], v[72:75], 0
  s_lshl_b32 s41, s67, 7
  s_add_u32 s96, s96, s41
  s_add_u32 s96, s96, 19398656
  s_add_u32 s80, s80, 14680064
  v_and_b32 v32, 3, v253
  s_waitcnt lgkmcnt(6)
  v_mfma_f32_32x32x16_bf16 v[40:55], v[4:7], v[76:79], v[40:55]
  v_bfe_u32 v33, v253, 3, 2
  v_lshl_add_u32 v32, v33, 2, v32
  v_lshrrev_b32 v33, 3, v253
  v_xnor_b32 v33, v33, v253
  v_bfe_u32 v33, v33, 2, 1
  s_waitcnt lgkmcnt(5)
  v_mfma_f32_32x32x16_bf16 v[40:55], v[8:11], v[80:83], v[40:55]
  v_lshrrev_b32 v34, 1, v32
  v_lshlrev_b32 v34, v34, v33
  v_and_b32 v35, 16, v255
  v_mov_b32 v36, 0x3f80
  v_lshlrev_b32 v35, v35, v36
  s_waitcnt lgkmcnt(4)
  v_mfma_f32_32x32x16_bf16 v[40:55], v[12:15], v[84:87], v[40:55]
  v_bfe_i32 v36, v34, 0, 1
  v_and_b32 v36, v35, v36
  v_accvgpr_write_b32 a248, v36
  v_bfe_i32 v37, v34, 1, 1
  v_and_b32 v37, v35, v37
  s_waitcnt lgkmcnt(3)
  v_mfma_f32_32x32x16_bf16 v[40:55], v[16:19], v[88:91], v[40:55]
  v_accvgpr_write_b32 a249, v37
  v_bfe_i32 v36, v34, 2, 1
  v_and_b32 v36, v35, v36
  v_accvgpr_write_b32 a250, v36
  v_bfe_i32 v37, v34, 3, 1
  s_waitcnt lgkmcnt(2)
  v_mfma_f32_32x32x16_bf16 v[40:55], v[20:23], v[92:95], v[40:55]
  v_and_b32 v37, v35, v37
  v_accvgpr_write_b32 a251, v37
  v_bfe_i32 v36, v34, 4, 1
  v_and_b32 v36, v35, v36
  v_accvgpr_write_b32 a252, v36
  s_waitcnt lgkmcnt(1)
  v_mfma_f32_32x32x16_bf16 v[40:55], v[24:27], v[96:99], v[40:55]
  v_bfe_i32 v37, v34, 5, 1
  v_and_b32 v37, v35, v37
  v_accvgpr_write_b32 a253, v37
  v_bfe_i32 v36, v34, 6, 1
  v_and_b32 v36, v35, v36
  s_waitcnt lgkmcnt(0)
  v_mfma_f32_32x32x16_bf16 v[40:55], v[28:31], v[100:103], v[40:55]
  v_accvgpr_write_b32 a254, v36
  v_bfe_i32 v37, v34, 7, 1
  v_and_b32 v37, v35, v37
  v_accvgpr_write_b32 a255, v37
  s_add_u32 s40, s96, 229376
  s_nop 6
  v_cvt_pk_bf16_f32 v56, v40, v41
  v_cvt_pk_bf16_f32 v57, v42, v43
  v_cvt_pk_bf16_f32 v58, v44, v45
  v_cvt_pk_bf16_f32 v59, v46, v47
  ds_write_b128 v248, v[56:59]
  v_cvt_pk_bf16_f32 v60, v48, v49
  v_cvt_pk_bf16_f32 v61, v50, v51
  v_cvt_pk_bf16_f32 v62, v52, v53
  v_cvt_pk_bf16_f32 v63, v54, v55
  ds_write_b128 v250, v[60:63]
  ds_read_b128 v[64:67], v251
  ds_read_b128 v[68:71], v251 offset:1024
  s_waitcnt lgkmcnt(1)
  buffer_store_dwordx4 v[64:67], v249, s[4:7], s96 offen sc1
  s_waitcnt lgkmcnt(0)
  buffer_store_dwordx4 v[68:71], v249, s[4:7], s40 offen sc1
  s_mov_b32 s93, s95
  s_waitcnt vmcnt(12)
  v_bitop3_b32 v254, v112, v116, 1 bitop3:0x80
  s_waitcnt vmcnt(10)
  v_bitop3_b32 v254, v120, v124, v254 bitop3:0x80
  v_cmp_ne_u32 vcc, 1, v254
  v_mov_b32 v250, s38
  v_mov_b32 v251, s39
  s_lshl_b32 s40, s64, 6
  v_add_u32 v247, s40, v253
  v_min_u32 v247, 223, v247
  v_lshlrev_b32 v247, 7, v247
  s_cbranch_vccnz SLOW_53
BACK_54:
  v_mfma_f32_32x32x16_bf16 v[0:15], a[248:251], v[112:115], 0
  v_and_b32 v222, 31, v253
  v_lshl_add_u32 v222, v222, 6, s70
  v_cvt_f32_u32 v222, v222
  v_and_b32 v216, 32, v253
  v_mul_f32 v222, 0x3a000000, v222
  v_cvt_f32_u32 v216, v216
  v_mfma_f32_32x32x16_bf16 v[0:15], a[252:255], v[116:119], v[0:15]
  v_mul_f32 v216, 0.5, v216
  v_mul_f32 v216, v216, v222
  v_add_f32 v218, v216, v222
  v_cos_f32 v222, v222
  v_mfma_f32_32x32x16_bf16 v[16:31], a[248:251], v[120:123], 0
  v_sin_f32 v217, v216
  v_cos_f32 v216, v216
  v_sin_f32 v219, v218
  v_mfma_f32_32x32x16_bf16 v[16:31], a[252:255], v[124:127], v[16:31]
  s_waitcnt vmcnt(8)
  v_bitop3_b32 v254, v128, v132, 1 bitop3:0x80
  s_waitcnt vmcnt(6)
  v_bitop3_b32 v254, v136, v140, v254 bitop3:0x80
  v_cmp_ne_u32 vcc, 1, v254
  s_nop 4
  s_cbranch_vccnz SLOW_55
BACK_56:
  v_cos_f32 v218, v218
  v_mfma_f32_32x32x16_bf16 v[32:47], a[248:251], v[128:131], 0
  v_add_f32 v222, v222, v222
  v_cvt_pk_bf16_f32 v223, v216, -v217
  v_cvt_pk_bf16_f32 v224, v216, v217
  v_accvgpr_write_b32 a224, v223
  v_fma_f32 v220, v222, v218, -v216
  v_fma_f32 v221, v222, v219, -v217
  v_mfma_f32_32x32x16_bf16 v[32:47], a[252:255], v[132:135], v[32:47]
  v_cvt_pk_bf16_f32 v223, v218, -v219
  v_cvt_pk_bf16_f32 v225, v218, v219
  v_accvgpr_write_b32 a225, v223
  v_fma_f32 v216, v222, v220, -v218
  v_fma_f32 v217, v222, v221, -v219
  v_cvt_pk_bf16_f32 v223, v220, -v221
  v_mfma_f32_32x32x16_bf16 v[48:63], a[248:251], v[136:139], 0
  v_cvt_pk_bf16_f32 v226, v220, v221
  v_accvgpr_write_b32 a226, v223
  v_fma_f32 v218, v222, v216, -v220
  v_fma_f32 v219, v222, v217, -v221
  v_cvt_pk_bf16_f32 v223, v216, -v217
  v_cvt_pk_bf16_f32 v227, v216, v217
  v_mfma_f32_32x32x16_bf16 v[48:63], a[252:255], v[140:143], v[48:63]
  s_waitcnt vmcnt(4)
  v_bitop3_b32 v254, v144, v148, 1 bitop3:0x80
  s_waitcnt vmcnt(2)
  v_bitop3_b32 v254, v152, v156, v254 bitop3:0x80
  v_cmp_ne_u32 vcc, 1, v254
  s_nop 4
  s_cbranch_vccnz SLOW_57
BACK_58:
  v_accvgpr_write_b32 a227, v223
  v_fma_f32 v220, v222, v218, -v216
  v_mfma_f32_32x32x16_bf16 v[64:79], a[248:251], v[144:147], 0
  v_fma_f32 v221, v222, v219, -v217
  v_cvt_pk_bf16_f32 v223, v218, -v219
  v_cvt_pk_bf16_f32 v228, v218, v219
  v_accvgpr_write_b32 a228, v223
  v_fma_f32 v216, v222, v220, -v218
  v_fma_f32 v217, v222, v221, -v219
  v_mfma_f32_32x32x16_bf16 v[64:79], a[252:255], v[148:151], v[64:79]
  v_cvt_pk_bf16_f32 v223, v220, -v221
  v_cvt_pk_bf16_f32 v229, v220, v221
  v_accvgpr_write_b32 a229, v223
  v_fma_f32 v218, v222, v216, -v220
  v_fma_f32 v219, v222, v217, -v221
  v_cvt_pk_bf16_f32 v223, v216, -v217
  v_mfma_f32_32x32x16_bf16 v[80:95], a[248:251], v[152:155], 0
  v_cvt_pk_bf16_f32 v230, v216, v217
  v_accvgpr_write_b32 a230, v223
  v_fma_f32 v220, v222, v218, -v216
  v_fma_f32 v221, v222, v219, -v217
  v_cvt_pk_bf16_f32 v223, v218, -v219
  v_cvt_pk_bf16_f32 v231, v218, v219
  v_mfma_f32_32x32x16_bf16 v[80:95], a[252:255], v[156:159], v[80:95]
  s_waitcnt vmcnt(0)
  s_barrier
  s_mov_b64 exec, 1
  buffer_store_dwordx2 v[250:251], v255, s[4:7], s80 offen sc1
  s_mov_b64 exec, -1
  s_add_u32 s98, s95, s27
  buffer_load_dwordx4 v[160:163], v255, s[4:7], s98 offen offset:0 sc1
  buffer_load_dwordx4 v[164:167], v255, s[4:7], s98 offen offset:1024 sc1
  buffer_load_dwordx4 v[168:171], v255, s[4:7], s98 offen offset:2048 sc1
  buffer_load_dwordx4 v[172:175], v255, s[4:7], s98 offen offset:3072 sc1
  s_add_u32 s98, s95, s28
  buffer_load_dwordx4 v[176:179], v255, s[4:7], s98 offen offset:0 sc1
  buffer_load_dwordx4 v[180:183], v255, s[4:7], s98 offen offset:1024 sc1
  buffer_load_dwordx4 v[184:187], v255, s[4:7], s98 offen offset:2048 sc1
  buffer_load_dwordx4 v[188:191], v255, s[4:7], s98 offen offset:3072 sc1
  s_add_u32 s98, s95, s29
  buffer_load_dwordx4 v[192:195], v255, s[4:7], s98 offen offset:0 sc1
  buffer_load_dwordx4 v[196:199], v255, s[4:7], s98 offen offset:1024 sc1
  buffer_load_dwordx4 v[200:203], v255, s[4:7], s98 offen offset:2048 sc1
  buffer_load_dwordx4 v[204:207], v255, s[4:7], s98 offen offset:3072 sc1
  s_add_u32 s98, s95, s30
  buffer_load_dwordx4 v[208:211], v255, s[4:7], s98 offen offset:0 sc1
  buffer_load_dwordx4 v[212:215], v255, s[4:7], s98 offen offset:1024 sc1
  buffer_load_dwordx4 a[240:243], v255, s[4:7], s98 offen offset:2048 sc1
  buffer_load_dwordx4 a[244:247], v255, s[4:7], s98 offen offset:3072 sc1
  v_accvgpr_write_b32 a231, v223
  v_fma_f32 v216, v222, v220, -v218
  v_fma_f32 v217, v222, v221, -v219
  v_cvt_pk_bf16_f32 v223, v220, -v221
  v_cvt_pk_bf16_f32 v232, v220, v221
  v_accvgpr_write_b32 a232, v223
  v_fma_f32 v218, v222, v216, -v220
  v_fma_f32 v219, v222, v217, -v221
  v_cvt_pk_bf16_f32 v223, v216, -v217
  v_cvt_pk_bf16_f32 v233, v216, v217
  v_accvgpr_write_b32 a233, v223
  v_fma_f32 v220, v222, v218, -v216
  v_fma_f32 v221, v222, v219, -v217
  v_cvt_pk_bf16_f32 v223, v218, -v219
  v_cvt_pk_bf16_f32 v234, v218, v219
  v_accvgpr_write_b32 a234, v223
  v_fma_f32 v216, v222, v220, -v218
  v_fma_f32 v217, v222, v221, -v219
  v_cvt_pk_bf16_f32 v223, v220, -v221
  v_cvt_pk_bf16_f32 v235, v220, v221
  v_accvgpr_write_b32 a235, v223
  v_fma_f32 v218, v222, v216, -v220
  v_fma_f32 v219, v222, v217, -v221
  v_cvt_pk_bf16_f32 v223, v216, -v217
  v_cvt_pk_bf16_f32 v236, v216, v217
  v_accvgpr_write_b32 a236, v223
  v_fma_f32 v220, v222, v218, -v216
  v_fma_f32 v221, v222, v219, -v217
  v_cvt_pk_bf16_f32 v223, v218, -v219
  v_cvt_pk_bf16_f32 v237, v218, v219
  v_accvgpr_write_b32 a237, v223
  v_fma_f32 v216, v222, v220, -v218
  v_fma_f32 v217, v222, v221, -v219
  v_cvt_pk_bf16_f32 v223, v220, -v221
  v_cvt_pk_bf16_f32 v238, v220, v221
  v_accvgpr_write_b32 a238, v223
  v_cvt_pk_bf16_f32 v223, v216, -v217
  v_cvt_pk_bf16_f32 v239, v216, v217
  v_accvgpr_write_b32 a239, v223
  v_lshrrev_b32 v244, 5, v253
  v_lshlrev_b32 v244, 11, v244
  v_bfe_u32 v245, v253, 2, 2
  v_lshl_add_u32 v244, v245, 6, v244
  v_and_b32 v245, 1, v253
  v_lshl_add_u32 v244, v245, 5, v244
  v_bfe_u32 v245, v253, 4, 1
  v_lshl_add_u32 v244, v245, 4, v244
  v_bfe_u32 v245, v253, 1, 1
  v_lshl_add_u32 v244, v245, 3, v244
  s_mul_i32 s40, s72, 28672
  s_add_u32 s40, s40, 4096
  v_add_u32 v245, s40, v244
  v_add_u32 v244, s85, v244
  s_lshl_b32 s40, s74, 12
  s_add_u32 s40, s40, 155648
  s_cmp_eq_u32 s73, 0
  s_cselect_b32 s40, s40, 151552
  v_add_u32 v246, s40, v255
  s_waitcnt vmcnt(14)
  v_bitop3_b32 v254, v160, v164, 1 bitop3:0x80
  s_waitcnt vmcnt(12)
  v_bitop3_b32 v254, v168, v172, v254 bitop3:0x80
  v_cmp_ne_u32 vcc, 1, v254
  s_nop 4
  s_cbranch_vccnz SLOW_59
BACK_60:
  v_mfma_f32_32x32x16_bf16 v[96:111], a[248:251], v[160:163], 0
  v_mfma_f32_32x32x16_bf16 v[96:111], a[252:255], v[164:167], v[96:111]
  v_mfma_f32_32x32x16_bf16 v[112:127], a[248:251], v[168:171], 0
  v_mfma_f32_32x32x16_bf16 v[112:127], a[252:255], v[172:175], v[112:127]
  s_waitcnt vmcnt(10)
  v_bitop3_b32 v254, v176, v180, 1 bitop3:0x80
  s_waitcnt vmcnt(8)
  v_bitop3_b32 v254, v184, v188, v254 bitop3:0x80
  v_cmp_ne_u32 vcc, 1, v254
  s_nop 4
  s_cbranch_vccnz SLOW_61
BACK_62:
  v_mfma_f32_32x32x16_bf16 v[128:143], a[248:251], v[176:179], 0
  v_mfma_f32_32x32x16_bf16 v[128:143], a[252:255], v[180:183], v[128:143]
  v_mfma_f32_32x32x16_bf16 v[144:159], a[248:251], v[184:187], 0
  v_mfma_f32_32x32x16_bf16 v[144:159], a[252:255], v[188:191], v[144:159]
  s_waitcnt vmcnt(6)
  v_bitop3_b32 v254, v192, v196, 1 bitop3:0x80
  s_waitcnt vmcnt(4)
  v_bitop3_b32 v254, v200, v204, v254 bitop3:0x80
  v_cmp_ne_u32 vcc, 1, v254
  s_nop 4
  s_cbranch_vccnz SLOW_63
BACK_64:
  v_mfma_f32_32x32x16_bf16 v[160:175], a[248:251], v[192:195], 0
  s_mov_b32 s97, 14811136
  buffer_load_dwordx2 v[248:249], v247, s[4:7], s97 offen sc1
  s_add_u32 s95, s95, 3670016
  s_mov_b32 s89, 0
  v_mfma_f32_32x32x16_bf16 v[160:175], a[252:255], v[196:199], v[160:175]
  v_mfma_f32_32x32x16_bf16 v[176:191], a[248:251], v[200:203], 0
  v_mfma_f32_32x32x16_bf16 v[176:191], a[252:255], v[204:207], v[176:191]
  s_waitcnt vmcnt(2)
  v_accvgpr_read_b32 v240, a240
  s_waitcnt vmcnt(1)
  v_accvgpr_read_b32 v241, a244
  v_bitop3_b32 v254, v208, v212, 1 bitop3:0x80
  v_bitop3_b32 v254, v240, v241, v254 bitop3:0x80
  s_branch L_over7
L_pad7:
  s_branch L_ret_F
L_over7:
  v_cmp_ne_u32 vcc, 1, v254
  s_nop 4
  s_cbranch_vccnz SLOW_65
BACK_66:
  v_mfma_f32_32x32x16_bf16 v[192:207], a[248:251], v[208:211], 0
  v_mfma_f32_32x32x16_bf16 v[192:207], a[252:255], v[212:215], v[192:207]
  v_mfma_f32_32x32x16_bf16 v[208:223], a[248:251], a[240:243], 0
  v_mfma_f32_32x32x16_bf16 v[208:223], a[252:255], a[244:247], v[208:223]
  s_waitcnt vmcnt(0)
  v_cmp_ne_u64 vcc, v[248:249], s[38:39]
  s_nop 4
  s_cbranch_vccnz SLOW_67
BACK_68:
  s_waitcnt lgkmcnt(0)
  s_barrier
  s_add_u32 m0, s85, 0
  s_add_u32 s43, s95, s24
  buffer_load_dwordx4 v255, s[4:7], s43 offen offset:0 sc1 lds
  buffer_load_dwordx4 v255, s[4:7], s43 offen offset:1024 sc1 lds
  buffer_load_dwordx4 v255, s[4:7], s43 offen offset:2048 sc1 lds
  buffer_load_dwordx4 v255, s[4:7], s43 offen offset:3072 sc1 lds
  s_add_u32 m0, s85, 4096
  s_add_u32 s43, s95, s25
  buffer_load_dwordx4 v255, s[4:7], s43 offen offset:0 sc1 lds
  buffer_load_dwordx4 v255, s[4:7], s43 offen offset:1024 sc1 lds
  buffer_load_dwordx4 v255, s[4:7], s43 offen offset:2048 sc1 lds
  buffer_load_dwordx4 v255, s[4:7], s43 offen offset:3072 sc1 lds
  s_add_u32 m0, s85, 8192
  s_add_u32 s43, s95, s26
  buffer_load_dwordx4 v255, s[4:7], s43 offen offset:0 sc1 lds
  buffer_load_dwordx4 v255, s[4:7], s43 offen offset:1024 sc1 lds
  buffer_load_dwordx4 v255, s[4:7], s43 offen offset:2048 sc1 lds
  buffer_load_dwordx4 v255, s[4:7], s43 offen offset:3072 sc1 lds
  s_add_u32 m0, s85, 12288
  s_add_u32 s43, s95, s27
  buffer_load_dwordx4 v255, s[4:7], s43 offen offset:0 sc1 lds
  buffer_load_dwordx4 v255, s[4:7], s43 offen offset:1024 sc1 lds
  buffer_load_dwordx4 v255, s[4:7], s43 offen offset:2048 sc1 lds
  buffer_load_dwordx4 v255, s[4:7], s43 offen offset:3072 sc1 lds
  v_mov_b32 v250, v0
  s_waitcnt vmcnt(12)
  s_barrier
  ds_read_b64_tr_b16 a[240:241], v244 offset:0
  ds_read_b64_tr_b16 a[242:243], v244 offset:256
  ds_read_b64_tr_b16 a[244:245], v244 offset:512
  ds_read_b64_tr_b16 a[246:247], v244 offset:768
  ds_read_b64_tr_b16 a[248:249], v244 offset:1024
  ds_read_b64_tr_b16 a[250:251], v244 offset:1280
  ds_read_b64_tr_b16 a[252:253], v244 offset:1536
  ds_read_b64_tr_b16 a[254:255], v244 offset:1792
  s_waitcnt lgkmcnt(6)
  v_mfma_f32_32x32x16_bf16 v[0:15], a[240:243], v[224:227], v[0:15]
  ds_read_b64_tr_b16 a[240:241], v245 offset:0
  ds_read_b64_tr_b16 a[242:243], v245 offset:256
  s_add_u32 m0, s85, 16384
  s_add_u32 s43, s95, s28
  buffer_load_dwordx4 v255, s[4:7], s43 offen offset:0 sc1 lds
  s_waitcnt lgkmcnt(6)
  v_mfma_f32_32x32x16_bf16 v[0:15], a[244:247], v[228:231], v[0:15]
  ds_read_b64_tr_b16 a[244:245], v245 offset:512
  ds_read_b64_tr_b16 a[246:247], v245 offset:768
  s_waitcnt lgkmcnt(4)
  v_mfma_f32_32x32x16_bf16 v[0:15], a[248:251], v[232:235], v[0:15]
  ds_read_b64_tr_b16 a[248:249], v245 offset:1024
  ds_read_b64_tr_b16 a[250:251], v245 offset:1280
  buffer_load_dwordx4 v255, s[4:7], s43 offen offset:1024 sc1 lds
  v_mfma_f32_32x32x16_bf16 v[0:15], a[252:255], v[236:239], v[0:15]
  ds_read_b64_tr_b16 a[252:253], v245 offset:1536
  ds_read_b64_tr_b16 a[254:255], v245 offset:1792
  s_waitcnt vmcnt(10)
  s_barrier
  s_waitcnt lgkmcnt(4)
  v_mfma_f32_32x32x16_bf16 v[16:31], a[240:243], a[224:227], v[16:31]
  ds_read_b64_tr_b16 a[240:241], v244 offset:4096
  ds_read_b64_tr_b16 a[242:243], v244 offset:4352
  buffer_load_dwordx4 v255, s[4:7], s43 offen offset:2048 sc1 lds
  v_mfma_f32_32x32x16_bf16 v[16:31], a[244:247], a[228:231], v[16:31]
  ds_read_b64_tr_b16 a[244:245], v244 offset:4608
  ds_read_b64_tr_b16 a[246:247], v244 offset:4864
  s_waitcnt lgkmcnt(4)
  v_mfma_f32_32x32x16_bf16 v[16:31], a[248:251], a[232:235], v[16:31]
  ds_read_b64_tr_b16 a[248:249], v244 offset:5120
  ds_read_b64_tr_b16 a[250:251], v244 offset:5376
  buffer_load_dwordx4 v255, s[4:7], s43 offen offset:3072 sc1 lds
  s_cmp_eq_u32 s24, 0
  s_cselect_b32 s88, -1, 0
  v_cndmask_b32_e64 v0, v0, v250, s[88:89]
  v_mov_b32 v250, v32
  v_mfma_f32_32x32x16_bf16 v[16:31], a[252:255], a[236:239], v[16:31]
  ds_read_b64_tr_b16 a[252:253], v244 offset:5632
  ds_read_b64_tr_b16 a[254:255], v244 offset:5888
  v_mov_b32 v240, v0
  v_mul_f32 v241, v0, v0
  v_mov_b32 v242, v1
  v_mul_f32 v243, v1, v1
  s_waitcnt lgkmcnt(4)
  v_mfma_f32_32x32x16_bf16 v[32:47], a[240:243], v[224:227], v[32:47]
  ds_read_b64_tr_b16 a[240:241], v245 offset:4096
  ds_read_b64_tr_b16 a[242:243], v245 offset:4352
  s_add_u32 m0, s85, 20480
  s_add_u32 s43, s95, s29
  buffer_load_dwordx4 v255, s[4:7], s43 offen offset:0 sc1 lds
  v_add_f32 v240, v240, v2
  v_fmac_f32 v241, v2, v2
  v_add_f32 v242, v242, v3
  v_fmac_f32 v243, v3, v3
  v_mfma_f32_32x32x16_bf16 v[32:47], a[244:247], v[228:231], v[32:47]
  ds_read_b64_tr_b16 a[244:245], v245 offset:4608
  ds_read_b64_tr_b16 a[246:247], v245 offset:4864
  v_add_f32 v240, v240, v4
  v_fmac_f32 v241, v4, v4
  v_add_f32 v242, v242, v5
  v_fmac_f32 v243, v5, v5
  s_waitcnt lgkmcnt(4)
  v_mfma_f32_32x32x16_bf16 v[32:47], a[248:251], v[232:235], v[32:47]
  ds_read_b64_tr_b16 a[248:249], v245 offset:5120
  ds_read_b64_tr_b16 a[250:251], v245 offset:5376
  buffer_load_dwordx4 v255, s[4:7], s43 offen offset:1024 sc1 lds
  v_add_f32 v240, v240, v6
  v_fmac_f32 v241, v6, v6
  v_add_f32 v242, v242, v7
  v_fmac_f32 v243, v7, v7
  v_mfma_f32_32x32x16_bf16 v[32:47], a[252:255], v[236:239], v[32:47]
  ds_read_b64_tr_b16 a[252:253], v245 offset:5632
  ds_read_b64_tr_b16 a[254:255], v245 offset:5888
  v_add_f32 v240, v240, v8
  v_fmac_f32 v241, v8, v8
  v_add_f32 v242, v242, v9
  v_fmac_f32 v243, v9, v9
  s_waitcnt vmcnt(10)
  s_barrier
  s_waitcnt lgkmcnt(4)
  v_mfma_f32_32x32x16_bf16 v[48:63], a[240:243], a[224:227], v[48:63]
  ds_read_b64_tr_b16 a[240:241], v244 offset:8192
  ds_read_b64_tr_b16 a[242:243], v244 offset:8448
  buffer_load_dwordx4 v255, s[4:7], s43 offen offset:2048 sc1 lds
  v_add_f32 v240, v240, v10
  v_fmac_f32 v241, v10, v10
  v_add_f32 v242, v242, v11
  v_fmac_f32 v243, v11, v11
  v_mfma_f32_32x32x16_bf16 v[48:63], a[244:247], a[228:231], v[48:63]
  ds_read_b64_tr_b16 a[244:245], v244 offset:8704
  ds_read_b64_tr_b16 a[246:247], v244 offset:8960
  v_add_f32 v240, v240, v12
  v_fmac_f32 v241, v12, v12
  v_add_f32 v242, v242, v13
  v_fmac_f32 v243, v13, v13
  s_waitcnt lgkmcnt(4)
  v_mfma_f32_32x32x16_bf16 v[48:63], a[248:251], a[232:235], v[48:63]
  ds_read_b64_tr_b16 a[248:249], v244 offset:9216
  ds_read_b64_tr_b16 a[250:251], v244 offset:9472
  buffer_load_dwordx4 v255, s[4:7], s43 offen offset:3072 sc1 lds
  s_cmp_eq_u32 s25, 0
  s_cselect_b32 s88, -1, 0
  v_cndmask_b32_e64 v32, v32, v250, s[88:89]
  v_mov_b32 v250, v64
  v_add_f32 v240, v240, v14
  v_fmac_f32 v241, v14, v14
  v_add_f32 v242, v242, v15
  v_fmac_f32 v243, v15, v15
  v_mfma_f32_32x32x16_bf16 v[48:63], a[252:255], a[236:239], v[48:63]
  ds_read_b64_tr_b16 a[252:253], v244 offset:9728
  ds_read_b64_tr_b16 a[254:255], v244 offset:9984
  v_add_f32 v240, v240, v16
  v_fmac_f32 v241, v16, v16
  v_add_f32 v242, v242, v17
  v_fmac_f32 v243, v17, v17
  s_waitcnt lgkmcnt(4)
  v_mfma_f32_32x32x16_bf16 v[64:79], a[240:243], v[224:227], v[64:79]
  ds_read_b64_tr_b16 a[240:241], v245 offset:8192
  ds_read_b64_tr_b16 a[242:243], v245 offset:8448
  s_add_u32 m0, s85, 24576
  s_add_u32 s43, s95, s30
  buffer_load_dwordx4 v255, s[4:7], s43 offen offset:0 sc1 lds
  v_add_f32 v240, v240, v18
  v_fmac_f32 v241, v18, v18
  v_add_f32 v242, v242, v19
  v_fmac_f32 v243, v19, v19
  v_mfma_f32_32x32x16_bf16 v[64:79], a[244:247], v[228:231], v[64:79]
  ds_read_b64_tr_b16 a[244:245], v245 offset:8704
  ds_read_b64_tr_b16 a[246:247], v245 offset:8960
  v_add_f32 v240, v240, v20
  v_fmac_f32 v241, v20, v20
  v_add_f32 v242, v242, v21
  v_fmac_f32 v243, v21, v21
  s_waitcnt lgkmcnt(4)
  v_mfma_f32_32x32x16_bf16 v[64:79], a[248:251], v[232:235], v[64:79]
  ds_read_b64_tr_b16 a[248:249], v245 offset:9216
  ds_read_b64_tr_b16 a[250:251], v245 offset:9472
  buffer_load_dwordx4 v255, s[4:7], s43 offen offset:1024 sc1 lds
  v_add_f32 v240, v240, v22
  v_fmac_f32 v241, v22, v22
  v_add_f32 v242, v242, v23
  v_fmac_f32 v243, v23, v23
  v_mfma_f32_32x32x16_bf16 v[64:79], a[252:255], v[236:239], v[64:79]
  ds_read_b64_tr_b16 a[252:253], v245 offset:9728
  ds_read_b64_tr_b16 a[254:255], v245 offset:9984
  v_add_f32 v240, v240, v24
  v_fmac_f32 v241, v24, v24
  v_add_f32 v242, v242, v25
  v_fmac_f32 v243, v25, v25
  s_waitcnt vmcnt(10)
  s_barrier
  s_waitcnt lgkmcnt(4)
  v_mfma_f32_32x32x16_bf16 v[80:95], a[240:243], a[224:227], v[80:95]
  ds_read_b64_tr_b16 a[240:241], v244 offset:12288
  ds_read_b64_tr_b16 a[242:243], v244 offset:12544
  buffer_load_dwordx4 v255, s[4:7], s43 offen offset:2048 sc1 lds
  v_add_f32 v240, v240, v26
  v_fmac_f32 v241, v26, v26
  v_add_f32 v242, v242, v27
  v_fmac_f32 v243, v27, v27
  v_mfma_f32_32x32x16_bf16 v[80:95], a[244:247], a[228:231], v[80:95]
  ds_read_b64_tr_b16 a[244:245], v244 offset:12800
  ds_read_b64_tr_b16 a[246:247], v244 offset:13056
  v_add_f32 v240, v240, v28
  v_fmac_f32 v241, v28, v28
  v_add_f32 v242, v242, v29
  v_fmac_f32 v243, v29, v29
  s_waitcnt lgkmcnt(4)
  v_mfma_f32_32x32x16_bf16 v[80:95], a[248:251], a[232:235], v[80:95]
  ds_read_b64_tr_b16 a[248:249], v244 offset:13312
  ds_read_b64_tr_b16 a[250:251], v244 offset:13568
  buffer_load_dwordx4 v255, s[4:7], s43 offen offset:3072 sc1 lds
  s_cmp_eq_u32 s26, 0
  s_cselect_b32 s88, -1, 0
  v_cndmask_b32_e64 v64, v64, v250, s[88:89]
  v_mov_b32 v250, v96
  v_add_f32 v240, v240, v30
  v_fmac_f32 v241, v30, v30
  v_add_f32 v242, v242, v31
  v_fmac_f32 v243, v31, v31
  v_mfma_f32_32x32x16_bf16 v[80:95], a[252:255], a[236:239], v[80:95]
  ds_read_b64_tr_b16 a[252:253], v244 offset:13824
  ds_read_b64_tr_b16 a[254:255], v244 offset:14080
  v_add_f32 v240, v240, v242
  v_add_f32 v241, v241, v243
  v_mov_b32 v242, v240
  v_mov_b32 v243, v241
  s_waitcnt lgkmcnt(4)
  v_mfma_f32_32x32x16_bf16 v[96:111], a[240:243], v[224:227], v[96:111]
  ds_read_b64_tr_b16 a[240:241], v245 offset:12288
  ds_read_b64_tr_b16 a[242:243], v245 offset:12544
  s_add_u32 m0, s85, 0
  s_add_u32 s43, s32, 32768
  buffer_load_dwordx4 v255, s[4:7], s43 offen offset:0 sc1 lds
  s_lshl_b32 s96, s67, 2
  s_add_u32 s96, s96, s64
  s_lshl_b32 s96, s96, 12
  s_add_u32 s96, s96, 28573696
  v_permlane32_swap_b32 v240, v242
  v_permlane32_swap_b32 v241, v243
  v_mfma_f32_32x32x16_bf16 v[96:111], a[244:247], v[228:231], v[96:111]
  ds_read_b64_tr_b16 a[244:245], v245 offset:12800
  ds_read_b64_tr_b16 a[246:247], v245 offset:13056
  v_add_f32 v240, v240, v242
  v_add_f32 v241, v241, v243
  v_mov_b32 v242, s38
  v_mov_b32 v243, s39
  s_waitcnt lgkmcnt(4)
  v_mfma_f32_32x32x16_bf16 v[96:111], a[248:251], v[232:235], v[96:111]
  ds_read_b64_tr_b16 a[248:249], v245 offset:13312
  ds_read_b64_tr_b16 a[250:251], v245 offset:13568
  buffer_load_dwordx4 v255, s[4:7], s43 offen offset:1024 sc1 lds
  s_lshl_b32 s40, s65, 9
  s_add_u32 s40, s40, s96
  s_mov_b64 exec, s[78:79]
  buffer_store_dwordx4 v[240:243], v255, s[4:7], s40 offen sc1
  s_mov_b64 exec, -1
  v_cvt_pk_bf16_f32 v0, v0, v1
  v_cvt_pk_bf16_f32 v1, v2, v3
  v_mfma_f32_32x32x16_bf16 v[96:111], a[252:255], v[236:239], v[96:111]
  ds_read_b64_tr_b16 a[252:253], v245 offset:13824
  ds_read_b64_tr_b16 a[254:255], v245 offset:14080
  v_cvt_pk_bf16_f32 v2, v4, v5
  v_cvt_pk_bf16_f32 v3, v6, v7
  v_cvt_pk_bf16_f32 v4, v8, v9
  v_cvt_pk_bf16_f32 v5, v10, v11
  s_waitcnt vmcnt(11)
  s_barrier
  s_waitcnt lgkmcnt(4)
  v_mfma_f32_32x32x16_bf16 v[112:127], a[240:243], a[224:227], v[112:127]
  ds_read_b64_tr_b16 a[240:241], v244 offset:16384
  ds_read_b64_tr_b16 a[242:243], v244 offset:16640
  buffer_load_dwordx4 v255, s[4:7], s43 offen offset:2048 sc1 lds
  v_cvt_pk_bf16_f32 v6, v12, v13
  v_cvt_pk_bf16_f32 v7, v14, v15
  v_cvt_pk_bf16_f32 v8, v16, v17
  v_cvt_pk_bf16_f32 v9, v18, v19
  v_mfma_f32_32x32x16_bf16 v[112:127], a[244:247], a[228:231], v[112:127]
  ds_read_b64_tr_b16 a[244:245], v244 offset:16896
  ds_read_b64_tr_b16 a[246:247], v244 offset:17152
  v_cvt_pk_bf16_f32 v10, v20, v21
  v_cvt_pk_bf16_f32 v11, v22, v23
  v_cvt_pk_bf16_f32 v12, v24, v25
  v_cvt_pk_bf16_f32 v13, v26, v27
  s_waitcnt lgkmcnt(4)
  v_mfma_f32_32x32x16_bf16 v[112:127], a[248:251], a[232:235], v[112:127]
  ds_read_b64_tr_b16 a[248:249], v244 offset:17408
  ds_read_b64_tr_b16 a[250:251], v244 offset:17664
  buffer_load_dwordx4 v255, s[4:7], s43 offen offset:3072 sc1 lds
  s_cmp_eq_u32 s27, 0
  s_cselect_b32 s88, -1, 0
  v_cndmask_b32_e64 v96, v96, v250, s[88:89]
  v_mov_b32 v250, v128
  v_cvt_pk_bf16_f32 v14, v28, v29
  v_cvt_pk_bf16_f32 v15, v30, v31
  ds_write_b128 v246, v[0:3] offset:0
  ds_write_b128 v246, v[4:7] offset:1024
  v_mfma_f32_32x32x16_bf16 v[112:127], a[252:255], a[236:239], v[112:127]
  ds_read_b64_tr_b16 a[252:253], v244 offset:17920
  ds_read_b64_tr_b16 a[254:255], v244 offset:18176
  ds_write_b128 v246, v[8:11] offset:2048
  ds_write_b128 v246, v[12:15] offset:3072
  v_cvt_pk_bf16_f32 v16, v32, v33
  v_cvt_pk_bf16_f32 v17, v34, v35
  s_waitcnt lgkmcnt(8)
  v_mfma_f32_32x32x16_bf16 v[128:143], a[240:243], v[224:227], v[128:143]
  ds_read_b64_tr_b16 a[240:241], v245 offset:16384
  ds_read_b64_tr_b16 a[242:243], v245 offset:16640
  s_add_u32 m0, s85, 4096
  s_add_u32 s43, s32, 49152
  buffer_load_dwordx4 v255, s[4:7], s43 offen offset:0 sc1 lds
  v_cvt_pk_bf16_f32 v18, v36, v37
  v_cvt_pk_bf16_f32 v19, v38, v39
  v_cvt_pk_bf16_f32 v20, v40, v41
  v_cvt_pk_bf16_f32 v21, v42, v43
  v_mfma_f32_32x32x16_bf16 v[128:143], a[244:247], v[228:231], v[128:143]
  ds_read_b64_tr_b16 a[244:245], v245 offset:16896
  ds_read_b64_tr_b16 a[246:247], v245 offset:17152
  v_cvt_pk_bf16_f32 v22, v44, v45
  v_cvt_pk_bf16_f32 v23, v46, v47
  v_cvt_pk_bf16_f32 v24, v48, v49
  v_cvt_pk_bf16_f32 v25, v50, v51
  s_waitcnt lgkmcnt(6)
  v_mfma_f32_32x32x16_bf16 v[128:143], a[248:251], v[232:235], v[128:143]
  ds_read_b64_tr_b16 a[248:249], v245 offset:17408
  ds_read_b64_tr_b16 a[250:251], v245 offset:17664
  buffer_load_dwordx4 v255, s[4:7], s43 offen offset:1024 sc1 lds
  v_cvt_pk_bf16_f32 v26, v52, v53
  v_cvt_pk_bf16_f32 v27, v54, v55
  v_cvt_pk_bf16_f32 v28, v56, v57
  v_cvt_pk_bf16_f32 v29, v58, v59
  v_mfma_f32_32x32x16_bf16 v[128:143], a[252:255], v[236:239], v[128:143]
  ds_read_b64_tr_b16 a[252:253], v245 offset:17920
  ds_read_b64_tr_b16 a[254:255], v245 offset:18176
  v_cvt_pk_bf16_f32 v30, v60, v61
  v_cvt_pk_bf16_f32 v31, v62, v63
  v_cvt_pk_bf16_f32 v32, v64, v65
  v_cvt_pk_bf16_f32 v33, v66, v67
  s_waitcnt vmcnt(11)
  s_barrier
  s_waitcnt lgkmcnt(4)
  v_mfma_f32_32x32x16_bf16 v[144:159], a[240:243], a[224:227], v[144:159]
  ds_read_b64_tr_b16 a[240:241], v244 offset:20480
  ds_read_b64_tr_b16 a[242:243], v244 offset:20736
  buffer_load_dwordx4 v255, s[4:7], s43 offen offset:2048 sc1 lds
  v_cvt_pk_bf16_f32 v34, v68, v69
  v_cvt_pk_bf16_f32 v35, v70, v71
  v_cvt_pk_bf16_f32 v36, v72, v73
  v_cvt_pk_bf16_f32 v37, v74, v75
  v_mfma_f32_32x32x16_bf16 v[144:159], a[244:247], a[228:231], v[144:159]
  ds_read_b64_tr_b16 a[244:245], v244 offset:20992
  ds_read_b64_tr_b16 a[246:247], v244 offset:21248
  v_cvt_pk_bf16_f32 v38, v76, v77
  v_cvt_pk_bf16_f32 v39, v78, v79
  v_cvt_pk_bf16_f32 v40, v80, v81
  v_cvt_pk_bf16_f32 v41, v82, v83
  s_waitcnt lgkmcnt(4)
  v_mfma_f32_32x32x16_bf16 v[144:159], a[248:251], a[232:235], v[144:159]
  ds_read_b64_tr_b16 a[248:249], v244 offset:21504
  ds_read_b64_tr_b16 a[250:251], v244 offset:21760
  buffer_load_dwordx4 v255, s[4:7], s43 offen offset:3072 sc1 lds
  s_cmp_eq_u32 s28, 0
  s_cselect_b32 s88, -1, 0
  v_cndmask_b32_e64 v128, v128, v250, s[88:89]
  v_mov_b32 v250, v160
  v_cvt_pk_bf16_f32 v42, v84, v85
  v_cvt_pk_bf16_f32 v43, v86, v87
  v_cvt_pk_bf16_f32 v44, v88, v89
  v_cvt_pk_bf16_f32 v45, v90, v91
  v_mfma_f32_32x32x16_bf16 v[144:159], a[252:255], a[236:239], v[144:159]
  ds_read_b64_tr_b16 a[252:253], v244 offset:22016
  ds_read_b64_tr_b16 a[254:255], v244 offset:22272
  v_cvt_pk_bf16_f32 v46, v92, v93
  v_cvt_pk_bf16_f32 v47, v94, v95
  v_cvt_pk_bf16_f32 v48, v96, v97
  v_cvt_pk_bf16_f32 v49, v98, v99
  s_waitcnt lgkmcnt(4)
  v_mfma_f32_32x32x16_bf16 v[160:175], a[240:243], v[224:227], v[160:175]
  ds_read_b64_tr_b16 a[240:241], v245 offset:20480
  ds_read_b64_tr_b16 a[242:243], v245 offset:20736
  s_add_u32 m0, s85, 8192
  s_add_u32 s43, s32, 65536
  buffer_load_dwordx4 v255, s[4:7], s43 offen offset:0 sc1 lds
  v_cvt_pk_bf16_f32 v50, v100, v101
  v_cvt_pk_bf16_f32 v51, v102, v103
  v_cvt_pk_bf16_f32 v52, v104, v105
  v_cvt_pk_bf16_f32 v53, v106, v107
  v_mfma_f32_32x32x16_bf16 v[160:175], a[244:247], v[228:231], v[160:175]
  ds_read_b64_tr_b16 a[244:245], v245 offset:20992
  ds_read_b64_tr_b16 a[246:247], v245 offset:21248
  v_cvt_pk_bf16_f32 v54, v108, v109
  v_cvt_pk_bf16_f32 v55, v110, v111
  v_cvt_pk_bf16_f32 v56, v112, v113
  v_cvt_pk_bf16_f32 v57, v114, v115
  s_waitcnt lgkmcnt(4)
  v_mfma_f32_32x32x16_bf16 v[160:175], a[248:251], v[232:235], v[160:175]
  ds_read_b64_tr_b16 a[248:249], v245 offset:21504
  ds_read_b64_tr_b16 a[250:251], v245 offset:21760
  buffer_load_dwordx4 v255, s[4:7], s43 offen offset:1024 sc1 lds
  v_cvt_pk_bf16_f32 v58, v116, v117
  v_cvt_pk_bf16_f32 v59, v118, v119
  v_cvt_pk_bf16_f32 v60, v120, v121
  v_cvt_pk_bf16_f32 v61, v122, v123
  v_mfma_f32_32x32x16_bf16 v[160:175], a[252:255], v[236:239], v[160:175]
  ds_read_b64_tr_b16 a[252:253], v245 offset:22016
  ds_read_b64_tr_b16 a[254:255], v245 offset:22272
  v_cvt_pk_bf16_f32 v62, v124, v125
  v_cvt_pk_bf16_f32 v63, v126, v127
  v_cvt_pk_bf16_f32 v64, v128, v129
  v_cvt_pk_bf16_f32 v65, v130, v131
  s_waitcnt vmcnt(11)
  s_barrier
  s_waitcnt lgkmcnt(4)
  v_mfma_f32_32x32x16_bf16 v[176:191], a[240:243], a[224:227], v[176:191]
  ds_read_b64_tr_b16 a[240:241], v244 offset:24576
  ds_read_b64_tr_b16 a[242:243], v244 offset:24832
  buffer_load_dwordx4 v255, s[4:7], s43 offen offset:2048 sc1 lds
  v_cvt_pk_bf16_f32 v66, v132, v133
  v_cvt_pk_bf16_f32 v67, v134, v135
  v_cvt_pk_bf16_f32 v68, v136, v137
  v_cvt_pk_bf16_f32 v69, v138, v139
  v_mfma_f32_32x32x16_bf16 v[176:191], a[244:247], a[228:231], v[176:191]
  ds_read_b64_tr_b16 a[244:245], v244 offset:25088
  ds_read_b64_tr_b16 a[246:247], v244 offset:25344
  v_cvt_pk_bf16_f32 v70, v140, v141
  v_cvt_pk_bf16_f32 v71, v142, v143
  v_cvt_pk_bf16_f32 v72, v144, v145
  v_cvt_pk_bf16_f32 v73, v146, v147
  s_waitcnt lgkmcnt(4)
  v_mfma_f32_32x32x16_bf16 v[176:191], a[248:251], a[232:235], v[176:191]
  ds_read_b64_tr_b16 a[248:249], v244 offset:25600
  ds_read_b64_tr_b16 a[250:251], v244 offset:25856
  buffer_load_dwordx4 v255, s[4:7], s43 offen offset:3072 sc1 lds
  s_cmp_eq_u32 s29, 0
  s_cselect_b32 s88, -1, 0
  v_cndmask_b32_e64 v160, v160, v250, s[88:89]
  v_mov_b32 v250, v192
  v_cvt_pk_bf16_f32 v74, v148, v149
  v_cvt_pk_bf16_f32 v75, v150, v151
  v_cvt_pk_bf16_f32 v76, v152, v153
  v_cvt_pk_bf16_f32 v77, v154, v155
  v_mfma_f32_32x32x16_bf16 v[176:191], a[252:255], a[236:239], v[176:191]
  ds_read_b64_tr_b16 a[252:253], v244 offset:26112
  ds_read_b64_tr_b16 a[254:255], v244 offset:26368
  v_cvt_pk_bf16_f32 v78, v156, v157
  v_cvt_pk_bf16_f32 v79, v158, v159
  s_waitcnt lgkmcnt(4)
  v_mfma_f32_32x32x16_bf16 v[192:207], a[240:243], v[224:227], v[192:207]
  ds_read_b64_tr_b16 a[240:241], v245 offset:24576
  ds_read_b64_tr_b16 a[242:243], v245 offset:24832
  s_add_u32 m0, s85, 12288
  s_add_u32 s43, s32, 81920
  buffer_load_dwordx4 v255, s[4:7], s43 offen offset:0 sc1 lds
  v_mfma_f32_32x32x16_bf16 v[192:207], a[244:247], v[228:231], v[192:207]
  ds_read_b64_tr_b16 a[244:245], v245 offset:25088
  ds_read_b64_tr_b16 a[246:247], v245 offset:25344
  s_waitcnt lgkmcnt(4)
  v_mfma_f32_32x32x16_bf16 v[192:207], a[248:251], v[232:235], v[192:207]
  ds_read_b64_tr_b16 a[248:249], v245 offset:25600
  ds_read_b64_tr_b16 a[250:251], v245 offset:25856
  buffer_load_dwordx4 v255, s[4:7], s43 offen offset:1024 sc1 lds
  v_mfma_f32_32x32x16_bf16 v[192:207], a[252:255], v[236:239], v[192:207]
  ds_read_b64_tr_b16 a[252:253], v245 offset:26112
  ds_read_b64_tr_b16 a[254:255], v245 offset:26368
  s_barrier
  s_waitcnt lgkmcnt(4)
  v_mfma_f32_32x32x16_bf16 v[208:223], a[240:243], a[224:227], v[208:223]
  buffer_load_dwordx4 v255, s[4:7], s43 offen offset:2048 sc1 lds
  v_mov_b32 v156, 0
  v_mov_b32 v157, 0
  v_mov_b32 v158, s38
  v_mov_b32 v159, s39
  v_mfma_f32_32x32x16_bf16 v[208:223], a[244:247], a[228:231], v[208:223]
  buffer_load_dwordx4 v[144:147], v255, s[4:7], s96 offen offset:0 sc1
  buffer_load_dwordx4 v[148:151], v255, s[4:7], s96 offen offset:1024 sc1
  buffer_load_dwordx4 v[152:155], v255, s[4:7], s96 offen offset:2048 sc1
  s_mov_b64 exec, s[78:79]
  buffer_load_dwordx4 v[156:159], v255, s[4:7], s96 offen offset:3072 sc1
  s_mov_b64 exec, -1
  s_waitcnt lgkmcnt(0)
  v_mfma_f32_32x32x16_bf16 v[208:223], a[248:251], a[232:235], v[208:223]
  buffer_load_dwordx4 v255, s[4:7], s43 offen offset:3072 sc1 lds
  s_cmp_eq_u32 s30, 0
  s_cselect_b32 s88, -1, 0
  v_cndmask_b32_e64 v192, v192, v250, s[88:89]
  v_mfma_f32_32x32x16_bf16 v[208:223], a[252:255], a[236:239], v[208:223]
  v_add_u32 v244, 0x10000, v255
  v_add_u32 v245, 0x20000, v255
  ds_read_b128 a[224:227], v244 offset:53248
  ds_read_b128 a[228:231], v244 offset:54272
  ds_read_b128 a[232:235], v244 offset:55296
  ds_read_b128 a[236:239], v244 offset:56320
  ds_read_b128 a[240:243], v244 offset:57344
  ds_read_b128 a[244:247], v244 offset:58368
  s_waitcnt lgkmcnt(4)
  v_mfma_f32_32x32x16_bf16 v[112:127], a[224:227], v[0:3], 0
  ds_read_b128 a[248:251], v244 offset:59392
  v_mfma_f32_32x32x16_bf16 v[112:127], a[228:231], v[4:7], v[112:127]
  ds_read_b128 a[252:255], v244 offset:60416
  s_add_u32 m0, s85, 16384
  s_add_u32 s43, s32, 98304
  buffer_load_dwordx4 v255, s[4:7], s43 offen offset:0 sc1 lds
  s_waitcnt lgkmcnt(4)
  v_mfma_f32_32x32x16_bf16 v[112:127], a[232:235], v[8:11], v[112:127]
  ds_read_b128 a[224:227], v244 offset:61440
  buffer_load_dwordx4 v255, s[4:7], s43 offen offset:1024 sc1 lds
  v_cvt_pk_bf16_f32 v80, v160, v161
  v_cvt_pk_bf16_f32 v81, v162, v163
  v_mfma_f32_32x32x16_bf16 v[112:127], a[236:239], v[12:15], v[112:127]
  ds_read_b128 a[228:231], v244 offset:62464
  buffer_load_dwordx4 v255, s[4:7], s43 offen offset:2048 sc1 lds
  v_cvt_pk_bf16_f32 v82, v164, v165
  s_waitcnt lgkmcnt(4)
  v_mfma_f32_32x32x16_bf16 v[112:127], a[240:243], v[16:19], v[112:127]
  ds_read_b128 a[232:235], v244 offset:63488
  v_cvt_pk_bf16_f32 v83, v166, v167
  v_cvt_pk_bf16_f32 v84, v168, v169
  v_cvt_pk_bf16_f32 v85, v170, v171
  v_cvt_pk_bf16_f32 v86, v172, v173
  v_cvt_pk_bf16_f32 v87, v174, v175
  v_mfma_f32_32x32x16_bf16 v[112:127], a[244:247], v[20:23], v[112:127]
  ds_read_b128 a[236:239], v244 offset:64512
  v_cvt_pk_bf16_f32 v88, v176, v177
  v_cvt_pk_bf16_f32 v89, v178, v179
  v_cvt_pk_bf16_f32 v90, v180, v181
  v_cvt_pk_bf16_f32 v91, v182, v183
  s_waitcnt lgkmcnt(4)
  v_mfma_f32_32x32x16_bf16 v[112:127], a[248:251], v[24:27], v[112:127]
  ds_read_b128 a[240:243], v245 offset:0
  buffer_load_dwordx4 v255, s[4:7], s43 offen offset:3072 sc1 lds
  v_cvt_pk_bf16_f32 v92, v184, v185
  v_cvt_pk_bf16_f32 v93, v186, v187
  v_mfma_f32_32x32x16_bf16 v[112:127], a[252:255], v[28:31], v[112:127]
  ds_read_b128 a[244:247], v245 offset:1024
  v_cvt_pk_bf16_f32 v94, v188, v189
  v_cvt_pk_bf16_f32 v95, v190, v191
  v_cvt_pk_bf16_f32 v96, v192, v193
  v_cvt_pk_bf16_f32 v97, v194, v195
  s_waitcnt lgkmcnt(4)
  v_mfma_f32_32x32x16_bf16 v[112:127], a[224:227], v[32:35], v[112:127]
  ds_read_b128 a[248:251], v245 offset:2048
  v_cvt_pk_bf16_f32 v98, v196, v197
  v_cvt_pk_bf16_f32 v99, v198, v199
  v_cvt_pk_bf16_f32 v100, v200, v201
  v_cvt_pk_bf16_f32 v101, v202, v203
  v_cvt_pk_bf16_f32 v102, v204, v205
  v_mfma_f32_32x32x16_bf16 v[112:127], a[228:231], v[36:39], v[112:127]
  ds_read_b128 a[252:255], v245 offset:3072
  v_cvt_pk_bf16_f32 v103, v206, v207
  v_cvt_pk_bf16_f32 v104, v208, v209
  v_cvt_pk_bf16_f32 v105, v210, v211
  v_cvt_pk_bf16_f32 v106, v212, v213
  s_waitcnt lgkmcnt(4)
  v_mfma_f32_32x32x16_bf16 v[112:127], a[232:235], v[40:43], v[112:127]
  ds_read_b128 a[224:227], v245 offset:4096
  s_add_u32 m0, s85, 20480
  s_add_u32 s43, s32, 114688
  buffer_load_dwordx4 v255, s[4:7], s43 offen offset:0 sc1 lds
  v_mfma_f32_32x32x16_bf16 v[112:127], a[236:239], v[44:47], v[112:127]
  ds_read_b128 a[228:231], v245 offset:5120
  v_cvt_pk_bf16_f32 v107, v214, v215
  v_cvt_pk_bf16_f32 v108, v216, v217
  v_cvt_pk_bf16_f32 v109, v218, v219
  v_cvt_pk_bf16_f32 v110, v220, v221
  s_waitcnt lgkmcnt(4)
  v_mfma_f32_32x32x16_bf16 v[112:127], a[240:243], v[48:51], v[112:127]
  ds_read_b128 a[232:235], v245 offset:6144
  buffer_load_dwordx4 v255, s[4:7], s43 offen offset:1024 sc1 lds
  v_cvt_pk_bf16_f32 v111, v222, v223
  v_mfma_f32_32x32x16_bf16 v[112:127], a[244:247], v[52:55], v[112:127]
  ds_read_b128 a[236:239], v245 offset:7168
  s_waitcnt lgkmcnt(4)
  v_mfma_f32_32x32x16_bf16 v[112:127], a[248:251], v[56:59], v[112:127]
  ds_read_b128 a[240:243], v245 offset:8192
  v_mfma_f32_32x32x16_bf16 v[112:127], a[252:255], v[60:63], v[112:127]
  ds_read_b128 a[244:247], v245 offset:9216
  buffer_load_dwordx4 v255, s[4:7], s43 offen offset:2048 sc1 lds
  s_waitcnt lgkmcnt(4)
  v_mfma_f32_32x32x16_bf16 v[112:127], a[224:227], v[64:67], v[112:127]
  ds_read_b128 a[248:251], v245 offset:10240
  v_add_u32 v242, s51, v255
  v_add_u32 v246, s54, v255
  v_mfma_f32_32x32x16_bf16 v[112:127], a[228:231], v[68:71], v[112:127]
  ds_read_b128 a[252:255], v245 offset:11264
  s_waitcnt vmcnt(11)
  v_cmp_ne_u64 vcc, v[146:147], s[38:39]
  s_waitcnt vmcnt(10)
  v_cmp_ne_u64 s[88:89], v[150:151], s[38:39]
  s_waitcnt vmcnt(9)
  v_cmp_ne_u64 s[92:93], v[154:155], s[38:39]
  s_waitcnt vmcnt(8)
  v_cmp_ne_u64 s[94:95], v[158:159], s[38:39]
  s_or_b64 s[88:89], s[88:89], vcc
  s_branch L_over8
L_pad8:
  s_branch L_ret_F
L_over8:
  s_or_b64 s[92:93], s[92:93], s[94:95]
  s_or_b64 s[88:89], s[88:89], s[92:93]
  s_cbranch_scc1 SLOW_105
BACK_106:
  s_waitcnt lgkmcnt(4)
  v_mfma_f32_32x32x16_bf16 v[112:127], a[232:235], v[72:75], v[112:127]
  ds_read_b128 a[224:227], v245 offset:12288
  v_add_f32 v144, v144, v148
  v_add_f32 v145, v145, v149
  v_add_f32 v152, v152, v156
  v_add_f32 v153, v153, v157
  v_add_f32 v248, v144, v152
  v_mfma_f32_32x32x16_bf16 v[112:127], a[236:239], v[76:79], v[112:127]
  ds_read_b128 a[228:231], v245 offset:13312
  v_add_f32 v250, v145, v153
  v_mov_b32 v251, 0
  s_nop 0
  v_permlane32_swap_b32 v248, v250
  s_waitcnt lgkmcnt(4)
  v_mfma_f32_32x32x16_bf16 v[112:127], a[240:243], v[80:83], v[112:127]
  ds_read_b128 a[232:235], v245 offset:14336
  v_add_f32 v248, v248, v250
  v_mul_f32 v248, 0x3b124925, v248
  v_mov_b32 v250, v248
  s_nop 1
  v_permlane32_swap_b32 v248, v250
  v_mfma_f32_32x32x16_bf16 v[112:127], a[244:247], v[84:87], v[112:127]
  ds_read_b128 a[236:239], v245 offset:15360
  v_fma_f32 v250, -v248, v248, v250
  buffer_load_dwordx4 v255, s[4:7], s43 offen offset:3072 sc1 lds
  s_waitcnt lgkmcnt(4)
  v_mfma_f32_32x32x16_bf16 v[112:127], a[248:251], v[88:91], v[112:127]
  ds_read_b64 a[240:241], v255 offset:0
  v_cvt_pk_bf16_f32 v249, -v248, -v248
  v_max_f32 v250, 0, v250
  v_add_f32 v254, 0x3727c5ac, v250
  v_lshlrev_b32 v250, 16, v249
  v_mfma_f32_32x32x16_bf16 v[112:127], a[252:255], v[92:95], v[112:127]
  ds_read_b128 a[244:247], v245 offset:16384
  v_rsq_f32 v247, v254
  v_sub_f32 v250, -v248, v250
  v_cndmask_b32_e64 v248, 0, v249, s[78:79]
  s_waitcnt lgkmcnt(4)
  v_mfma_f32_32x32x16_bf16 v[112:127], a[224:227], v[96:99], v[112:127]
  ds_read_b128 a[248:251], v245 offset:17408
  v_cvt_pk_bf16_f32 v249, v250, v250
  v_mov_b32 v250, 0
  v_cndmask_b32_e64 v249, 0, v249, s[78:79]
  v_mul_f32 v247, 0xbfb8aa3b, v247
  v_mfma_f32_32x32x16_bf16 v[112:127], a[228:231], v[100:103], v[112:127]
  ds_read_b128 a[252:255], v245 offset:18432
  s_waitcnt lgkmcnt(4)
  v_mfma_f32_32x32x16_bf16 v[112:127], a[232:235], v[104:107], v[112:127]
  ds_read_b128 a[224:227], v245 offset:19456
  s_waitcnt vmcnt(8)
  s_barrier
  v_mfma_f32_32x32x16_bf16 v[112:127], a[236:239], v[108:111], v[112:127]
  ds_read_b128 a[228:231], v255 offset:4096
  s_waitcnt lgkmcnt(4)
  v_mfma_f32_32x32x16_bf16 v[112:127], a[240:243], v[248:251], v[112:127]
  ds_read_b128 a[232:235], v255 offset:5120
  s_add_u32 m0, s85, 24576
  s_add_u32 s43, s32, 131072
  buffer_load_dwordx4 v255, s[4:7], s43 offen offset:0 sc1 lds
  v_mfma_f32_32x32x16_bf16 v[128:143], a[244:247], v[0:3], 0
  ds_read_b128 a[236:239], v255 offset:6144
  buffer_load_dwordx4 v255, s[4:7], s43 offen offset:1024 sc1 lds
  s_waitcnt lgkmcnt(4)
  v_mfma_f32_32x32x16_bf16 v[128:143], a[248:251], v[4:7], v[128:143]
  ds_read_b128 a[240:243], v255 offset:7168
  v_mul_f32 v120, v120, v112
  v_mul_f32 v112, v247, v112
  v_exp_f32 v112, v112
  v_mul_f32 v121, v121, v113
  v_mfma_f32_32x32x16_bf16 v[128:143], a[252:255], v[8:11], v[128:143]
  ds_read_b128 a[244:247], v255 offset:32768
  v_mul_f32 v113, v247, v113
  v_fma_f32 v112, v112, v254, v254
  v_exp_f32 v113, v113
  s_waitcnt lgkmcnt(4)
  v_mfma_f32_32x32x16_bf16 v[128:143], a[224:227], v[12:15], v[128:143]
  ds_read_b128 a[248:251], v255 offset:33792
  v_rcp_f32 v112, v112
  v_mul_f32 v122, v122, v114
  v_mul_f32 v114, v247, v114
  v_fma_f32 v113, v113, v254, v254
  v_mfma_f32_32x32x16_bf16 v[128:143], a[228:231], v[16:19], v[128:143]
  ds_read_b128 a[252:255], v255 offset:34816
  v_exp_f32 v114, v114
  v_mul_f32 v120, v120, v112
  s_waitcnt lgkmcnt(4)
  v_mfma_f32_32x32x16_bf16 v[128:143], a[232:235], v[20:23], v[128:143]
  ds_read_b128 a[224:227], v255 offset:35840
  v_rcp_f32 v113, v113
  v_mul_f32 v123, v123, v115
  v_mul_f32 v115, v247, v115
  v_fma_f32 v114, v114, v254, v254
  v_mfma_f32_32x32x16_bf16 v[128:143], a[236:239], v[24:27], v[128:143]
  ds_read_b128 a[228:231], v255 offset:61440
  buffer_load_dwordx4 v255, s[4:7], s43 offen offset:2048 sc1 lds
  s_waitcnt lgkmcnt(4)
  v_mfma_f32_32x32x16_bf16 v[128:143], a[240:243], v[28:31], v[128:143]
  ds_read_b128 a[232:235], v255 offset:62464
  v_exp_f32 v115, v115
  v_mul_f32 v121, v121, v113
  v_rcp_f32 v114, v114
  v_mfma_f32_32x32x16_bf16 v[128:143], a[244:247], v[32:35], v[128:143]
  ds_read_b128 a[236:239], v255 offset:63488
  v_cvt_pk_bf16_f32 v112, v120, v121
  v_mul_f32 v124, v124, v116
  v_mul_f32 v116, v247, v116
  v_fma_f32 v115, v115, v254, v254
  s_waitcnt lgkmcnt(4)
  v_mfma_f32_32x32x16_bf16 v[128:143], a[248:251], v[36:39], v[128:143]
  ds_read_b128 a[240:243], v255 offset:64512
  v_exp_f32 v116, v116
  v_mul_f32 v122, v122, v114
  v_rcp_f32 v115, v115
  v_mfma_f32_32x32x16_bf16 v[128:143], a[252:255], v[40:43], v[128:143]
  ds_read_b128 a[244:247], v244 offset:24576
  buffer_load_dwordx4 v255, s[4:7], s43 offen offset:3072 sc1 lds
  v_or_b32 v112, 1, v112
  s_waitcnt lgkmcnt(4)
  v_mfma_f32_32x32x16_bf16 v[128:143], a[224:227], v[44:47], v[128:143]
  ds_read_b128 a[248:251], v244 offset:25600
  v_mul_f32 v125, v125, v117
  v_mul_f32 v117, v247, v117
  v_fma_f32 v116, v116, v254, v254
  v_exp_f32 v117, v117
  v_mfma_f32_32x32x16_bf16 v[128:143], a[228:231], v[48:51], v[128:143]
  ds_read_b128 a[252:255], v244 offset:26624
  v_mul_f32 v123, v123, v115
  v_rcp_f32 v116, v116
  v_cvt_pk_bf16_f32 v113, v122, v123
  s_waitcnt lgkmcnt(4)
  v_mfma_f32_32x32x16_bf16 v[128:143], a[232:235], v[52:55], v[128:143]
  ds_read_b128 a[224:227], v244 offset:27648
  v_mul_f32 v126, v126, v118
  v_mul_f32 v118, v247, v118
  v_fma_f32 v117, v117, v254, v254
  v_exp_f32 v118, v118
  v_mfma_f32_32x32x16_bf16 v[128:143], a[236:239], v[56:59], v[128:143]
  ds_read_b128 a[228:231], v255 offset:8192
  v_mul_f32 v124, v124, v116
  v_rcp_f32 v117, v117
  v_mul_f32 v127, v127, v119
  s_waitcnt lgkmcnt(4)
  v_mfma_f32_32x32x16_bf16 v[128:143], a[240:243], v[60:63], v[128:143]
  ds_read_b128 a[232:235], v255 offset:9216
  v_mul_f32 v119, v247, v119
  v_fma_f32 v118, v118, v254, v254
  v_exp_f32 v119, v119
  v_mul_f32 v125, v125, v117
  v_mfma_f32_32x32x16_bf16 v[128:143], a[244:247], v[64:67], v[128:143]
  ds_read_b128 a[236:239], v255 offset:10240
  v_rcp_f32 v118, v118
  v_cvt_pk_bf16_f32 v114, v124, v125
  v_fma_f32 v119, v119, v254, v254
  s_waitcnt lgkmcnt(4)
  v_mfma_f32_32x32x16_bf16 v[128:143], a[248:251], v[68:71], v[128:143]
  ds_read_b128 a[240:243], v255 offset:11264
  s_add_u32 m0, s33, 0
  s_add_u32 s43, s32, 147456
  buffer_load_dwordx4 v255, s[4:7], s43 offen offset:0 sc1 lds
  v_mfma_f32_32x32x16_bf16 v[128:143], a[252:255], v[72:75], v[128:143]
  ds_read_b128 a[244:247], v255 offset:36864
  v_mul_f32 v126, v126, v118
  v_rcp_f32 v119, v119
  s_nop 0
  v_mul_f32 v127, v127, v119
  s_waitcnt lgkmcnt(4)
  v_mfma_f32_32x32x16_bf16 v[128:143], a[224:227], v[76:79], v[128:143]
  ds_read_b128 a[248:251], v255 offset:37888
  v_cvt_pk_bf16_f32 v115, v126, v127
  buffer_load_dwordx4 v255, s[4:7], s43 offen offset:1024 sc1 lds
  v_mfma_f32_32x32x16_bf16 v[128:143], a[228:231], v[80:83], v[128:143]
  ds_read_b128 a[252:255], v255 offset:38912
  s_waitcnt lgkmcnt(4)
  v_mfma_f32_32x32x16_bf16 v[128:143], a[232:235], v[84:87], v[128:143]
  ds_read_b128 a[224:227], v255 offset:39936
  buffer_store_dwordx4 v[112:115], v255, s[4:7], s46 offen offset:0 sc1
  v_mfma_f32_32x32x16_bf16 v[128:143], a[236:239], v[88:91], v[128:143]
  ds_read_b64 a[228:229], v255 offset:8
  buffer_load_dwordx4 v255, s[4:7], s43 offen offset:2048 sc1 lds
  s_waitcnt lgkmcnt(4)
  v_mfma_f32_32x32x16_bf16 v[128:143], a[240:243], v[92:95], v[128:143]
  ds_read_b128 a[232:235], v244 offset:0
  s_lshl_b32 s40, s74, 12
  s_lshl_b32 s41, s73, 10
  s_add_u32 s40, s40, s41
  s_add_u32 s40, s40, 155648
  v_add_u32 v243, s40, v255
  v_mfma_f32_32x32x16_bf16 v[128:143], a[244:247], v[96:99], v[128:143]
  ds_read_b128 a[236:239], v244 offset:1024
  s_waitcnt lgkmcnt(4)
  v_mfma_f32_32x32x16_bf16 v[128:143], a[248:251], v[100:103], v[128:143]
  ds_read_b128 a[240:243], v244 offset:2048
  v_mfma_f32_32x32x16_bf16 v[128:143], a[252:255], v[104:107], v[128:143]
  ds_read_b128 a[244:247], v244 offset:3072
  buffer_load_dwordx4 v255, s[4:7], s43 offen offset:3072 sc1 lds
  s_waitcnt lgkmcnt(4)
  v_mfma_f32_32x32x16_bf16 v[128:143], a[224:227], v[108:111], v[128:143]
  ds_read_b128 a[248:251], v244 offset:28672
  v_mfma_f32_32x32x16_bf16 v[128:143], a[228:231], v[248:251], v[128:143]
  ds_read_b128 a[252:255], v244 offset:29696
  s_waitcnt lgkmcnt(4)
  v_mfma_f32_32x32x16_bf16 v[112:127], a[232:235], v[0:3], 0
  ds_read_b128 a[224:227], v244 offset:30720
  v_mfma_f32_32x32x16_bf16 v[112:127], a[236:239], v[4:7], v[112:127]
  ds_read_b128 a[228:231], v244 offset:31744
  v_mul_f32 v136, v136, v128
  v_mul_f32 v128, v247, v128
  v_exp_f32 v128, v128
  s_waitcnt lgkmcnt(4)
  v_mfma_f32_32x32x16_bf16 v[112:127], a[240:243], v[8:11], v[112:127]
  ds_read_b128 a[232:235], v255 offset:12288
  v_mul_f32 v137, v137, v129
  v_mul_f32 v129, v247, v129
  v_fma_f32 v128, v128, v254, v254
  v_exp_f32 v129, v129
  v_mfma_f32_32x32x16_bf16 v[112:127], a[244:247], v[12:15], v[112:127]
  ds_read_b128 a[236:239], v255 offset:13312
  v_rcp_f32 v128, v128
  v_mul_f32 v138, v138, v130
  v_mul_f32 v130, v247, v130
  s_waitcnt lgkmcnt(4)
  v_mfma_f32_32x32x16_bf16 v[112:127], a[248:251], v[16:19], v[112:127]
  ds_read_b128 a[240:243], v255 offset:14336
  v_fma_f32 v129, v129, v254, v254
  v_exp_f32 v130, v130
  v_mul_f32 v136, v136, v128
  v_mfma_f32_32x32x16_bf16 v[112:127], a[252:255], v[20:23], v[112:127]
  ds_read_b128 a[244:247], v255 offset:15360
  v_rcp_f32 v129, v129
  v_mul_f32 v139, v139, v131
  v_mul_f32 v131, v247, v131
  s_waitcnt lgkmcnt(4)
  v_mfma_f32_32x32x16_bf16 v[112:127], a[224:227], v[24:27], v[112:127]
  ds_read_b128 a[248:251], v255 offset:40960
  v_fma_f32 v130, v130, v254, v254
  v_exp_f32 v131, v131
  v_mul_f32 v137, v137, v129
  v_mfma_f32_32x32x16_bf16 v[112:127], a[228:231], v[28:31], v[112:127]
  ds_read_b128 a[252:255], v255 offset:41984
  v_rcp_f32 v130, v130
  v_cvt_pk_bf16_f32 v128, v136, v137
  v_mul_f32 v140, v140, v132
  s_waitcnt lgkmcnt(4)
  v_mfma_f32_32x32x16_bf16 v[112:127], a[232:235], v[32:35], v[112:127]
  ds_read_b128 a[224:227], v255 offset:43008
  v_mul_f32 v132, v247, v132
  v_fma_f32 v131, v131, v254, v254
  v_exp_f32 v132, v132
  v_mul_f32 v138, v138, v130
  v_mfma_f32_32x32x16_bf16 v[112:127], a[236:239], v[36:39], v[112:127]
  ds_read_b128 a[228:231], v255 offset:44032
  v_rcp_f32 v131, v131
  v_or_b32 v128, 1, v128
  v_mul_f32 v141, v141, v133
  s_waitcnt lgkmcnt(4)
  v_mfma_f32_32x32x16_bf16 v[112:127], a[240:243], v[40:43], v[112:127]
  ds_read_b128 a[232:235], v244 offset:4096
  v_mul_f32 v133, v247, v133
  v_fma_f32 v132, v132, v254, v254
  v_exp_f32 v133, v133
  v_mul_f32 v139, v139, v131
  v_mfma_f32_32x32x16_bf16 v[112:127], a[244:247], v[44:47], v[112:127]
  ds_read_b128 a[236:239], v244 offset:5120
  v_rcp_f32 v132, v132
  v_cvt_pk_bf16_f32 v129, v138, v139
  v_mul_f32 v142, v142, v134
  s_waitcnt lgkmcnt(4)
  v_mfma_f32_32x32x16_bf16 v[112:127], a[248:251], v[48:51], v[112:127]
  ds_read_b128 a[240:243], v244 offset:6144
  v_mul_f32 v134, v247, v134
  v_fma_f32 v133, v133, v254, v254
  v_exp_f32 v134, v134
  v_mul_f32 v140, v140, v132
  v_mfma_f32_32x32x16_bf16 v[112:127], a[252:255], v[52:55], v[112:127]
  ds_read_b128 a[244:247], v244 offset:7168
  v_rcp_f32 v133, v133
  v_mul_f32 v143, v143, v135
  v_mul_f32 v135, v247, v135
  s_waitcnt lgkmcnt(4)
  v_mfma_f32_32x32x16_bf16 v[112:127], a[224:227], v[56:59], v[112:127]
  ds_read_b128 a[248:251], v244 offset:32768
  v_fma_f32 v134, v134, v254, v254
  v_exp_f32 v135, v135
  v_mul_f32 v141, v141, v133
  v_mfma_f32_32x32x16_bf16 v[112:127], a[228:231], v[60:63], v[112:127]
  ds_read_b128 a[252:255], v244 offset:33792
  v_rcp_f32 v134, v134
  v_cvt_pk_bf16_f32 v130, v140, v141
  v_fma_f32 v135, v135, v254, v254
  s_waitcnt lgkmcnt(4)
  v_mfma_f32_32x32x16_bf16 v[112:127], a[232:235], v[64:67], v[112:127]
  ds_read_b128 a[224:227], v244 offset:34816
  v_mul_f32 v142, v142, v134
  v_rcp_f32 v135, v135
  s_nop 0
  v_mul_f32 v143, v143, v135
  v_cvt_pk_bf16_f32 v131, v142, v143
  v_mfma_f32_32x32x16_bf16 v[112:127], a[236:239], v[68:71], v[112:127]
  ds_read_b128 a[228:231], v244 offset:35840
  s_waitcnt lgkmcnt(4)
  v_mfma_f32_32x32x16_bf16 v[112:127], a[240:243], v[72:75], v[112:127]
  ds_read_b128 a[232:235], v255 offset:16384
  buffer_store_dwordx4 v[128:131], v255, s[4:7], s46 offen offset:1024 sc1
  v_mfma_f32_32x32x16_bf16 v[112:127], a[244:247], v[76:79], v[112:127]
  ds_read_b128 a[236:239], v255 offset:17408
  s_waitcnt lgkmcnt(4)
  v_mfma_f32_32x32x16_bf16 v[112:127], a[248:251], v[80:83], v[112:127]
  ds_read_b128 a[240:243], v255 offset:18432
  v_mfma_f32_32x32x16_bf16 v[112:127], a[252:255], v[84:87], v[112:127]
  ds_read_b128 a[244:247], v255 offset:19456
  s_waitcnt lgkmcnt(4)
  v_mfma_f32_32x32x16_bf16 v[112:127], a[224:227], v[88:91], v[112:127]
  ds_read_b64 a[248:249], v255 offset:1024
  v_mfma_f32_32x32x16_bf16 v[112:127], a[228:231], v[92:95], v[112:127]
  ds_read_b128 a[252:255], v255 offset:45056
  s_waitcnt lgkmcnt(4)
  v_mfma_f32_32x32x16_bf16 v[112:127], a[232:235], v[96:99], v[112:127]
  ds_read_b128 a[224:227], v255 offset:46080
  v_mfma_f32_32x32x16_bf16 v[112:127], a[236:239], v[100:103], v[112:127]
  ds_read_b128 a[228:231], v255 offset:47104
  s_waitcnt lgkmcnt(4)
  v_mfma_f32_32x32x16_bf16 v[112:127], a[240:243], v[104:107], v[112:127]
  ds_read_b128 a[232:235], v255 offset:48128
  v_mfma_f32_32x32x16_bf16 v[112:127], a[244:247], v[108:111], v[112:127]
  ds_read_b128 a[236:239], v244 offset:8192
  s_waitcnt lgkmcnt(4)
  v_mfma_f32_32x32x16_bf16 v[112:127], a[248:251], v[248:251], v[112:127]
  ds_read_b128 a[240:243], v244 offset:9216
  v_mfma_f32_32x32x16_bf16 v[128:143], a[252:255], v[0:3], 0
  ds_read_b128 a[244:247], v244 offset:10240
  s_waitcnt lgkmcnt(4)
  v_mfma_f32_32x32x16_bf16 v[128:143], a[224:227], v[4:7], v[128:143]
  ds_read_b128 a[248:251], v244 offset:11264
  v_mul_f32 v120, v120, v112
  v_mul_f32 v112, v247, v112
  v_exp_f32 v112, v112
  v_mul_f32 v121, v121, v113
  v_mfma_f32_32x32x16_bf16 v[128:143], a[228:231], v[8:11], v[128:143]
  ds_read_b128 a[252:255], v244 offset:36864
  v_mul_f32 v113, v247, v113
  v_fma_f32 v112, v112, v254, v254
  v_exp_f32 v113, v113
  s_waitcnt lgkmcnt(4)
  v_mfma_f32_32x32x16_bf16 v[128:143], a[232:235], v[12:15], v[128:143]
  ds_read_b128 a[224:227], v244 offset:37888
  v_rcp_f32 v112, v112
  v_mul_f32 v122, v122, v114
  v_mul_f32 v114, v247, v114
  v_fma_f32 v113, v113, v254, v254
  v_mfma_f32_32x32x16_bf16 v[128:143], a[236:239], v[16:19], v[128:143]
  ds_read_b128 a[228:231], v244 offset:38912
  v_exp_f32 v114, v114
  v_mul_f32 v120, v120, v112
  s_waitcnt lgkmcnt(4)
  v_mfma_f32_32x32x16_bf16 v[128:143], a[240:243], v[20:23], v[128:143]
  ds_read_b128 a[232:235], v244 offset:39936
  v_rcp_f32 v113, v113
  v_mul_f32 v123, v123, v115
  s_waitcnt vmcnt(1)
  s_barrier
  v_mfma_f32_32x32x16_bf16 v[128:143], a[244:247], v[24:27], v[128:143]
  ds_read_b128 a[236:239], v255 offset:20480
  v_mul_f32 v115, v247, v115
  v_fma_f32 v114, v114, v254, v254
  v_exp_f32 v115, v115
  s_waitcnt lgkmcnt(4)
  v_mfma_f32_32x32x16_bf16 v[128:143], a[248:251], v[28:31], v[128:143]
  ds_read_b128 a[240:243], v255 offset:21504
  s_add_u32 m0, s33, 16384
  s_add_u32 s43, s32, 163840
  buffer_load_dwordx4 v255, s[4:7], s43 offen offset:0 sc1 lds
  v_mfma_f32_32x32x16_bf16 v[128:143], a[252:255], v[32:35], v[128:143]
  ds_read_b128 a[244:247], v255 offset:22528
  buffer_load_dwordx4 v255, s[4:7], s43 offen offset:1024 sc1 lds
  v_mul_f32 v121, v121, v113
  s_waitcnt lgkmcnt(4)
  v_mfma_f32_32x32x16_bf16 v[128:143], a[224:227], v[36:39], v[128:143]
  ds_read_b128 a[248:251], v255 offset:23552
  buffer_load_dwordx4 v255, s[4:7], s43 offen offset:2048 sc1 lds
  v_rcp_f32 v114, v114
  v_mfma_f32_32x32x16_bf16 v[128:143], a[228:231], v[40:43], v[128:143]
  ds_read_b128 a[252:255], v255 offset:49152
  v_cvt_pk_bf16_f32 v112, v120, v121
  v_mul_f32 v124, v124, v116
  v_mul_f32 v116, v247, v116
  v_fma_f32 v115, v115, v254, v254
  s_waitcnt lgkmcnt(4)
  v_mfma_f32_32x32x16_bf16 v[128:143], a[232:235], v[44:47], v[128:143]
  ds_read_b128 a[224:227], v255 offset:50176
  buffer_load_dwordx4 v255, s[4:7], s43 offen offset:3072 sc1 lds
  v_exp_f32 v116, v116
  v_mfma_f32_32x32x16_bf16 v[128:143], a[236:239], v[48:51], v[128:143]
  ds_read_b128 a[228:231], v255 offset:51200
  v_mul_f32 v122, v122, v114
  v_rcp_f32 v115, v115
  v_or_b32 v112, 1, v112
  s_waitcnt lgkmcnt(4)
  v_mfma_f32_32x32x16_bf16 v[128:143], a[240:243], v[52:55], v[128:143]
  ds_read_b128 a[232:235], v255 offset:52224
  s_add_u32 m0, s85, 0
  s_add_u32 s43, s32, 180224
  buffer_load_dwordx4 v255, s[4:7], s43 offen offset:0 sc1 lds
  v_mfma_f32_32x32x16_bf16 v[128:143], a[244:247], v[56:59], v[128:143]
  ds_read_b128 a[236:239], v244 offset:12288
  v_mul_f32 v125, v125, v117
  v_mul_f32 v117, v247, v117
  v_fma_f32 v116, v116, v254, v254
  s_waitcnt lgkmcnt(4)
  v_mfma_f32_32x32x16_bf16 v[128:143], a[248:251], v[60:63], v[128:143]
  ds_read_b128 a[240:243], v244 offset:13312
  buffer_load_dwordx4 v255, s[4:7], s43 offen offset:1024 sc1 lds
  v_exp_f32 v117, v117
  v_mfma_f32_32x32x16_bf16 v[128:143], a[252:255], v[64:67], v[128:143]
  ds_read_b128 a[244:247], v244 offset:14336
  v_mul_f32 v123, v123, v115
  v_rcp_f32 v116, v116
  v_cvt_pk_bf16_f32 v113, v122, v123
  s_waitcnt lgkmcnt(4)
  v_mfma_f32_32x32x16_bf16 v[128:143], a[224:227], v[68:71], v[128:143]
  ds_read_b128 a[248:251], v244 offset:15360
  v_mul_f32 v126, v126, v118
  v_mul_f32 v118, v247, v118
  v_fma_f32 v117, v117, v254, v254
  v_exp_f32 v118, v118
  v_mfma_f32_32x32x16_bf16 v[128:143], a[228:231], v[72:75], v[128:143]
  ds_read_b128 a[252:255], v244 offset:40960
  v_mul_f32 v124, v124, v116
  buffer_load_dwordx4 v255, s[4:7], s43 offen offset:2048 sc1 lds
  s_waitcnt lgkmcnt(4)
  v_mfma_f32_32x32x16_bf16 v[128:143], a[232:235], v[76:79], v[128:143]
  ds_read_b128 a[224:227], v244 offset:41984
  v_rcp_f32 v117, v117
  v_mul_f32 v127, v127, v119
  v_mul_f32 v119, v247, v119
  v_fma_f32 v118, v118, v254, v254
  v_mfma_f32_32x32x16_bf16 v[128:143], a[236:239], v[80:83], v[128:143]
  ds_read_b128 a[228:231], v244 offset:43008
  v_exp_f32 v119, v119
  v_mul_f32 v125, v125, v117
  s_waitcnt lgkmcnt(4)
  v_mfma_f32_32x32x16_bf16 v[128:143], a[240:243], v[84:87], v[128:143]
  ds_read_b128 a[232:235], v244 offset:44032
  buffer_load_dwordx4 v255, s[4:7], s43 offen offset:3072 sc1 lds
  v_rcp_f32 v118, v118
  v_mfma_f32_32x32x16_bf16 v[128:143], a[244:247], v[88:91], v[128:143]
  ds_read_b64 a[236:237], v255 offset:1032
  v_cvt_pk_bf16_f32 v114, v124, v125
  v_fma_f32 v119, v119, v254, v254
  v_mul_f32 v126, v126, v118
  s_waitcnt lgkmcnt(4)
  v_mfma_f32_32x32x16_bf16 v[128:143], a[248:251], v[92:95], v[128:143]
  ds_read_b128 a[240:243], v255 offset:24576
  v_rcp_f32 v119, v119
  s_nop 0
  v_mul_f32 v127, v127, v119
  v_cvt_pk_bf16_f32 v115, v126, v127
  v_mfma_f32_32x32x16_bf16 v[128:143], a[252:255], v[96:99], v[128:143]
  ds_read_b128 a[244:247], v255 offset:25600
  s_waitcnt lgkmcnt(4)
  v_mfma_f32_32x32x16_bf16 v[128:143], a[224:227], v[100:103], v[128:143]
  ds_read_b128 a[248:251], v255 offset:26624
  s_add_u32 m0, s85, 4096
  s_add_u32 s43, s32, 196608
  buffer_load_dwordx4 v255, s[4:7], s43 offen offset:0 sc1 lds
  v_mfma_f32_32x32x16_bf16 v[128:143], a[228:231], v[104:107], v[128:143]
  ds_read_b128 a[252:255], v255 offset:27648
  buffer_load_dwordx4 v255, s[4:7], s43 offen offset:1024 sc1 lds
  s_waitcnt lgkmcnt(4)
  v_mfma_f32_32x32x16_bf16 v[128:143], a[232:235], v[108:111], v[128:143]
  ds_read_b128 a[224:227], v255 offset:53248
  buffer_store_dwordx4 v[112:115], v255, s[4:7], s46 offen offset:2048 sc1
  v_mfma_f32_32x32x16_bf16 v[128:143], a[236:239], v[248:251], v[128:143]
  ds_read_b128 a[228:231], v255 offset:54272
  s_waitcnt lgkmcnt(4)
  v_mfma_f32_32x32x16_bf16 v[112:127], a[240:243], v[0:3], 0
  ds_read_b128 a[232:235], v255 offset:55296
  buffer_load_dwordx4 v255, s[4:7], s43 offen offset:2048 sc1 lds
  v_mfma_f32_32x32x16_bf16 v[112:127], a[244:247], v[4:7], v[112:127]
  ds_read_b128 a[236:239], v255 offset:56320
  v_mul_f32 v136, v136, v128
  v_mul_f32 v128, v247, v128
  v_exp_f32 v128, v128
  s_waitcnt lgkmcnt(4)
  v_mfma_f32_32x32x16_bf16 v[112:127], a[248:251], v[8:11], v[112:127]
  ds_read_b128 a[240:243], v244 offset:16384
  buffer_load_dwordx4 v255, s[4:7], s43 offen offset:3072 sc1 lds
  v_mul_f32 v137, v137, v129
  v_mul_f32 v129, v247, v129
  v_mfma_f32_32x32x16_bf16 v[112:127], a[252:255], v[12:15], v[112:127]
  ds_read_b128 a[244:247], v244 offset:17408
  v_fma_f32 v128, v128, v254, v254
  v_exp_f32 v129, v129
  s_waitcnt lgkmcnt(4)
  v_mfma_f32_32x32x16_bf16 v[112:127], a[224:227], v[16:19], v[112:127]
  ds_read_b128 a[248:251], v244 offset:18432
  s_add_u32 m0, s85, 8192
  s_add_u32 s43, s32, 212992
  buffer_load_dwordx4 v255, s[4:7], s43 offen offset:0 sc1 lds
  v_mfma_f32_32x32x16_bf16 v[112:127], a[228:231], v[20:23], v[112:127]
  ds_read_b128 a[252:255], v244 offset:19456
  v_rcp_f32 v128, v128
  v_mul_f32 v138, v138, v130
  v_mul_f32 v130, v247, v130
  s_waitcnt lgkmcnt(4)
  v_mfma_f32_32x32x16_bf16 v[112:127], a[232:235], v[24:27], v[112:127]
  ds_read_b128 a[224:227], v244 offset:45056
  buffer_load_dwordx4 v255, s[4:7], s43 offen offset:1024 sc1 lds
  v_fma_f32 v129, v129, v254, v254
  v_mfma_f32_32x32x16_bf16 v[112:127], a[236:239], v[28:31], v[112:127]
  ds_read_b128 a[228:231], v244 offset:46080
  v_exp_f32 v130, v130
  v_mul_f32 v136, v136, v128
  s_waitcnt lgkmcnt(4)
  v_mfma_f32_32x32x16_bf16 v[112:127], a[240:243], v[32:35], v[112:127]
  ds_read_b128 a[232:235], v244 offset:47104
  buffer_load_dwordx4 v255, s[4:7], s43 offen offset:2048 sc1 lds
  v_rcp_f32 v129, v129
  v_mfma_f32_32x32x16_bf16 v[112:127], a[244:247], v[36:39], v[112:127]
  ds_read_b128 a[236:239], v244 offset:48128
  v_mul_f32 v139, v139, v131
  v_mul_f32 v131, v247, v131
  v_fma_f32 v130, v130, v254, v254
  s_waitcnt lgkmcnt(4)
  v_mfma_f32_32x32x16_bf16 v[112:127], a[248:251], v[40:43], v[112:127]
  ds_read_b128 a[240:243], v255 offset:28672
  buffer_load_dwordx4 v255, s[4:7], s43 offen offset:3072 sc1 lds
  v_exp_f32 v131, v131
  v_mfma_f32_32x32x16_bf16 v[112:127], a[252:255], v[44:47], v[112:127]
  ds_read_b128 a[244:247], v255 offset:29696
  v_mul_f32 v137, v137, v129
  v_rcp_f32 v130, v130
  v_cvt_pk_bf16_f32 v128, v136, v137
  s_waitcnt lgkmcnt(4)
  v_mfma_f32_32x32x16_bf16 v[112:127], a[224:227], v[48:51], v[112:127]
  ds_read_b128 a[248:251], v255 offset:30720
  v_mul_f32 v140, v140, v132
  v_mul_f32 v132, v247, v132
  v_fma_f32 v131, v131, v254, v254
  v_exp_f32 v132, v132
  v_mfma_f32_32x32x16_bf16 v[112:127], a[228:231], v[52:55], v[112:127]
  ds_read_b128 a[252:255], v255 offset:31744
  v_mul_f32 v138, v138, v130
  v_rcp_f32 v131, v131
  v_or_b32 v128, 1, v128
  s_waitcnt lgkmcnt(4)
  v_mfma_f32_32x32x16_bf16 v[112:127], a[232:235], v[56:59], v[112:127]
  ds_read_b128 a[224:227], v255 offset:57344
  s_add_u32 s42, s50, 0
  buffer_load_dwordx4 v[148:151], v246, s[4:7], s42 offen sc1
  v_mul_f32 v141, v141, v133
  v_mfma_f32_32x32x16_bf16 v[112:127], a[236:239], v[60:63], v[112:127]
  ds_read_b128 a[228:231], v255 offset:58368
  v_mul_f32 v133, v247, v133
  v_fma_f32 v132, v132, v254, v254
  v_exp_f32 v133, v133
  s_waitcnt lgkmcnt(4)
  v_mfma_f32_32x32x16_bf16 v[112:127], a[240:243], v[64:67], v[112:127]
  ds_read_b128 a[232:235], v255 offset:59392
  v_mul_f32 v139, v139, v131
  v_rcp_f32 v132, v132
  v_cvt_pk_bf16_f32 v129, v138, v139
  v_mul_f32 v142, v142, v134
  v_mfma_f32_32x32x16_bf16 v[112:127], a[244:247], v[68:71], v[112:127]
  ds_read_b128 a[236:239], v255 offset:60416
  v_mul_f32 v134, v247, v134
  buffer_load_dwordx4 v[144:147], v242, s[4:7], s42 offen sc1
  s_waitcnt lgkmcnt(4)
  v_mfma_f32_32x32x16_bf16 v[112:127], a[248:251], v[72:75], v[112:127]
  ds_read_b128 a[240:243], v244 offset:20480
  v_fma_f32 v133, v133, v254, v254
  v_exp_f32 v134, v134
  v_mul_f32 v140, v140, v132
  v_mfma_f32_32x32x16_bf16 v[112:127], a[252:255], v[76:79], v[112:127]
  ds_read_b128 a[244:247], v244 offset:21504
  v_rcp_f32 v133, v133
  v_mul_f32 v143, v143, v135
  v_mul_f32 v135, v247, v135
  s_waitcnt lgkmcnt(4)
  v_mfma_f32_32x32x16_bf16 v[112:127], a[224:227], v[80:83], v[112:127]
  ds_read_b128 a[248:251], v244 offset:22528
  v_fma_f32 v134, v134, v254, v254
  v_exp_f32 v135, v135
  v_mul_f32 v141, v141, v133
  v_mfma_f32_32x32x16_bf16 v[112:127], a[228:231], v[84:87], v[112:127]
  ds_read_b128 a[252:255], v244 offset:23552
  s_add_u32 s42, s50, 32768
  buffer_load_dwordx4 v[156:159], v246, s[4:7], s42 offen sc1
  s_waitcnt lgkmcnt(4)
  v_mfma_f32_32x32x16_bf16 v[112:127], a[232:235], v[88:91], v[112:127]
  ds_read_b64 a[224:225], v255 offset:2048
  v_rcp_f32 v134, v134
  v_cvt_pk_bf16_f32 v130, v140, v141
  v_fma_f32 v135, v135, v254, v254
  v_mul_f32 v142, v142, v134
  v_mfma_f32_32x32x16_bf16 v[112:127], a[236:239], v[92:95], v[112:127]
  ds_read_b128 a[228:231], v244 offset:49152
  v_rcp_f32 v135, v135
  s_nop 0
  v_mul_f32 v143, v143, v135
  v_cvt_pk_bf16_f32 v131, v142, v143
  s_waitcnt lgkmcnt(4)
  v_mfma_f32_32x32x16_bf16 v[112:127], a[240:243], v[96:99], v[112:127]
  ds_read_b128 a[232:235], v244 offset:50176
  buffer_load_dwordx4 v[152:155], v242, s[4:7], s42 offen sc1
  v_mfma_f32_32x32x16_bf16 v[112:127], a[244:247], v[100:103], v[112:127]
  ds_read_b128 a[236:239], v244 offset:51200
  s_add_u32 s42, s50, 65536
  buffer_load_dwordx4 v[164:167], v246, s[4:7], s42 offen sc1
  s_waitcnt lgkmcnt(4)
  v_mfma_f32_32x32x16_bf16 v[112:127], a[248:251], v[104:107], v[112:127]
  ds_read_b128 a[240:243], v244 offset:52224
  buffer_store_dwordx4 v[128:131], v255, s[4:7], s46 offen offset:3072 sc1
  v_mfma_f32_32x32x16_bf16 v[112:127], a[252:255], v[108:111], v[112:127]
  ds_read_b128 a[244:247], v244 offset:53248
  s_waitcnt lgkmcnt(4)
  v_mfma_f32_32x32x16_bf16 v[112:127], a[224:227], v[248:251], v[112:127]
  ds_read_b128 a[248:251], v244 offset:54272
  buffer_load_dwordx4 v[160:163], v242, s[4:7], s42 offen sc1
  v_mfma_f32_32x32x16_bf16 v[128:143], a[228:231], v[0:3], 0
  ds_read_b128 a[252:255], v244 offset:55296
  s_waitcnt lgkmcnt(4)
  v_mfma_f32_32x32x16_bf16 v[128:143], a[232:235], v[4:7], v[128:143]
  ds_read_b128 a[224:227], v244 offset:56320
  v_mul_f32 v120, v120, v112
  v_mul_f32 v112, v247, v112
  v_exp_f32 v112, v112
  v_mul_f32 v121, v121, v113
  v_mfma_f32_32x32x16_bf16 v[128:143], a[236:239], v[8:11], v[128:143]
  ds_read_b128 a[228:231], v244 offset:57344
  s_add_u32 s42, s53, 0
  buffer_load_dwordx4 v[172:175], v246, s[4:7], s42 offen sc1
  s_waitcnt lgkmcnt(4)
  v_mfma_f32_32x32x16_bf16 v[128:143], a[240:243], v[12:15], v[128:143]
  ds_read_b128 a[232:235], v244 offset:58368
  v_mul_f32 v113, v247, v113
  v_fma_f32 v112, v112, v254, v254
  v_exp_f32 v113, v113
  v_mfma_f32_32x32x16_bf16 v[128:143], a[244:247], v[16:19], v[128:143]
  ds_read_b128 a[236:239], v244 offset:59392
  v_rcp_f32 v112, v112
  v_mul_f32 v122, v122, v114
  v_mul_f32 v114, v247, v114
  s_waitcnt lgkmcnt(4)
  v_mfma_f32_32x32x16_bf16 v[128:143], a[248:251], v[20:23], v[128:143]
  ds_read_b128 a[240:243], v244 offset:60416
  s_branch L_over9
L_pad9:
  s_branch L_ret_B0
L_over9:
  v_fma_f32 v113, v113, v254, v254
  v_exp_f32 v114, v114
  v_mul_f32 v120, v120, v112
  v_mfma_f32_32x32x16_bf16 v[128:143], a[252:255], v[24:27], v[128:143]
  ds_read_b128 a[244:247], v244 offset:61440
  buffer_load_dwordx4 v[168:171], v242, s[4:7], s42 offen sc1
  s_waitcnt lgkmcnt(4)
  v_mfma_f32_32x32x16_bf16 v[128:143], a[224:227], v[28:31], v[128:143]
  ds_read_b128 a[248:251], v244 offset:62464
  v_rcp_f32 v113, v113
  v_mul_f32 v123, v123, v115
  v_mul_f32 v115, v247, v115
  v_fma_f32 v114, v114, v254, v254
  v_mfma_f32_32x32x16_bf16 v[128:143], a[228:231], v[32:35], v[128:143]
  ds_read_b128 a[252:255], v244 offset:63488
  v_exp_f32 v115, v115
  v_mul_f32 v121, v121, v113
  s_waitcnt lgkmcnt(4)
  v_mfma_f32_32x32x16_bf16 v[128:143], a[232:235], v[36:39], v[128:143]
  ds_read_b128 a[224:227], v244 offset:64512
  v_rcp_f32 v114, v114
  v_cvt_pk_bf16_f32 v112, v120, v121
  v_mul_f32 v124, v124, v116
  v_mul_f32 v116, v247, v116
  v_mfma_f32_32x32x16_bf16 v[128:143], a[236:239], v[40:43], v[128:143]
  ds_read_b128 a[228:231], v245 offset:0
  s_add_u32 s42, s50, 17408
  buffer_load_dwordx4 v[180:183], v246, s[4:7], s42 offen sc1
  s_waitcnt lgkmcnt(4)
  v_mfma_f32_32x32x16_bf16 v[128:143], a[240:243], v[44:47], v[128:143]
  ds_read_b128 a[232:235], v245 offset:1024
  v_fma_f32 v115, v115, v254, v254
  v_exp_f32 v116, v116
  v_mul_f32 v122, v122, v114
  v_mfma_f32_32x32x16_bf16 v[128:143], a[244:247], v[48:51], v[128:143]
  ds_read_b128 a[236:239], v245 offset:2048
  v_rcp_f32 v115, v115
  v_or_b32 v112, 1, v112
  v_mul_f32 v125, v125, v117
  s_waitcnt lgkmcnt(4)
  v_mfma_f32_32x32x16_bf16 v[128:143], a[248:251], v[52:55], v[128:143]
  ds_read_b128 a[240:243], v245 offset:3072
  v_mul_f32 v117, v247, v117
  v_fma_f32 v116, v116, v254, v254
  s_waitcnt vmcnt(10)
  s_barrier
  v_mfma_f32_32x32x16_bf16 v[128:143], a[252:255], v[56:59], v[128:143]
  ds_read_b128 a[244:247], v245 offset:4096
  buffer_load_dwordx4 v[176:179], v242, s[4:7], s42 offen sc1
  s_waitcnt lgkmcnt(4)
  v_mfma_f32_32x32x16_bf16 v[128:143], a[224:227], v[60:63], v[128:143]
  ds_read_b128 a[248:251], v245 offset:5120
  v_exp_f32 v117, v117
  v_mul_f32 v123, v123, v115
  v_rcp_f32 v116, v116
  v_mfma_f32_32x32x16_bf16 v[128:143], a[228:231], v[64:67], v[128:143]
  ds_read_b128 a[252:255], v245 offset:6144
  v_cvt_pk_bf16_f32 v113, v122, v123
  v_mul_f32 v126, v126, v118
  v_mul_f32 v118, v247, v118
  v_fma_f32 v117, v117, v254, v254
  s_waitcnt lgkmcnt(4)
  v_mfma_f32_32x32x16_bf16 v[128:143], a[232:235], v[68:71], v[128:143]
  ds_read_b128 a[224:227], v245 offset:7168
  v_exp_f32 v118, v118
  v_mul_f32 v124, v124, v116
  v_rcp_f32 v117, v117
  v_mfma_f32_32x32x16_bf16 v[128:143], a[236:239], v[72:75], v[128:143]
  ds_read_b128 a[228:231], v245 offset:8192
  s_add_u32 s42, s50, 50176
  buffer_load_dwordx4 v[188:191], v246, s[4:7], s42 offen sc1
  s_waitcnt lgkmcnt(4)
  v_mfma_f32_32x32x16_bf16 v[128:143], a[240:243], v[76:79], v[128:143]
  ds_read_b128 a[232:235], v245 offset:9216
  v_mul_f32 v127, v127, v119
  v_mul_f32 v119, v247, v119
  v_fma_f32 v118, v118, v254, v254
  v_exp_f32 v119, v119
  v_mfma_f32_32x32x16_bf16 v[128:143], a[244:247], v[80:83], v[128:143]
  ds_read_b128 a[236:239], v245 offset:10240
  v_mul_f32 v125, v125, v117
  v_rcp_f32 v118, v118
  v_cvt_pk_bf16_f32 v114, v124, v125
  s_waitcnt lgkmcnt(4)
  v_mfma_f32_32x32x16_bf16 v[128:143], a[248:251], v[84:87], v[128:143]
  ds_read_b128 a[240:243], v245 offset:11264
  v_fma_f32 v119, v119, v254, v254
  buffer_load_dwordx4 v[184:187], v242, s[4:7], s42 offen sc1
  v_mul_f32 v126, v126, v118
  v_mfma_f32_32x32x16_bf16 v[128:143], a[252:255], v[88:91], v[128:143]
  ds_read_b64 a[244:245], v255 offset:2056
  v_rcp_f32 v119, v119
  s_nop 0
  v_mul_f32 v127, v127, v119
  v_cvt_pk_bf16_f32 v115, v126, v127
  s_waitcnt lgkmcnt(4)
  v_mfma_f32_32x32x16_bf16 v[128:143], a[224:227], v[92:95], v[128:143]
  ds_read_b128 a[248:251], v245 offset:12288
  buffer_store_dwordx4 v[112:115], v255, s[4:7], s47 offen offset:0 sc1
  v_mfma_f32_32x32x16_bf16 v[128:143], a[228:231], v[96:99], v[128:143]
  ds_read_b128 a[252:255], v245 offset:13312
  s_add_u32 s42, s50, 82944
  buffer_load_dwordx4 v[196:199], v246, s[4:7], s42 offen sc1
  s_waitcnt lgkmcnt(4)
  v_mfma_f32_32x32x16_bf16 v[128:143], a[232:235], v[100:103], v[128:143]
  ds_read_b128 a[224:227], v245 offset:14336
  buffer_load_dwordx4 v[192:195], v242, s[4:7], s42 offen sc1
  v_mfma_f32_32x32x16_bf16 v[128:143], a[236:239], v[104:107], v[128:143]
  ds_read_b128 a[228:231], v245 offset:15360
  s_waitcnt lgkmcnt(4)
  v_mfma_f32_32x32x16_bf16 v[128:143], a[240:243], v[108:111], v[128:143]
  ds_read_b128 a[232:235], v245 offset:16384
  s_add_u32 s42, s50, 2048
  buffer_load_dwordx4 v[204:207], v246, s[4:7], s42 offen sc1
  v_mfma_f32_32x32x16_bf16 v[128:143], a[244:247], v[248:251], v[128:143]
  ds_read_b128 a[236:239], v245 offset:17408
  s_waitcnt lgkmcnt(4)
  v_mfma_f32_32x32x16_bf16 v[112:127], a[248:251], v[0:3], 0
  ds_read_b128 a[240:243], v245 offset:18432
  buffer_load_dwordx4 v[200:203], v242, s[4:7], s42 offen sc1
  v_mfma_f32_32x32x16_bf16 v[112:127], a[252:255], v[4:7], v[112:127]
  ds_read_b128 a[244:247], v245 offset:19456
  v_mul_f32 v136, v136, v128
  v_mul_f32 v128, v247, v128
  v_exp_f32 v128, v128
  s_waitcnt lgkmcnt(4)
  v_mfma_f32_32x32x16_bf16 v[112:127], a[224:227], v[8:11], v[112:127]
  ds_read_b128 a[248:251], v255 offset:4096
  v_mul_f32 v137, v137, v129
  v_mul_f32 v129, v247, v129
  v_fma_f32 v128, v128, v254, v254
  v_exp_f32 v129, v129
  v_mfma_f32_32x32x16_bf16 v[112:127], a[228:231], v[12:15], v[112:127]
  ds_read_b128 a[252:255], v255 offset:5120
  s_add_u32 s42, s50, 34816
  buffer_load_dwordx4 v[212:215], v246, s[4:7], s42 offen sc1
  s_waitcnt lgkmcnt(4)
  v_mfma_f32_32x32x16_bf16 v[112:127], a[232:235], v[16:19], v[112:127]
  ds_read_b128 a[224:227], v255 offset:6144
  v_rcp_f32 v128, v128
  v_mul_f32 v138, v138, v130
  v_mul_f32 v130, v247, v130
  v_fma_f32 v129, v129, v254, v254
  v_mfma_f32_32x32x16_bf16 v[112:127], a[236:239], v[20:23], v[112:127]
  ds_read_b128 a[228:231], v255 offset:7168
  v_exp_f32 v130, v130
  v_mul_f32 v136, v136, v128
  s_waitcnt lgkmcnt(4)
  v_mfma_f32_32x32x16_bf16 v[112:127], a[240:243], v[24:27], v[112:127]
  ds_read_b128 a[232:235], v255 offset:32768
  buffer_load_dwordx4 v[208:211], v242, s[4:7], s42 offen sc1
  v_rcp_f32 v129, v129
  v_mfma_f32_32x32x16_bf16 v[112:127], a[244:247], v[28:31], v[112:127]
  ds_read_b128 a[236:239], v255 offset:33792
  v_mul_f32 v139, v139, v131
  v_mul_f32 v131, v247, v131
  v_fma_f32 v130, v130, v254, v254
  s_waitcnt lgkmcnt(4)
  v_mfma_f32_32x32x16_bf16 v[112:127], a[248:251], v[32:35], v[112:127]
  ds_read_b128 a[240:243], v255 offset:34816
  v_exp_f32 v131, v131
  v_mul_f32 v137, v137, v129
  v_rcp_f32 v130, v130
  v_mfma_f32_32x32x16_bf16 v[112:127], a[252:255], v[36:39], v[112:127]
  ds_read_b128 a[244:247], v255 offset:35840
  v_cvt_pk_bf16_f32 v128, v136, v137
  v_mul_f32 v140, v140, v132
  v_mul_f32 v132, v247, v132
  v_fma_f32 v131, v131, v254, v254
  s_waitcnt lgkmcnt(4)
  v_mfma_f32_32x32x16_bf16 v[112:127], a[224:227], v[40:43], v[112:127]
  ds_read_b128 a[248:251], v255 offset:61440
  s_add_u32 s42, s50, 67584
  buffer_load_dwordx4 v[220:223], v246, s[4:7], s42 offen sc1
  v_mfma_f32_32x32x16_bf16 v[112:127], a[228:231], v[44:47], v[112:127]
  ds_read_b128 a[252:255], v255 offset:62464
  v_exp_f32 v132, v132
  v_mul_f32 v138, v138, v130
  s_waitcnt lgkmcnt(4)
  v_mfma_f32_32x32x16_bf16 v[112:127], a[232:235], v[48:51], v[112:127]
  ds_read_b128 a[224:227], v255 offset:63488
  v_rcp_f32 v131, v131
  v_or_b32 v128, 1, v128
  v_mul_f32 v141, v141, v133
  v_mul_f32 v133, v247, v133
  v_mfma_f32_32x32x16_bf16 v[112:127], a[236:239], v[52:55], v[112:127]
  ds_read_b128 a[228:231], v255 offset:64512
  v_fma_f32 v132, v132, v254, v254
  buffer_load_dwordx4 v[216:219], v242, s[4:7], s42 offen sc1
  s_waitcnt lgkmcnt(4)
  v_mfma_f32_32x32x16_bf16 v[112:127], a[240:243], v[56:59], v[112:127]
  ds_read_b128 a[232:235], v244 offset:24576
  v_exp_f32 v133, v133
  v_mul_f32 v139, v139, v131
  v_rcp_f32 v132, v132
  v_mfma_f32_32x32x16_bf16 v[112:127], a[244:247], v[60:63], v[112:127]
  ds_read_b128 a[236:239], v244 offset:25600
  v_cvt_pk_bf16_f32 v129, v138, v139
  v_mul_f32 v142, v142, v134
  v_mul_f32 v134, v247, v134
  v_fma_f32 v133, v133, v254, v254
  s_waitcnt lgkmcnt(4)
  v_mfma_f32_32x32x16_bf16 v[112:127], a[248:251], v[64:67], v[112:127]
  ds_read_b128 a[240:243], v244 offset:26624
  v_exp_f32 v134, v134
  v_mul_f32 v140, v140, v132
  v_rcp_f32 v133, v133
  v_mfma_f32_32x32x16_bf16 v[112:127], a[252:255], v[68:71], v[112:127]
  ds_read_b128 a[244:247], v244 offset:27648
  s_add_u32 s42, s53, 2048
  buffer_load_dwordx4 v[228:231], v246, s[4:7], s42 offen sc1
  s_waitcnt lgkmcnt(4)
  v_mfma_f32_32x32x16_bf16 v[112:127], a[224:227], v[72:75], v[112:127]
  ds_read_b128 a[248:251], v255 offset:8192
  v_mul_f32 v143, v143, v135
  v_mul_f32 v135, v247, v135
  v_fma_f32 v134, v134, v254, v254
  v_exp_f32 v135, v135
  v_mfma_f32_32x32x16_bf16 v[112:127], a[228:231], v[76:79], v[112:127]
  ds_read_b128 a[252:255], v255 offset:9216
  v_mul_f32 v141, v141, v133
  v_rcp_f32 v134, v134
  v_cvt_pk_bf16_f32 v130, v140, v141
  s_waitcnt lgkmcnt(4)
  v_mfma_f32_32x32x16_bf16 v[112:127], a[232:235], v[80:83], v[112:127]
  ds_read_b128 a[224:227], v255 offset:10240
  v_fma_f32 v135, v135, v254, v254
  buffer_load_dwordx4 v[224:227], v242, s[4:7], s42 offen sc1
  v_mul_f32 v142, v142, v134
  v_mfma_f32_32x32x16_bf16 v[112:127], a[236:239], v[84:87], v[112:127]
  ds_read_b128 a[228:231], v255 offset:11264
  v_rcp_f32 v135, v135
  s_nop 0
  v_mul_f32 v143, v143, v135
  v_cvt_pk_bf16_f32 v131, v142, v143
  s_waitcnt lgkmcnt(4)
  v_mfma_f32_32x32x16_bf16 v[112:127], a[240:243], v[88:91], v[112:127]
  ds_read_b64 a[232:233], v255 offset:3072
  buffer_store_dwordx4 v[128:131], v255, s[4:7], s47 offen offset:1024 sc1
  v_mfma_f32_32x32x16_bf16 v[112:127], a[244:247], v[92:95], v[112:127]
  ds_read_b128 a[236:239], v255 offset:36864
  s_waitcnt lgkmcnt(4)
  v_mfma_f32_32x32x16_bf16 v[112:127], a[248:251], v[96:99], v[112:127]
  ds_read_b128 a[240:243], v255 offset:37888
  v_mfma_f32_32x32x16_bf16 v[112:127], a[252:255], v[100:103], v[112:127]
  ds_read_b128 a[244:247], v255 offset:38912
  s_waitcnt lgkmcnt(4)
  v_mfma_f32_32x32x16_bf16 v[112:127], a[224:227], v[104:107], v[112:127]
  ds_read_b128 a[248:251], v255 offset:39936
  v_mfma_f32_32x32x16_bf16 v[112:127], a[228:231], v[108:111], v[112:127]
  ds_read_b128 a[252:255], v244 offset:0
  s_waitcnt lgkmcnt(4)
  v_mfma_f32_32x32x16_bf16 v[112:127], a[232:235], v[248:251], v[112:127]
  ds_read_b128 a[224:227], v244 offset:1024
  v_mfma_f32_32x32x16_bf16 v[128:143], a[236:239], v[0:3], 0
  ds_read_b128 a[228:231], v244 offset:2048
  s_waitcnt lgkmcnt(4)
  v_mfma_f32_32x32x16_bf16 v[128:143], a[240:243], v[4:7], v[128:143]
  ds_read_b128 a[232:235], v244 offset:3072
  v_mul_f32 v120, v120, v112
  v_mul_f32 v112, v247, v112
  v_exp_f32 v112, v112
  v_mul_f32 v121, v121, v113
  v_mfma_f32_32x32x16_bf16 v[128:143], a[244:247], v[8:11], v[128:143]
  ds_read_b128 a[236:239], v244 offset:28672
  v_mul_f32 v113, v247, v113
  v_fma_f32 v112, v112, v254, v254
  v_exp_f32 v113, v113
  s_waitcnt lgkmcnt(4)
  v_mfma_f32_32x32x16_bf16 v[128:143], a[248:251], v[12:15], v[128:143]
  ds_read_b128 a[240:243], v244 offset:29696
  v_rcp_f32 v112, v112
  v_mul_f32 v122, v122, v114
  v_mul_f32 v114, v247, v114
  v_fma_f32 v113, v113, v254, v254
  v_mfma_f32_32x32x16_bf16 v[128:143], a[252:255], v[16:19], v[128:143]
  ds_read_b128 a[244:247], v244 offset:30720
  v_exp_f32 v114, v114
  v_mul_f32 v120, v120, v112
  s_waitcnt lgkmcnt(4)
  v_mfma_f32_32x32x16_bf16 v[128:143], a[224:227], v[20:23], v[128:143]
  ds_read_b128 a[248:251], v244 offset:31744
  v_rcp_f32 v113, v113
  v_mul_f32 v123, v123, v115
  v_mul_f32 v115, v247, v115
  v_fma_f32 v114, v114, v254, v254
  v_mfma_f32_32x32x16_bf16 v[128:143], a[228:231], v[24:27], v[128:143]
  ds_read_b128 a[252:255], v255 offset:12288
  v_exp_f32 v115, v115
  v_mul_f32 v121, v121, v113
  s_waitcnt lgkmcnt(4)
  v_mfma_f32_32x32x16_bf16 v[128:143], a[232:235], v[28:31], v[128:143]
  ds_read_b128 a[224:227], v255 offset:13312
  v_rcp_f32 v114, v114
  v_cvt_pk_bf16_f32 v112, v120, v121
  v_mul_f32 v124, v124, v116
  v_mul_f32 v116, v247, v116
  v_mfma_f32_32x32x16_bf16 v[128:143], a[236:239], v[32:35], v[128:143]
  ds_read_b128 a[228:231], v255 offset:14336
  v_fma_f32 v115, v115, v254, v254
  v_exp_f32 v116, v116
  v_mul_f32 v122, v122, v114
  s_waitcnt lgkmcnt(4)
  v_mfma_f32_32x32x16_bf16 v[128:143], a[240:243], v[36:39], v[128:143]
  ds_read_b128 a[232:235], v255 offset:15360
  v_rcp_f32 v115, v115
  v_or_b32 v112, 1, v112
  v_mul_f32 v125, v125, v117
  v_mul_f32 v117, v247, v117
  v_mfma_f32_32x32x16_bf16 v[128:143], a[244:247], v[40:43], v[128:143]
  ds_read_b128 a[236:239], v255 offset:40960
  s_add_u32 s42, s50, 19456
  buffer_load_dwordx4 v[36:39], v246, s[4:7], s42 offen sc1
  s_waitcnt lgkmcnt(4)
  v_mfma_f32_32x32x16_bf16 v[128:143], a[248:251], v[44:47], v[128:143]
  ds_read_b128 a[240:243], v255 offset:41984
  buffer_load_dwordx4 v[32:35], v242, s[4:7], s42 offen sc1
  v_fma_f32 v116, v116, v254, v254
  v_mfma_f32_32x32x16_bf16 v[128:143], a[252:255], v[48:51], v[128:143]
  ds_read_b128 a[244:247], v255 offset:43008
  s_add_u32 s42, s50, 52224
  buffer_load_dwordx4 v[44:47], v246, s[4:7], s42 offen sc1
  s_waitcnt lgkmcnt(4)
  v_mfma_f32_32x32x16_bf16 v[128:143], a[224:227], v[52:55], v[128:143]
  ds_read_b128 a[248:251], v255 offset:44032
  v_exp_f32 v117, v117
  v_mul_f32 v123, v123, v115
  v_rcp_f32 v116, v116
  v_mfma_f32_32x32x16_bf16 v[128:143], a[228:231], v[56:59], v[128:143]
  ds_read_b128 a[252:255], v244 offset:4096
  buffer_load_dwordx4 v[40:43], v242, s[4:7], s42 offen sc1
  v_cvt_pk_bf16_f32 v113, v122, v123
  s_waitcnt lgkmcnt(4)
  v_mfma_f32_32x32x16_bf16 v[128:143], a[232:235], v[60:63], v[128:143]
  ds_read_b128 a[224:227], v244 offset:5120
  v_mul_f32 v126, v126, v118
  v_mul_f32 v118, v247, v118
  v_fma_f32 v117, v117, v254, v254
  v_exp_f32 v118, v118
  v_mfma_f32_32x32x16_bf16 v[128:143], a[236:239], v[64:67], v[128:143]
  ds_read_b128 a[228:231], v244 offset:6144
  v_mul_f32 v124, v124, v116
  v_rcp_f32 v117, v117
  v_mul_f32 v127, v127, v119
  s_waitcnt lgkmcnt(4)
  v_mfma_f32_32x32x16_bf16 v[128:143], a[240:243], v[68:71], v[128:143]
  ds_read_b128 a[232:235], v244 offset:7168
  s_add_u32 s42, s50, 84992
  buffer_load_dwordx4 v[52:55], v246, s[4:7], s42 offen sc1
  v_mul_f32 v119, v247, v119
  v_mfma_f32_32x32x16_bf16 v[128:143], a[244:247], v[72:75], v[128:143]
  ds_read_b128 a[236:239], v244 offset:32768
  v_fma_f32 v118, v118, v254, v254
  v_exp_f32 v119, v119
  v_mul_f32 v125, v125, v117
  s_waitcnt lgkmcnt(4)
  v_mfma_f32_32x32x16_bf16 v[128:143], a[248:251], v[76:79], v[128:143]
  ds_read_b128 a[240:243], v244 offset:33792
  buffer_load_dwordx4 v[48:51], v242, s[4:7], s42 offen sc1
  v_rcp_f32 v118, v118
  v_mfma_f32_32x32x16_bf16 v[128:143], a[252:255], v[80:83], v[128:143]
  ds_read_b128 a[244:247], v244 offset:34816
  v_cvt_pk_bf16_f32 v114, v124, v125
  v_fma_f32 v119, v119, v254, v254
  v_mul_f32 v126, v126, v118
  s_waitcnt lgkmcnt(4)
  v_mfma_f32_32x32x16_bf16 v[128:143], a[224:227], v[84:87], v[128:143]
  ds_read_b128 a[248:251], v244 offset:35840
  v_rcp_f32 v119, v119
  s_nop 0
  v_mul_f32 v127, v127, v119
  v_cvt_pk_bf16_f32 v115, v126, v127
  v_mfma_f32_32x32x16_bf16 v[128:143], a[228:231], v[88:91], v[128:143]
  ds_read_b64 a[252:253], v255 offset:3080
  s_add_u32 s42, s50, 4096
  buffer_load_dwordx4 v[60:63], v246, s[4:7], s42 offen sc1
  s_waitcnt lgkmcnt(4)
  v_mfma_f32_32x32x16_bf16 v[128:143], a[232:235], v[92:95], v[128:143]
  buffer_store_dwordx4 v[112:115], v255, s[4:7], s47 offen offset:2048 sc1
  v_mfma_f32_32x32x16_bf16 v[128:143], a[236:239], v[96:99], v[128:143]
  buffer_load_dwordx4 v[56:59], v242, s[4:7], s42 offen sc1
  s_waitcnt lgkmcnt(2)
  v_mfma_f32_32x32x16_bf16 v[128:143], a[240:243], v[100:103], v[128:143]
  s_waitcnt vmcnt(31)
  v_bitop3_b32 v235, v148, v144, v156 bitop3:0x80
  s_waitcnt vmcnt(29)
  v_bitop3_b32 v235, v152, v164, v235 bitop3:0x80
  s_waitcnt vmcnt(27)
  v_bitop3_b32 v235, v160, v235, 1 bitop3:0x80
  v_cmp_ne_u32 vcc, 1, v235
  v_mfma_f32_32x32x16_bf16 v[128:143], a[244:247], v[104:107], v[128:143]
  s_add_u32 s42, s50, 36864
  buffer_load_dwordx4 v[68:71], v246, s[4:7], s42 offen sc1
  s_waitcnt lgkmcnt(0)
  v_mfma_f32_32x32x16_bf16 v[128:143], a[248:251], v[108:111], v[128:143]
  v_mfma_f32_32x32x16_bf16 v[128:143], a[252:255], v[248:251], v[128:143]
  s_cbranch_vccnz SLOW_87
BACK_88:
  buffer_load_dwordx4 v[64:67], v242, s[4:7], s42 offen sc1
  v_mfma_f32_32x32x16_bf16 a[224:239], a[0:3], v[148:151], 0
  v_mfma_f32_32x32x16_bf16 a[240:255], a[4:7], v[148:151], 0
  s_add_u32 s42, s50, 69632
  buffer_load_dwordx4 v[76:79], v246, s[4:7], s42 offen sc1
  v_mul_f32 v136, v136, v128
  v_mul_f32 v128, v247, v128
  v_mfma_f32_32x32x16_bf16 v[0:15], a[0:3], v[144:147], 0
  v_exp_f32 v128, v128
  v_mul_f32 v137, v137, v129
  v_mul_f32 v129, v247, v129
  v_fma_f32 v128, v128, v254, v254
  v_mfma_f32_32x32x16_bf16 v[16:31], a[4:7], v[144:147], 0
  buffer_load_dwordx4 v[72:75], v242, s[4:7], s42 offen sc1
  v_exp_f32 v129, v129
  v_mfma_f32_32x32x16_bf16 a[224:239], a[8:11], v[156:159], a[224:239]
  v_rcp_f32 v128, v128
  v_mul_f32 v138, v138, v130
  v_mul_f32 v130, v247, v130
  v_fma_f32 v129, v129, v254, v254
  v_mfma_f32_32x32x16_bf16 a[240:255], a[12:15], v[156:159], a[240:255]
  v_exp_f32 v130, v130
  v_mul_f32 v136, v136, v128
  v_rcp_f32 v129, v129
  v_mul_f32 v139, v139, v131
  v_mfma_f32_32x32x16_bf16 v[0:15], a[8:11], v[152:155], v[0:15]
  v_mul_f32 v131, v247, v131
  v_fma_f32 v130, v130, v254, v254
  v_exp_f32 v131, v131
  v_mul_f32 v137, v137, v129
  v_mfma_f32_32x32x16_bf16 v[16:31], a[12:15], v[152:155], v[16:31]
  v_rcp_f32 v130, v130
  v_cvt_pk_bf16_f32 v128, v136, v137
  v_mul_f32 v140, v140, v132
  v_mul_f32 v132, v247, v132
  v_fma_f32 v131, v131, v254, v254
  v_mfma_f32_32x32x16_bf16 a[224:239], a[16:19], v[164:167], a[224:239]
  v_exp_f32 v132, v132
  v_mul_f32 v138, v138, v130
  s_waitcnt vmcnt(28)
  v_bitop3_b32 v235, v172, v168, v180 bitop3:0x80
  v_rcp_f32 v131, v131
  v_mfma_f32_32x32x16_bf16 a[240:255], a[20:23], v[164:167], a[240:255]
  v_or_b32 v128, 1, v128
  v_mul_f32 v141, v141, v133
  v_mul_f32 v133, v247, v133
  v_fma_f32 v132, v132, v254, v254
  s_waitcnt vmcnt(26)
  v_bitop3_b32 v235, v176, v188, v235 bitop3:0x80
  s_waitcnt vmcnt(23)
  v_bitop3_b32 v235, v184, v196, v235 bitop3:0x80
  v_mfma_f32_32x32x16_bf16 v[0:15], a[16:19], v[160:163], v[0:15]
  s_waitcnt vmcnt(22)
  v_bitop3_b32 v235, v192, v235, 1 bitop3:0x80
  v_cmp_ne_u32 vcc, 1, v235
  v_exp_f32 v133, v133
  v_mul_f32 v139, v139, v131
  v_mfma_f32_32x32x16_bf16 v[16:31], a[20:23], v[160:163], v[16:31]
  v_rcp_f32 v132, v132
  v_cvt_pk_bf16_f32 v129, v138, v139
  s_cbranch_vccnz SLOW_89
BACK_90:
  v_mul_f32 v142, v142, v134
  v_mul_f32 v134, v247, v134
  v_mfma_f32_32x32x16_bf16 a[224:239], a[24:27], v[172:175], a[224:239]
  v_fma_f32 v133, v133, v254, v254
  v_exp_f32 v134, v134
  v_mul_f32 v140, v140, v132
  s_add_u32 s42, s53, 4096
  buffer_load_dwordx4 v[84:87], v246, s[4:7], s42 offen sc1
  v_mfma_f32_32x32x16_bf16 a[240:255], a[28:31], v[172:175], a[240:255]
  v_rcp_f32 v133, v133
  v_mul_f32 v143, v143, v135
  v_mul_f32 v135, v247, v135
  v_fma_f32 v134, v134, v254, v254
  v_mfma_f32_32x32x16_bf16 v[0:15], a[24:27], v[168:171], v[0:15]
  v_exp_f32 v135, v135
  v_mul_f32 v141, v141, v133
  v_rcp_f32 v134, v134
  v_cvt_pk_bf16_f32 v130, v140, v141
  v_fma_f32 v135, v135, v254, v254
  buffer_load_dwordx4 v[80:83], v242, s[4:7], s42 offen sc1
  v_mfma_f32_32x32x16_bf16 v[16:31], a[28:31], v[168:171], v[16:31]
  v_mul_f32 v142, v142, v134
  v_rcp_f32 v135, v135
  s_nop 0
  v_mul_f32 v143, v143, v135
  v_cvt_pk_bf16_f32 v131, v142, v143
  v_mfma_f32_32x32x16_bf16 a[224:239], a[32:35], v[180:183], a[224:239]
  buffer_store_dwordx4 v[128:131], v255, s[4:7], s47 offen offset:3072 sc1
  s_add_u32 s42, s50, 21504
  buffer_load_dwordx4 v[92:95], v246, s[4:7], s42 offen sc1
  v_mfma_f32_32x32x16_bf16 a[240:255], a[36:39], v[180:183], a[240:255]
  v_mfma_f32_32x32x16_bf16 v[0:15], a[32:35], v[176:179], v[0:15]
  buffer_load_dwordx4 v[88:91], v242, s[4:7], s42 offen sc1
  v_mfma_f32_32x32x16_bf16 v[16:31], a[36:39], v[176:179], v[16:31]
  v_mfma_f32_32x32x16_bf16 a[224:239], a[40:43], v[188:191], a[224:239]
  s_add_u32 s42, s50, 54272
  buffer_load_dwordx4 v[100:103], v246, s[4:7], s42 offen sc1
  s_barrier
  v_mfma_f32_32x32x16_bf16 a[240:255], a[44:47], v[188:191], a[240:255]
  v_mfma_f32_32x32x16_bf16 v[0:15], a[40:43], v[184:187], v[0:15]
  buffer_load_dwordx4 v[96:99], v242, s[4:7], s42 offen sc1
  v_mfma_f32_32x32x16_bf16 v[16:31], a[44:47], v[184:187], v[16:31]
  v_mfma_f32_32x32x16_bf16 a[224:239], a[48:51], v[196:199], a[224:239]
  s_add_u32 s42, s50, 87040
  buffer_load_dwordx4 v[108:111], v246, s[4:7], s42 offen sc1
  s_waitcnt vmcnt(27)
  v_bitop3_b32 v235, v204, v200, v212 bitop3:0x80
  s_waitcnt vmcnt(25)
  v_bitop3_b32 v235, v208, v220, v235 bitop3:0x80
  v_mfma_f32_32x32x16_bf16 a[240:255], a[52:55], v[196:199], a[240:255]
  s_waitcnt vmcnt(24)
  v_bitop3_b32 v235, v216, v235, 1 bitop3:0x80
  v_cmp_ne_u32 vcc, 1, v235
  v_mfma_f32_32x32x16_bf16 v[0:15], a[48:51], v[192:195], v[0:15]
  buffer_load_dwordx4 v[104:107], v242, s[4:7], s42 offen sc1
  v_mfma_f32_32x32x16_bf16 v[16:31], a[52:55], v[192:195], v[16:31]
  s_nop 1
  s_cbranch_vccnz SLOW_91
BACK_92:
  v_mfma_f32_32x32x16_bf16 a[224:239], a[56:59], v[204:207], a[224:239]
  v_mfma_f32_32x32x16_bf16 a[240:255], a[60:63], v[204:207], a[240:255]
  v_mfma_f32_32x32x16_bf16 v[0:15], a[56:59], v[200:203], v[0:15]
  ds_read_b128 v[168:171], v243
  ds_read_b128 v[172:175], v243 offset:2048
  v_mfma_f32_32x32x16_bf16 v[16:31], a[60:63], v[200:203], v[16:31]
  v_mfma_f32_32x32x16_bf16 a[224:239], a[64:67], v[212:215], a[224:239]
  v_mfma_f32_32x32x16_bf16 a[240:255], a[68:71], v[212:215], a[240:255]
  v_mfma_f32_32x32x16_bf16 v[0:15], a[64:67], v[208:211], v[0:15]
  v_mfma_f32_32x32x16_bf16 v[16:31], a[68:71], v[208:211], v[16:31]
  v_mfma_f32_32x32x16_bf16 a[224:239], a[72:75], v[220:223], a[224:239]
  s_waitcnt vmcnt(21)
  v_bitop3_b32 v235, v228, v224, v36 bitop3:0x80
  s_waitcnt vmcnt(19)
  v_bitop3_b32 v235, v32, v44, v235 bitop3:0x80
  s_waitcnt vmcnt(17)
  v_bitop3_b32 v235, v40, v52, v235 bitop3:0x80
  s_waitcnt vmcnt(16)
  v_bitop3_b32 v235, v48, v235, 1 bitop3:0x80
  v_cmp_ne_u32 vcc, 1, v235
  s_waitcnt lgkmcnt(1)
  v_lshlrev_b32 v176, 16, v168
  v_mfma_f32_32x32x16_bf16 a[240:255], a[76:79], v[220:223], a[240:255]
  v_and_b32 v177, s82, v168
  v_lshlrev_b32 v178, 16, v169
  v_and_b32 v179, s82, v169
  v_lshlrev_b32 v180, 16, v170
  v_and_b32 v181, s82, v170
  v_lshlrev_b32 v182, 16, v171
  v_mfma_f32_32x32x16_bf16 v[0:15], a[72:75], v[216:219], v[0:15]
  v_and_b32 v183, s82, v171
  s_waitcnt lgkmcnt(0)
  v_lshlrev_b32 v184, 16, v172
  v_and_b32 v185, s82, v172
  v_lshlrev_b32 v186, 16, v173
  v_and_b32 v187, s82, v173
  v_lshlrev_b32 v188, 16, v174
  v_mfma_f32_32x32x16_bf16 v[16:31], a[76:79], v[216:219], v[16:31]
  s_cbranch_vccnz SLOW_93
BACK_94:
  v_and_b32 v189, s82, v174
  v_lshlrev_b32 v190, 16, v175
  v_and_b32 v191, s82, v175
  v_mfma_f32_32x32x16_bf16 a[224:239], a[80:83], v[228:231], a[224:239]
  v_lshlrev_b32 v206, 1, v253
  v_and_b32 v206, 64, v206
  v_add_u32 v206, v206, v255
  v_mfma_f32_32x32x16_bf16 a[240:255], a[84:87], v[228:231], a[240:255]
  s_add_u32 s42, s50, 6144
  buffer_load_dwordx4 v[116:119], v246, s[4:7], s42 offen sc1
  v_mfma_f32_32x32x16_bf16 v[0:15], a[80:83], v[224:227], v[0:15]
  buffer_load_dwordx4 v[112:115], v242, s[4:7], s42 offen sc1
  v_mfma_f32_32x32x16_bf16 v[16:31], a[84:87], v[224:227], v[16:31]
  s_add_u32 s42, s50, 38912
  buffer_load_dwordx4 v[124:127], v246, s[4:7], s42 offen sc1
  v_mfma_f32_32x32x16_bf16 a[224:239], a[88:91], v[36:39], a[224:239]
  s_lshl_b32 s40, s73, 7
  v_add_u32 v207, s40, v206
  s_xor_b32 s40, s40, 128
  v_add_u32 v206, s40, v206
  v_mfma_f32_32x32x16_bf16 a[240:255], a[92:95], v[36:39], a[240:255]
  buffer_load_dwordx4 v[120:123], v242, s[4:7], s42 offen sc1
  s_movk_i32 s40, 0x1ff
  v_bfi_b32 v207, s40, v207, v255
  v_bfi_b32 v206, s40, v206, v255
  v_mfma_f32_32x32x16_bf16 v[0:15], a[88:91], v[32:35], v[0:15]
  s_xor_b32 s40, s64, 1
  s_mul_i32 s40, s40, 28672
  v_add_u32 v208, s40, v207
  s_xor_b32 s40, s64, 3
  s_mul_i32 s40, s40, 28672
  v_add_u32 v210, s40, v206
  v_mfma_f32_32x32x16_bf16 v[16:31], a[92:95], v[32:35], v[16:31]
  s_add_u32 s42, s50, 71680
  buffer_load_dwordx4 v[132:135], v246, s[4:7], s42 offen sc1
  v_mfma_f32_32x32x16_bf16 a[224:239], a[96:99], v[44:47], a[224:239]
  s_xor_b32 s40, s64, 2
  s_mul_i32 s40, s40, 28672
  v_add_u32 v209, s40, v206
  v_add_u32 v207, s85, v207
  v_lshrrev_b32 v205, 2, v253
  v_mfma_f32_32x32x16_bf16 a[240:255], a[100:103], v[44:47], a[240:255]
  buffer_load_dwordx4 v[128:131], v242, s[4:7], s42 offen sc1
  s_lshl_b32 s40, s73, 4
  v_add_u32 v205, s40, v205
  v_bfe_u32 v204, v253, 1, 1
  v_mfma_f32_32x32x16_bf16 v[0:15], a[96:99], v[40:43], v[0:15]
  v_and_b32 v203, 1, v253
  v_lshl_add_u32 v211, v203, 1, v204
  v_lshl_add_u32 v211, v211, 2, v205
  v_and_b32 v211, 31, v211
  v_lshl_add_u32 v211, v204, 5, v211
  v_mul_u32_u24 v203, 57344, v203
  v_mfma_f32_32x32x16_bf16 v[16:31], a[100:103], v[40:43], v[16:31]
  v_lshl_add_u32 v211, v211, 4, v203
  s_mul_i32 s40, s74, 28672
  s_add_u32 s40, s40, 4096
  v_add_u32 v211, s40, v211
  v_lshl_add_u32 v205, v205, 6, s71
  v_mul_u32_u24 v205, 896, v205
  v_mfma_f32_32x32x16_bf16 a[224:239], a[104:107], v[52:55], a[224:239]
  s_waitcnt vmcnt(18)
  v_bitop3_b32 v235, v60, v56, v68 bitop3:0x80
  s_waitcnt vmcnt(16)
  v_bitop3_b32 v235, v64, v76, v235 bitop3:0x80
  s_waitcnt vmcnt(15)
  v_bitop3_b32 v235, v72, v235, 1 bitop3:0x80
  v_cmp_ne_u32 vcc, 1, v235
  v_and_b32 v204, 48, v255
  v_mfma_f32_32x32x16_bf16 a[240:255], a[108:111], v[52:55], a[240:255]
  s_lshl_b32 s40, s65, 6
  v_add_u32 v204, s40, v204
  v_add_u32 v203, v205, v204
  v_sub_u32 v204, v205, v204
  v_add_u32 v204, 880, v204
  v_mfma_f32_32x32x16_bf16 v[0:15], a[104:107], v[48:51], v[0:15]
  s_cmp_eq_u32 s65, 0
  s_cselect_b32 s40, -432, 16
  v_mov_b32 v205, s40
  s_mov_b32 s88, 0x88888888
  s_mov_b32 s89, s88
  v_cndmask_b32_e64 v205, v205, 2, s[88:89]
  v_mfma_f32_32x32x16_bf16 v[16:31], a[108:111], v[48:51], v[16:31]
  s_cbranch_vccnz SLOW_95
BACK_96:
  v_add_u32 v205, v205, v204
  v_mfma_f32_32x32x16_bf16 a[224:239], a[112:115], v[60:63], a[224:239]
  v_mfma_f32_32x32x16_bf16 a[240:255], a[116:119], v[60:63], a[240:255]
  v_mfma_f32_32x32x16_bf16 v[0:15], a[112:115], v[56:59], v[0:15]
  v_mfma_f32_32x32x16_bf16 v[16:31], a[116:119], v[56:59], v[16:31]
  v_mfma_f32_32x32x16_bf16 a[224:239], a[120:123], v[68:71], a[224:239]
  v_mfma_f32_32x32x16_bf16 a[240:255], a[124:127], v[68:71], a[240:255]
  s_add_u32 s42, s53, 6144
  buffer_load_dwordx4 v[140:143], v246, s[4:7], s42 offen sc1
  v_mfma_f32_32x32x16_bf16 v[0:15], a[120:123], v[64:67], v[0:15]
  s_add_u32 s42, s50, 23552
  s_branch L_over10
L_pad10:
  s_branch L_ret_B0
L_over10:
  buffer_load_dwordx4 v[148:151], v246, s[4:7], s42 offen sc1
  v_mfma_f32_32x32x16_bf16 v[16:31], a[124:127], v[64:67], v[16:31]
  s_add_u32 s42, s50, 56320
  buffer_load_dwordx4 v[156:159], v246, s[4:7], s42 offen sc1
  v_mfma_f32_32x32x16_bf16 a[224:239], a[128:131], v[76:79], a[224:239]
  s_waitcnt vmcnt(14)
  v_bitop3_b32 v235, v84, v80, v92 bitop3:0x80
  s_waitcnt vmcnt(12)
  v_bitop3_b32 v235, v88, v100, v235 bitop3:0x80
  s_waitcnt vmcnt(10)
  v_bitop3_b32 v235, v96, v108, v235 bitop3:0x80
  s_waitcnt vmcnt(9)
  v_bitop3_b32 v235, v104, v235, 1 bitop3:0x80
  v_cmp_ne_u32 vcc, 1, v235
  v_mfma_f32_32x32x16_bf16 a[240:255], a[132:135], v[76:79], a[240:255]
  s_add_u32 s42, s50, 89088
  buffer_load_dwordx4 v[164:167], v246, s[4:7], s42 offen sc1
  v_mfma_f32_32x32x16_bf16 v[0:15], a[128:131], v[72:75], v[0:15]
  v_mfma_f32_32x32x16_bf16 v[16:31], a[132:135], v[72:75], v[16:31]
  s_cbranch_vccnz SLOW_97
BACK_98:
  s_add_u32 s42, s53, 6144
  buffer_load_dwordx4 v[136:139], v242, s[4:7], s42 offen sc1
  v_mfma_f32_32x32x16_bf16 a[224:239], a[136:139], v[84:87], a[224:239]
  v_mfma_f32_32x32x16_bf16 a[240:255], a[140:143], v[84:87], a[240:255]
  s_add_u32 s42, s50, 23552
  buffer_load_dwordx4 v[144:147], v242, s[4:7], s42 offen sc1
  v_mfma_f32_32x32x16_bf16 v[0:15], a[136:139], v[80:83], v[0:15]
  v_mfma_f32_32x32x16_bf16 v[16:31], a[140:143], v[80:83], v[16:31]
  s_add_u32 s42, s50, 56320
  buffer_load_dwordx4 v[152:155], v242, s[4:7], s42 offen sc1
  v_mfma_f32_32x32x16_bf16 a[224:239], a[144:147], v[92:95], a[224:239]
  v_mfma_f32_32x32x16_bf16 a[240:255], a[148:151], v[92:95], a[240:255]
  s_add_u32 s42, s50, 89088
  buffer_load_dwordx4 v[160:163], v242, s[4:7], s42 offen sc1
  v_mfma_f32_32x32x16_bf16 v[0:15], a[144:147], v[88:91], v[0:15]
  v_mfma_f32_32x32x16_bf16 v[16:31], a[148:151], v[88:91], v[16:31]
  v_mfma_f32_32x32x16_bf16 a[224:239], a[152:155], v[100:103], a[224:239]
  v_mfma_f32_32x32x16_bf16 a[240:255], a[156:159], v[100:103], a[240:255]
  v_mfma_f32_32x32x16_bf16 v[0:15], a[152:155], v[96:99], v[0:15]
  v_mfma_f32_32x32x16_bf16 v[16:31], a[156:159], v[96:99], v[16:31]
  v_mfma_f32_32x32x16_bf16 a[224:239], a[160:163], v[108:111], a[224:239]
  s_waitcnt vmcnt(11)
  v_bitop3_b32 v235, v116, v112, v124 bitop3:0x80
  s_waitcnt vmcnt(9)
  v_bitop3_b32 v235, v120, v132, v235 bitop3:0x80
  s_waitcnt vmcnt(8)
  v_bitop3_b32 v235, v128, v235, 1 bitop3:0x80
  v_cmp_ne_u32 vcc, 1, v235
  v_mfma_f32_32x32x16_bf16 a[240:255], a[164:167], v[108:111], a[240:255]
  v_mfma_f32_32x32x16_bf16 v[0:15], a[160:163], v[104:107], v[0:15]
  v_mfma_f32_32x32x16_bf16 v[16:31], a[164:167], v[104:107], v[16:31]
  s_nop 1
  s_cbranch_vccnz SLOW_99
BACK_100:
  v_mfma_f32_32x32x16_bf16 a[224:239], a[168:171], v[116:119], a[224:239]
  v_mfma_f32_32x32x16_bf16 a[240:255], a[172:175], v[116:119], a[240:255]
  v_mfma_f32_32x32x16_bf16 v[0:15], a[168:171], v[112:115], v[0:15]
  v_mfma_f32_32x32x16_bf16 v[16:31], a[172:175], v[112:115], v[16:31]
  v_mfma_f32_32x32x16_bf16 a[224:239], a[176:179], v[124:127], a[224:239]
  v_mfma_f32_32x32x16_bf16 a[240:255], a[180:183], v[124:127], a[240:255]
  v_mfma_f32_32x32x16_bf16 v[0:15], a[176:179], v[120:123], v[0:15]
  v_mfma_f32_32x32x16_bf16 v[16:31], a[180:183], v[120:123], v[16:31]
  v_mfma_f32_32x32x16_bf16 a[224:239], a[184:187], v[132:135], a[224:239]
  s_waitcnt vmcnt(5)
  v_bitop3_b32 v235, v140, v148, v156 bitop3:0x80
  s_waitcnt vmcnt(4)
  v_bitop3_b32 v235, v164, v235, 1 bitop3:0x80
  v_cmp_ne_u32 vcc, 1, v235
  v_mfma_f32_32x32x16_bf16 a[240:255], a[188:191], v[132:135], a[240:255]
  v_mfma_f32_32x32x16_bf16 v[0:15], a[184:187], v[128:131], v[0:15]
  v_mfma_f32_32x32x16_bf16 v[16:31], a[188:191], v[128:131], v[16:31]
  s_nop 1
  s_cbranch_vccnz SLOW_101
BACK_102:
  v_mfma_f32_32x32x16_bf16 a[224:239], a[192:195], v[140:143], a[224:239]
  v_mfma_f32_32x32x16_bf16 a[240:255], a[196:199], v[140:143], a[240:255]
  v_add_f32 v0, v0, v176
  v_add_f32 v1, v1, v177
  v_add_f32 v2, v2, v178
  v_add_f32 v3, v3, v179
  v_add_f32 v4, v4, v180
  v_add_f32 v5, v5, v181
  v_mfma_f32_32x32x16_bf16 a[224:239], a[200:203], v[148:151], a[224:239]
  v_add_f32 v6, v6, v182
  v_add_f32 v7, v7, v183
  v_add_f32 v16, v16, v184
  v_add_f32 v17, v17, v185
  v_add_f32 v18, v18, v186
  v_add_f32 v19, v19, v187
  v_mfma_f32_32x32x16_bf16 a[240:255], a[204:207], v[148:151], a[240:255]
  v_add_f32 v20, v20, v188
  v_add_f32 v21, v21, v189
  v_add_f32 v22, v22, v190
  v_add_f32 v23, v23, v191
  v_mfma_f32_32x32x16_bf16 a[224:239], a[208:211], v[156:159], a[224:239]
  s_waitcnt vmcnt(1)
  v_bitop3_b32 v235, v136, v144, v152 bitop3:0x80
  s_waitcnt vmcnt(0)
  v_bitop3_b32 v235, v160, v235, 1 bitop3:0x80
  v_cmp_ne_u32 vcc, 1, v235
  v_mfma_f32_32x32x16_bf16 a[240:255], a[212:215], v[156:159], a[240:255]
  v_mfma_f32_32x32x16_bf16 a[224:239], a[216:219], v[164:167], a[224:239]
  v_mfma_f32_32x32x16_bf16 a[240:255], a[220:223], v[164:167], a[240:255]
  s_nop 1
  s_cbranch_vccnz SLOW_103
BACK_104:
  v_mfma_f32_32x32x16_bf16 v[0:15], a[192:195], v[136:139], v[0:15]
  v_mfma_f32_32x32x16_bf16 v[16:31], a[196:199], v[136:139], v[16:31]
  ds_write_b128 v208, a[224:227] offset:4096
  ds_write_b128 v208, a[228:231] offset:5120
  ds_write_b128 v208, a[240:243] offset:6144
  v_mfma_f32_32x32x16_bf16 v[0:15], a[200:203], v[144:147], v[0:15]
  ds_write_b128 v208, a[244:247] offset:7168
  ds_write_b128 v210, a[232:235] offset:12288
  ds_write_b128 v210, a[236:239] offset:13312
  v_mfma_f32_32x32x16_bf16 v[0:15], a[208:211], v[152:155], v[0:15]
  ds_write_b128 v210, a[248:251] offset:14336
  ds_write_b128 v210, a[252:255] offset:15360
  v_mfma_f32_32x32x16_bf16 v[0:15], a[216:219], v[160:163], v[0:15]
  v_mfma_f32_32x32x16_bf16 v[16:31], a[204:207], v[144:147], v[16:31]
  v_mfma_f32_32x32x16_bf16 v[16:31], a[212:215], v[152:155], v[16:31]
  v_mfma_f32_32x32x16_bf16 v[16:31], a[220:223], v[160:163], v[16:31]
  ds_write_b128 v209, v[8:11] offset:8192
  ds_write_b128 v209, v[12:15] offset:9216
  ds_write_b128 v207, v[0:3] offset:12288
  ds_write_b128 v207, v[4:7] offset:13312
  s_nop 7
  ds_write_b128 v209, v[24:27] offset:10240
  ds_write_b128 v209, v[28:31] offset:11264
  ds_write_b128 v207, v[16:19] offset:14336
  ds_write_b128 v207, v[20:23] offset:15360
  s_waitcnt lgkmcnt(0)
  s_barrier
  ds_read_b128 v[0:3], v211 offset:0
  ds_read_b128 v[32:35], v211 offset:4096
  ds_read_b128 v[48:51], v211 offset:8192
  ds_read_b128 v[64:67], v211 offset:12288
  ds_read_b128 v[4:7], v211 offset:1024
  ds_read_b128 v[36:39], v211 offset:5120
  ds_read_b128 v[52:55], v211 offset:9216
  ds_read_b128 v[68:71], v211 offset:13312
  ds_read_b128 v[16:19], v211 offset:2048
  ds_read_b128 v[40:43], v211 offset:6144
  ds_read_b128 v[56:59], v211 offset:10240
  ds_read_b128 v[72:75], v211 offset:14336
  ds_read_b128 v[20:23], v211 offset:3072
  ds_read_b128 v[44:47], v211 offset:7168
  ds_read_b128 v[60:63], v211 offset:11264
  ds_read_b128 v[76:79], v211 offset:15360
  s_waitcnt lgkmcnt(14)
  v_pk_add_f32 v[0:1], v[0:1], v[32:33]
  v_pk_add_f32 v[2:3], v[2:3], v[34:35]
  s_waitcnt lgkmcnt(12)
  v_pk_add_f32 v[48:49], v[48:49], v[64:65]
  v_pk_add_f32 v[50:51], v[50:51], v[66:67]
  v_pk_add_f32 v[0:1], v[0:1], v[48:49]
  v_pk_add_f32 v[2:3], v[2:3], v[50:51]
  s_waitcnt lgkmcnt(10)
  v_pk_add_f32 v[4:5], v[4:5], v[36:37]
  v_pk_add_f32 v[6:7], v[6:7], v[38:39]
  s_waitcnt lgkmcnt(8)
  v_pk_add_f32 v[52:53], v[52:53], v[68:69]
  v_pk_add_f32 v[54:55], v[54:55], v[70:71]
  v_pk_add_f32 v[4:5], v[4:5], v[52:53]
  v_pk_add_f32 v[6:7], v[6:7], v[54:55]
  v_cvt_pk_bf16_f32 v8, v0, v1
  v_cvt_pk_bf16_f32 v9, v2, v3
  v_cvt_pk_bf16_f32 v10, v4, v5
  v_cvt_pk_bf16_f32 v11, v6, v7
  buffer_store_dwordx4 v[8:11], v203, s[20:23], 0 offen
  s_waitcnt lgkmcnt(6)
  v_pk_add_f32 v[16:17], v[16:17], v[40:41]
  v_pk_add_f32 v[18:19], v[18:19], v[42:43]
  s_waitcnt lgkmcnt(4)
  v_pk_add_f32 v[56:57], v[56:57], v[72:73]
  v_pk_add_f32 v[58:59], v[58:59], v[74:75]
  v_pk_add_f32 v[16:17], v[16:17], v[56:57]
  v_pk_add_f32 v[18:19], v[18:19], v[58:59]
  s_waitcnt lgkmcnt(2)
  v_pk_add_f32 v[20:21], v[20:21], v[44:45]
  v_pk_add_f32 v[22:23], v[22:23], v[46:47]
  s_waitcnt lgkmcnt(0)
  v_pk_add_f32 v[60:61], v[60:61], v[76:77]
  v_pk_add_f32 v[62:63], v[62:63], v[78:79]
  v_pk_add_f32 v[20:21], v[20:21], v[60:61]
  v_pk_add_f32 v[22:23], v[22:23], v[62:63]
  v_mov_b32_dpp v48, v16 quad_perm:[1,2,3,3] row_mask:0xf bank_mask:0xf
  v_cvt_pk_bf16_f32 v49, v22, v21
  v_cvt_pk_bf16_f32 v50, v20, v19
  v_cvt_pk_bf16_f32 v51, v18, v17
  v_cvt_pk_bf16_f32 v48, v48, v23
  v_cndmask_b32_e64 v52, v16, v23, s[88:89]
  v_cvt_pk_bf16_f32 v54, v22, v21
  v_cvt_pk_bf16_f32 v55, v20, v19
  v_cvt_pk_bf16_f32 v56, v18, v17
  v_cvt_pk_bf16_f32 v52, v52, v52
  s_andn2_b64 exec, exec, s[88:89]
  buffer_store_dwordx4 v[48:51], v204, s[20:23], 0 offen
  s_mov_b64 exec, s[88:89]
  buffer_store_dwordx3 v[54:56], v204, s[20:23], 0 offen offset:4
  s_mov_b32 exec_lo, 0x99999999
  s_mov_b32 exec_hi, 0x99999999
  buffer_store_short v52, v205, s[20:23], 0 offen
  s_mov_b64 exec, -1
  s_or_b32 s88, s2, s64
  s_cbranch_scc1 L_end
  v_mov_b32 v58, 0
  v_mov_b32 v59, 0
  s_mov_b64 exec, 1
  global_store_dwordx2 v58, v[58:59], s[36:37]
L_end:
L_exit:
  s_endpgm
SLOW_1:
  global_load_dwordx2 v[236:237], v238, s[36:37] sc1
  s_add_u32 s75, s75, 1
  s_cmp_gt_u32 s75, 300000
  s_cbranch_scc1 L_end
  s_waitcnt vmcnt(0)
  v_cmp_eq_u32 vcc, 0, v236
  s_nop 4
  s_cbranch_vccnz SLOW_1
  s_branch BACK_2
SLOW_3:
  buffer_load_dwordx2 v[226:227], v239, s[4:7], s17 offen sc1
  s_add_u32 s75, s75, 1
  s_cmp_gt_u32 s75, 300000
  s_cbranch_scc1 L_end
  s_waitcnt vmcnt(0)
  v_cmp_ne_u64 vcc, v[226:227], s[38:39]
  s_nop 4
  s_cbranch_vccnz SLOW_3
  s_branch BACK_4
SLOW_5:
  buffer_load_dwordx2 v[248:249], v247, s[4:7], s97 offen sc1
  s_add_u32 s75, s75, 1
  s_cmp_gt_u32 s75, 300000
  s_cbranch_scc1 L_end
  s_waitcnt vmcnt(0)
  v_cmp_ne_u64 vcc, v[248:249], s[38:39]
  s_nop 4
  s_cbranch_vccnz SLOW_5
  s_branch BACK_6
SLOW_7:
  buffer_load_dwordx2 v[248:249], v247, s[4:7], s97 offen sc1
  s_add_u32 s75, s75, 1
  s_cmp_gt_u32 s75, 300000
  s_cbranch_scc1 L_end
  s_waitcnt vmcnt(0)
  v_cmp_ne_u64 vcc, v[248:249], s[38:39]
  s_nop 4
  s_cbranch_vccnz SLOW_7
  s_branch BACK_8
SLOW_29:
  buffer_load_dwordx2 v[236:237], v240, s[4:7], s55 offen sc1
  s_add_u32 s75, s75, 1
  s_cmp_gt_u32 s75, 300000
  s_cbranch_scc1 L_end
  s_waitcnt vmcnt(0)
  v_cmp_ne_u64 s[92:93], v[236:237], s[38:39]
  s_nop 1
  s_cmp_lg_u64 s[92:93], 0
  s_cbranch_scc1 SLOW_29
  s_branch BACK_30
SLOW_31:
  s_add_u32 s41, s50, 0
  buffer_load_dwordx4 v[148:151], v246, s[4:7], s41 offen sc1
  s_add_u32 s41, s50, 0
  buffer_load_dwordx4 v[144:147], v242, s[4:7], s41 offen sc1
  s_add_u32 s41, s50, 32768
  buffer_load_dwordx4 v[156:159], v246, s[4:7], s41 offen sc1
  s_add_u32 s41, s50, 32768
  buffer_load_dwordx4 v[152:155], v242, s[4:7], s41 offen sc1
  s_add_u32 s41, s50, 65536
  buffer_load_dwordx4 v[164:167], v246, s[4:7], s41 offen sc1
  s_add_u32 s41, s50, 65536
  buffer_load_dwordx4 v[160:163], v242, s[4:7], s41 offen sc1
  s_add_u32 s75, s75, 1
  s_cmp_gt_u32 s75, 300000
  s_cbranch_scc1 L_end
  s_waitcnt vmcnt(0)
  v_bitop3_b32 v235, v148, v144, v156 bitop3:0xfe
  v_bitop3_b32 v235, v152, v164, v235 bitop3:0xfe
  v_bitop3_b32 v235, v160, v235, 1 bitop3:0xa8
  v_cmp_ne_u32 vcc, 0, v235
  s_nop 4
  s_cbranch_vccnz SLOW_31
  s_branch BACK_32
SLOW_33:
  s_add_u32 s41, s53, 0
  buffer_load_dwordx4 v[172:175], v246, s[4:7], s41 offen sc1
  s_add_u32 s41, s53, 0
  buffer_load_dwordx4 v[168:171], v242, s[4:7], s41 offen sc1
  s_add_u32 s41, s50, 17408
  buffer_load_dwordx4 v[180:183], v246, s[4:7], s41 offen sc1
  s_add_u32 s41, s50, 17408
  buffer_load_dwordx4 v[176:179], v242, s[4:7], s41 offen sc1
  s_add_u32 s41, s50, 50176
  buffer_load_dwordx4 v[188:191], v246, s[4:7], s41 offen sc1
  s_add_u32 s41, s50, 50176
  buffer_load_dwordx4 v[184:187], v242, s[4:7], s41 offen sc1
  s_add_u32 s41, s50, 82944
  buffer_load_dwordx4 v[196:199], v246, s[4:7], s41 offen sc1
  s_add_u32 s41, s50, 82944
  buffer_load_dwordx4 v[192:195], v242, s[4:7], s41 offen sc1
  s_add_u32 s75, s75, 1
  s_cmp_gt_u32 s75, 300000
  s_cbranch_scc1 L_end
  s_waitcnt vmcnt(0)
  v_bitop3_b32 v235, v172, v168, v180 bitop3:0xfe
  v_bitop3_b32 v235, v176, v188, v235 bitop3:0xfe
  v_bitop3_b32 v235, v184, v196, v235 bitop3:0xfe
  v_bitop3_b32 v235, v192, v235, 1 bitop3:0xa8
  v_cmp_ne_u32 vcc, 0, v235
  s_nop 4
  s_cbranch_vccnz SLOW_33
  s_branch BACK_34
SLOW_35:
  s_add_u32 s41, s50, 2048
  buffer_load_dwordx4 v[204:207], v246, s[4:7], s41 offen sc1
  s_add_u32 s41, s50, 2048
  buffer_load_dwordx4 v[200:203], v242, s[4:7], s41 offen sc1
  s_add_u32 s41, s50, 34816
  buffer_load_dwordx4 v[212:215], v246, s[4:7], s41 offen sc1
  s_add_u32 s41, s50, 34816
  buffer_load_dwordx4 v[208:211], v242, s[4:7], s41 offen sc1
  s_add_u32 s41, s50, 67584
  buffer_load_dwordx4 v[220:223], v246, s[4:7], s41 offen sc1
  s_add_u32 s41, s50, 67584
  buffer_load_dwordx4 v[216:219], v242, s[4:7], s41 offen sc1
  s_add_u32 s75, s75, 1
  s_cmp_gt_u32 s75, 300000
  s_cbranch_scc1 L_end
  s_waitcnt vmcnt(0)
  v_bitop3_b32 v235, v204, v200, v212 bitop3:0xfe
  v_bitop3_b32 v235, v208, v220, v235 bitop3:0xfe
  v_bitop3_b32 v235, v216, v235, 1 bitop3:0xa8
  v_cmp_ne_u32 vcc, 0, v235
  s_nop 4
  s_cbranch_vccnz SLOW_35
  s_branch BACK_36
SLOW_37:
  s_add_u32 s41, s53, 2048
  buffer_load_dwordx4 v[228:231], v246, s[4:7], s41 offen sc1
  s_add_u32 s41, s53, 2048
  buffer_load_dwordx4 v[224:227], v242, s[4:7], s41 offen sc1
  s_add_u32 s41, s50, 19456
  buffer_load_dwordx4 v[36:39], v246, s[4:7], s41 offen sc1
  s_add_u32 s41, s50, 19456
  buffer_load_dwordx4 v[32:35], v242, s[4:7], s41 offen sc1
  s_add_u32 s41, s50, 52224
  buffer_load_dwordx4 v[44:47], v246, s[4:7], s41 offen sc1
  s_add_u32 s41, s50, 52224
  buffer_load_dwordx4 v[40:43], v242, s[4:7], s41 offen sc1
  s_add_u32 s41, s50, 84992
  buffer_load_dwordx4 v[52:55], v246, s[4:7], s41 offen sc1
  s_add_u32 s41, s50, 84992
  buffer_load_dwordx4 v[48:51], v242, s[4:7], s41 offen sc1
  s_add_u32 s75, s75, 1
  s_cmp_gt_u32 s75, 300000
  s_cbranch_scc1 L_end
  s_waitcnt vmcnt(0)
  v_bitop3_b32 v235, v228, v224, v36 bitop3:0xfe
  v_bitop3_b32 v235, v32, v44, v235 bitop3:0xfe
  v_bitop3_b32 v235, v40, v52, v235 bitop3:0xfe
  v_bitop3_b32 v235, v48, v235, 1 bitop3:0xa8
  v_cmp_ne_u32 vcc, 0, v235
  s_nop 4
  s_cbranch_vccnz SLOW_37
  s_branch BACK_38
SLOW_39:
  s_add_u32 s41, s50, 4096
  buffer_load_dwordx4 v[60:63], v246, s[4:7], s41 offen sc1
  s_add_u32 s41, s50, 4096
  buffer_load_dwordx4 v[56:59], v242, s[4:7], s41 offen sc1
  s_add_u32 s41, s50, 36864
  buffer_load_dwordx4 v[68:71], v246, s[4:7], s41 offen sc1
  s_add_u32 s41, s50, 36864
  buffer_load_dwordx4 v[64:67], v242, s[4:7], s41 offen sc1
  s_add_u32 s41, s50, 69632
  buffer_load_dwordx4 v[76:79], v246, s[4:7], s41 offen sc1
  s_add_u32 s41, s50, 69632
  buffer_load_dwordx4 v[72:75], v242, s[4:7], s41 offen sc1
  s_add_u32 s75, s75, 1
  s_cmp_gt_u32 s75, 300000
  s_cbranch_scc1 L_end
  s_waitcnt vmcnt(0)
  v_bitop3_b32 v235, v60, v56, v68 bitop3:0xfe
  v_bitop3_b32 v235, v64, v76, v235 bitop3:0xfe
  v_bitop3_b32 v235, v72, v235, 1 bitop3:0xa8
  v_cmp_ne_u32 vcc, 0, v235
  s_nop 4
  s_cbranch_vccnz SLOW_39
  s_branch BACK_40
SLOW_41:
  s_add_u32 s41, s53, 4096
  buffer_load_dwordx4 v[84:87], v246, s[4:7], s41 offen sc1
  s_add_u32 s41, s53, 4096
  buffer_load_dwordx4 v[80:83], v242, s[4:7], s41 offen sc1
  s_add_u32 s41, s50, 21504
  buffer_load_dwordx4 v[92:95], v246, s[4:7], s41 offen sc1
  s_add_u32 s41, s50, 21504
  buffer_load_dwordx4 v[88:91], v242, s[4:7], s41 offen sc1
  s_add_u32 s41, s50, 54272
  buffer_load_dwordx4 v[100:103], v246, s[4:7], s41 offen sc1
  s_add_u32 s41, s50, 54272
  buffer_load_dwordx4 v[96:99], v242, s[4:7], s41 offen sc1
  s_add_u32 s41, s50, 87040
  buffer_load_dwordx4 v[108:111], v246, s[4:7], s41 offen sc1
  s_add_u32 s41, s50, 87040
  buffer_load_dwordx4 v[104:107], v242, s[4:7], s41 offen sc1
  s_add_u32 s75, s75, 1
  s_cmp_gt_u32 s75, 300000
  s_cbranch_scc1 L_end
  s_waitcnt vmcnt(0)
  v_bitop3_b32 v235, v84, v80, v92 bitop3:0xfe
  v_bitop3_b32 v235, v88, v100, v235 bitop3:0xfe
  v_bitop3_b32 v235, v96, v108, v235 bitop3:0xfe
  v_bitop3_b32 v235, v104, v235, 1 bitop3:0xa8
  v_cmp_ne_u32 vcc, 0, v235
  s_nop 4
  s_cbranch_vccnz SLOW_41
  s_branch BACK_42
SLOW_43:
  s_add_u32 s41, s50, 6144
  buffer_load_dwordx4 v[116:119], v246, s[4:7], s41 offen sc1
  s_add_u32 s41, s50, 6144
  buffer_load_dwordx4 v[112:115], v242, s[4:7], s41 offen sc1
  s_add_u32 s41, s50, 38912
  buffer_load_dwordx4 v[124:127], v246, s[4:7], s41 offen sc1
  s_add_u32 s41, s50, 38912
  buffer_load_dwordx4 v[120:123], v242, s[4:7], s41 offen sc1
  s_add_u32 s41, s50, 71680
  buffer_load_dwordx4 v[132:135], v246, s[4:7], s41 offen sc1
  s_add_u32 s41, s50, 71680
  buffer_load_dwordx4 v[128:131], v242, s[4:7], s41 offen sc1
  s_add_u32 s75, s75, 1
  s_cmp_gt_u32 s75, 300000
  s_cbranch_scc1 L_end
  s_waitcnt vmcnt(0)
  v_bitop3_b32 v235, v116, v112, v124 bitop3:0xfe
  v_bitop3_b32 v235, v120, v132, v235 bitop3:0xfe
  v_bitop3_b32 v235, v128, v235, 1 bitop3:0xa8
  v_cmp_ne_u32 vcc, 0, v235
  s_nop 4
  s_cbranch_vccnz SLOW_43
  s_branch BACK_44
SLOW_45:
  s_add_u32 s41, s53, 6144
  buffer_load_dwordx4 v[140:143], v246, s[4:7], s41 offen sc1
  s_add_u32 s41, s50, 23552
  buffer_load_dwordx4 v[148:151], v246, s[4:7], s41 offen sc1
  s_add_u32 s41, s50, 56320
  buffer_load_dwordx4 v[156:159], v246, s[4:7], s41 offen sc1
  s_add_u32 s41, s50, 89088
  buffer_load_dwordx4 v[164:167], v246, s[4:7], s41 offen sc1
  s_add_u32 s75, s75, 1
  s_cmp_gt_u32 s75, 300000
  s_cbranch_scc1 L_end
  s_waitcnt vmcnt(0)
  v_bitop3_b32 v235, v140, v148, v156 bitop3:0xfe
  v_bitop3_b32 v235, v164, v235, 1 bitop3:0xa8
  v_cmp_ne_u32 vcc, 0, v235
  s_nop 4
  s_cbranch_vccnz SLOW_45
  s_branch BACK_46
SLOW_47:
  s_add_u32 s41, s53, 6144
  buffer_load_dwordx4 v[136:139], v242, s[4:7], s41 offen sc1
  s_add_u32 s41, s50, 23552
  buffer_load_dwordx4 v[144:147], v242, s[4:7], s41 offen sc1
  s_add_u32 s41, s50, 56320
  buffer_load_dwordx4 v[152:155], v242, s[4:7], s41 offen sc1
  s_add_u32 s41, s50, 89088
  buffer_load_dwordx4 v[160:163], v242, s[4:7], s41 offen sc1
  s_add_u32 s75, s75, 1
  s_cmp_gt_u32 s75, 300000
  s_cbranch_scc1 L_end
  s_waitcnt vmcnt(0)
  v_bitop3_b32 v235, v136, v144, v152 bitop3:0xfe
  v_bitop3_b32 v235, v160, v235, 1 bitop3:0xa8
  v_cmp_ne_u32 vcc, 0, v235
  s_nop 4
  s_cbranch_vccnz SLOW_47
  s_branch BACK_48
SLOW_49:
  buffer_load_dwordx4 v[144:147], v255, s[4:7], s96 offen offset:0 sc1
  buffer_load_dwordx4 v[148:151], v255, s[4:7], s96 offen offset:1024 sc1
  buffer_load_dwordx4 v[152:155], v255, s[4:7], s96 offen offset:2048 sc1
  s_mov_b64 exec, s[78:79]
  buffer_load_dwordx4 v[156:159], v255, s[4:7], s96 offen offset:3072 sc1
  s_mov_b64 exec, -1
  s_add_u32 s75, s75, 1
  s_cmp_gt_u32 s75, 300000
  s_cbranch_scc1 L_end
  s_waitcnt vmcnt(0)
  v_cmp_ne_u64 vcc, v[146:147], s[38:39]
  v_cmp_ne_u64 s[88:89], v[150:151], s[38:39]
  v_cmp_ne_u64 s[92:93], v[154:155], s[38:39]
  v_cmp_ne_u64 s[94:95], v[158:159], s[38:39]
  s_or_b64 s[88:89], s[88:89], vcc
  s_or_b64 s[92:93], s[92:93], s[94:95]
  s_or_b64 s[88:89], s[88:89], s[92:93]
  s_cbranch_scc1 SLOW_49
  s_branch BACK_50
SLOW_53:
  s_add_u32 s41, s93, s24
  buffer_load_dwordx4 v[112:115], v255, s[4:7], s41 offen offset:0 sc1
  buffer_load_dwordx4 v[116:119], v255, s[4:7], s41 offen offset:1024 sc1
  buffer_load_dwordx4 v[120:123], v255, s[4:7], s41 offen offset:2048 sc1
  buffer_load_dwordx4 v[124:127], v255, s[4:7], s41 offen offset:3072 sc1
  s_add_u32 s75, s75, 1
  s_cmp_gt_u32 s75, 300000
  s_cbranch_scc1 L_end
  s_waitcnt vmcnt(0)
  v_bitop3_b32 v254, v112, v116, 1 bitop3:0x80
  v_bitop3_b32 v254, v120, v124, v254 bitop3:0x80
  v_cmp_ne_u32 vcc, 1, v254
  s_nop 4
  s_cbranch_vccnz SLOW_53
  s_branch BACK_54
SLOW_55:
  s_add_u32 s41, s93, s25
  buffer_load_dwordx4 v[128:131], v255, s[4:7], s41 offen offset:0 sc1
  buffer_load_dwordx4 v[132:135], v255, s[4:7], s41 offen offset:1024 sc1
  buffer_load_dwordx4 v[136:139], v255, s[4:7], s41 offen offset:2048 sc1
  buffer_load_dwordx4 v[140:143], v255, s[4:7], s41 offen offset:3072 sc1
  s_add_u32 s75, s75, 1
  s_cmp_gt_u32 s75, 300000
  s_cbranch_scc1 L_end
  s_waitcnt vmcnt(0)
  v_bitop3_b32 v254, v128, v132, 1 bitop3:0x80
  v_bitop3_b32 v254, v136, v140, v254 bitop3:0x80
  v_cmp_ne_u32 vcc, 1, v254
  s_nop 4
  s_cbranch_vccnz SLOW_55
  s_branch BACK_56
SLOW_57:
  s_add_u32 s41, s93, s26
  buffer_load_dwordx4 v[144:147], v255, s[4:7], s41 offen offset:0 sc1
  buffer_load_dwordx4 v[148:151], v255, s[4:7], s41 offen offset:1024 sc1
  buffer_load_dwordx4 v[152:155], v255, s[4:7], s41 offen offset:2048 sc1
  buffer_load_dwordx4 v[156:159], v255, s[4:7], s41 offen offset:3072 sc1
  s_add_u32 s75, s75, 1
  s_cmp_gt_u32 s75, 300000
  s_cbranch_scc1 L_end
  s_waitcnt vmcnt(0)
  v_bitop3_b32 v254, v144, v148, 1 bitop3:0x80
  v_bitop3_b32 v254, v152, v156, v254 bitop3:0x80
  v_cmp_ne_u32 vcc, 1, v254
  s_nop 4
  s_cbranch_vccnz SLOW_57
  s_branch BACK_58
SLOW_59:
  s_add_u32 s41, s93, s27
  buffer_load_dwordx4 v[160:163], v255, s[4:7], s41 offen offset:0 sc1
  buffer_load_dwordx4 v[164:167], v255, s[4:7], s41 offen offset:1024 sc1
  buffer_load_dwordx4 v[168:171], v255, s[4:7], s41 offen offset:2048 sc1
  buffer_load_dwordx4 v[172:175], v255, s[4:7], s41 offen offset:3072 sc1
  s_add_u32 s75, s75, 1
  s_cmp_gt_u32 s75, 300000
  s_cbranch_scc1 L_end
  s_waitcnt vmcnt(0)
  v_bitop3_b32 v254, v160, v164, 1 bitop3:0x80
  v_bitop3_b32 v254, v168, v172, v254 bitop3:0x80
  v_cmp_ne_u32 vcc, 1, v254
  s_nop 4
  s_cbranch_vccnz SLOW_59
  s_branch BACK_60
SLOW_61:
  s_add_u32 s41, s93, s28
  buffer_load_dwordx4 v[176:179], v255, s[4:7], s41 offen offset:0 sc1
  buffer_load_dwordx4 v[180:183], v255, s[4:7], s41 offen offset:1024 sc1
  buffer_load_dwordx4 v[184:187], v255, s[4:7], s41 offen offset:2048 sc1
  buffer_load_dwordx4 v[188:191], v255, s[4:7], s41 offen offset:3072 sc1
  s_add_u32 s75, s75, 1
  s_cmp_gt_u32 s75, 300000
  s_cbranch_scc1 L_end
  s_waitcnt vmcnt(0)
  v_bitop3_b32 v254, v176, v180, 1 bitop3:0x80
  v_bitop3_b32 v254, v184, v188, v254 bitop3:0x80
  v_cmp_ne_u32 vcc, 1, v254
  s_nop 4
  s_cbranch_vccnz SLOW_61
  s_branch BACK_62
SLOW_63:
  s_add_u32 s41, s93, s29
  buffer_load_dwordx4 v[192:195], v255, s[4:7], s41 offen offset:0 sc1
  buffer_load_dwordx4 v[196:199], v255, s[4:7], s41 offen offset:1024 sc1
  buffer_load_dwordx4 v[200:203], v255, s[4:7], s41 offen offset:2048 sc1
  buffer_load_dwordx4 v[204:207], v255, s[4:7], s41 offen offset:3072 sc1
  s_add_u32 s75, s75, 1
  s_cmp_gt_u32 s75, 300000
  s_cbranch_scc1 L_end
  s_waitcnt vmcnt(0)
  v_bitop3_b32 v254, v192, v196, 1 bitop3:0x80
  v_bitop3_b32 v254, v200, v204, v254 bitop3:0x80
  v_cmp_ne_u32 vcc, 1, v254
  s_nop 4
  s_cbranch_vccnz SLOW_63
  s_branch BACK_64
SLOW_65:
  s_add_u32 s41, s93, s30
  buffer_load_dwordx4 v[208:211], v255, s[4:7], s41 offen offset:0 sc1
  buffer_load_dwordx4 v[212:215], v255, s[4:7], s41 offen offset:1024 sc1
  buffer_load_dwordx4 a[240:243], v255, s[4:7], s41 offen offset:2048 sc1
  buffer_load_dwordx4 a[244:247], v255, s[4:7], s41 offen offset:3072 sc1
  s_add_u32 s75, s75, 1
  s_cmp_gt_u32 s75, 300000
  s_cbranch_scc1 L_end
  s_waitcnt vmcnt(0)
  v_accvgpr_read_b32 v240, a240
  v_accvgpr_read_b32 v241, a244
  v_bitop3_b32 v254, v208, v212, 1 bitop3:0x80
  v_bitop3_b32 v254, v240, v241, v254 bitop3:0x80
  v_cmp_ne_u32 vcc, 1, v254
  s_nop 4
  s_cbranch_vccnz SLOW_65
  s_branch BACK_66
SLOW_67:
  buffer_load_dwordx2 v[248:249], v247, s[4:7], s97 offen sc1
  s_add_u32 s75, s75, 1
  s_cmp_gt_u32 s75, 300000
  s_cbranch_scc1 L_end
  s_waitcnt vmcnt(0)
  v_cmp_ne_u64 vcc, v[248:249], s[38:39]
  s_nop 4
  s_cbranch_vccnz SLOW_67
  s_branch BACK_68
SLOW_87:
  s_add_u32 s41, s50, 0
  buffer_load_dwordx4 v[148:151], v246, s[4:7], s41 offen sc1
  s_add_u32 s41, s50, 0
  buffer_load_dwordx4 v[144:147], v242, s[4:7], s41 offen sc1
  s_add_u32 s41, s50, 32768
  buffer_load_dwordx4 v[156:159], v246, s[4:7], s41 offen sc1
  s_add_u32 s41, s50, 32768
  buffer_load_dwordx4 v[152:155], v242, s[4:7], s41 offen sc1
  s_add_u32 s41, s50, 65536
  buffer_load_dwordx4 v[164:167], v246, s[4:7], s41 offen sc1
  s_add_u32 s41, s50, 65536
  buffer_load_dwordx4 v[160:163], v242, s[4:7], s41 offen sc1
  s_add_u32 s75, s75, 1
  s_cmp_gt_u32 s75, 300000
  s_cbranch_scc1 L_end
  s_waitcnt vmcnt(0)
  v_bitop3_b32 v235, v148, v144, v156 bitop3:0x80
  v_bitop3_b32 v235, v152, v164, v235 bitop3:0x80
  v_bitop3_b32 v235, v160, v235, 1 bitop3:0x80
  v_cmp_ne_u32 vcc, 1, v235
  s_nop 4
  s_cbranch_vccnz SLOW_87
  s_branch BACK_88
SLOW_89:
  s_add_u32 s41, s53, 0
  buffer_load_dwordx4 v[172:175], v246, s[4:7], s41 offen sc1
  s_add_u32 s41, s53, 0
  buffer_load_dwordx4 v[168:171], v242, s[4:7], s41 offen sc1
  s_add_u32 s41, s50, 17408
  buffer_load_dwordx4 v[180:183], v246, s[4:7], s41 offen sc1
  s_add_u32 s41, s50, 17408
  buffer_load_dwordx4 v[176:179], v242, s[4:7], s41 offen sc1
  s_add_u32 s41, s50, 50176
  buffer_load_dwordx4 v[188:191], v246, s[4:7], s41 offen sc1
  s_add_u32 s41, s50, 50176
  buffer_load_dwordx4 v[184:187], v242, s[4:7], s41 offen sc1
  s_add_u32 s41, s50, 82944
  buffer_load_dwordx4 v[196:199], v246, s[4:7], s41 offen sc1
  s_add_u32 s41, s50, 82944
  buffer_load_dwordx4 v[192:195], v242, s[4:7], s41 offen sc1
  s_add_u32 s75, s75, 1
  s_cmp_gt_u32 s75, 300000
  s_cbranch_scc1 L_end
  s_waitcnt vmcnt(0)
  v_bitop3_b32 v235, v172, v168, v180 bitop3:0x80
  v_bitop3_b32 v235, v176, v188, v235 bitop3:0x80
  v_bitop3_b32 v235, v184, v196, v235 bitop3:0x80
  v_bitop3_b32 v235, v192, v235, 1 bitop3:0x80
  v_cmp_ne_u32 vcc, 1, v235
  s_nop 4
  s_cbranch_vccnz SLOW_89
  s_branch BACK_90
SLOW_91:
  s_add_u32 s41, s50, 2048
  buffer_load_dwordx4 v[204:207], v246, s[4:7], s41 offen sc1
  s_add_u32 s41, s50, 2048
  buffer_load_dwordx4 v[200:203], v242, s[4:7], s41 offen sc1
  s_add_u32 s41, s50, 34816
  buffer_load_dwordx4 v[212:215], v246, s[4:7], s41 offen sc1
  s_add_u32 s41, s50, 34816
  buffer_load_dwordx4 v[208:211], v242, s[4:7], s41 offen sc1
  s_add_u32 s41, s50, 67584
  buffer_load_dwordx4 v[220:223], v246, s[4:7], s41 offen sc1
  s_add_u32 s41, s50, 67584
  buffer_load_dwordx4 v[216:219], v242, s[4:7], s41 offen sc1
  s_add_u32 s75, s75, 1
  s_cmp_gt_u32 s75, 300000
  s_cbranch_scc1 L_end
  s_waitcnt vmcnt(0)
  v_bitop3_b32 v235, v204, v200, v212 bitop3:0x80
  v_bitop3_b32 v235, v208, v220, v235 bitop3:0x80
  v_bitop3_b32 v235, v216, v235, 1 bitop3:0x80
  v_cmp_ne_u32 vcc, 1, v235
  s_nop 4
  s_cbranch_vccnz SLOW_91
  s_branch BACK_92
SLOW_93:
  s_add_u32 s41, s53, 2048
  buffer_load_dwordx4 v[228:231], v246, s[4:7], s41 offen sc1
  s_add_u32 s41, s53, 2048
  buffer_load_dwordx4 v[224:227], v242, s[4:7], s41 offen sc1
  s_add_u32 s41, s50, 19456
  buffer_load_dwordx4 v[36:39], v246, s[4:7], s41 offen sc1
  s_add_u32 s41, s50, 19456
  buffer_load_dwordx4 v[32:35], v242, s[4:7], s41 offen sc1
  s_add_u32 s41, s50, 52224
  buffer_load_dwordx4 v[44:47], v246, s[4:7], s41 offen sc1
  s_add_u32 s41, s50, 52224
  buffer_load_dwordx4 v[40:43], v242, s[4:7], s41 offen sc1
  s_add_u32 s41, s50, 84992
  buffer_load_dwordx4 v[52:55], v246, s[4:7], s41 offen sc1
  s_add_u32 s41, s50, 84992
  buffer_load_dwordx4 v[48:51], v242, s[4:7], s41 offen sc1
  s_add_u32 s75, s75, 1
  s_cmp_gt_u32 s75, 300000
  s_cbranch_scc1 L_end
  s_waitcnt vmcnt(0)
  v_bitop3_b32 v235, v228, v224, v36 bitop3:0x80
  v_bitop3_b32 v235, v32, v44, v235 bitop3:0x80
  v_bitop3_b32 v235, v40, v52, v235 bitop3:0x80
  v_bitop3_b32 v235, v48, v235, 1 bitop3:0x80
  v_cmp_ne_u32 vcc, 1, v235
  s_nop 4
  s_cbranch_vccnz SLOW_93
  s_branch BACK_94
SLOW_95:
  s_add_u32 s41, s50, 4096
  buffer_load_dwordx4 v[60:63], v246, s[4:7], s41 offen sc1
  s_add_u32 s41, s50, 4096
  buffer_load_dwordx4 v[56:59], v242, s[4:7], s41 offen sc1
  s_add_u32 s41, s50, 36864
  buffer_load_dwordx4 v[68:71], v246, s[4:7], s41 offen sc1
  s_add_u32 s41, s50, 36864
  buffer_load_dwordx4 v[64:67], v242, s[4:7], s41 offen sc1
  s_add_u32 s41, s50, 69632
  buffer_load_dwordx4 v[76:79], v246, s[4:7], s41 offen sc1
  s_add_u32 s41, s50, 69632
  buffer_load_dwordx4 v[72:75], v242, s[4:7], s41 offen sc1
  s_add_u32 s75, s75, 1
  s_cmp_gt_u32 s75, 300000
  s_cbranch_scc1 L_end
  s_waitcnt vmcnt(0)
  v_bitop3_b32 v235, v60, v56, v68 bitop3:0x80
  v_bitop3_b32 v235, v64, v76, v235 bitop3:0x80
  v_bitop3_b32 v235, v72, v235, 1 bitop3:0x80
  v_cmp_ne_u32 vcc, 1, v235
  s_nop 4
  s_cbranch_vccnz SLOW_95
  s_branch BACK_96
SLOW_97:
  s_add_u32 s41, s53, 4096
  buffer_load_dwordx4 v[84:87], v246, s[4:7], s41 offen sc1
  s_add_u32 s41, s53, 4096
  buffer_load_dwordx4 v[80:83], v242, s[4:7], s41 offen sc1
  s_add_u32 s41, s50, 21504
  buffer_load_dwordx4 v[92:95], v246, s[4:7], s41 offen sc1
  s_add_u32 s41, s50, 21504
  buffer_load_dwordx4 v[88:91], v242, s[4:7], s41 offen sc1
  s_add_u32 s41, s50, 54272
  buffer_load_dwordx4 v[100:103], v246, s[4:7], s41 offen sc1
  s_add_u32 s41, s50, 54272
  buffer_load_dwordx4 v[96:99], v242, s[4:7], s41 offen sc1
  s_add_u32 s41, s50, 87040
  buffer_load_dwordx4 v[108:111], v246, s[4:7], s41 offen sc1
  s_add_u32 s41, s50, 87040
  buffer_load_dwordx4 v[104:107], v242, s[4:7], s41 offen sc1
  s_add_u32 s75, s75, 1
  s_cmp_gt_u32 s75, 300000
  s_cbranch_scc1 L_end
  s_waitcnt vmcnt(0)
  v_bitop3_b32 v235, v84, v80, v92 bitop3:0x80
  v_bitop3_b32 v235, v88, v100, v235 bitop3:0x80
  v_bitop3_b32 v235, v96, v108, v235 bitop3:0x80
  v_bitop3_b32 v235, v104, v235, 1 bitop3:0x80
  v_cmp_ne_u32 vcc, 1, v235
  s_nop 4
  s_cbranch_vccnz SLOW_97
  s_branch BACK_98
SLOW_99:
  s_add_u32 s41, s50, 6144
  buffer_load_dwordx4 v[116:119], v246, s[4:7], s41 offen sc1
  s_add_u32 s41, s50, 6144
  buffer_load_dwordx4 v[112:115], v242, s[4:7], s41 offen sc1
  s_add_u32 s41, s50, 38912
  buffer_load_dwordx4 v[124:127], v246, s[4:7], s41 offen sc1
  s_add_u32 s41, s50, 38912
  buffer_load_dwordx4 v[120:123], v242, s[4:7], s41 offen sc1
  s_add_u32 s41, s50, 71680
  buffer_load_dwordx4 v[132:135], v246, s[4:7], s41 offen sc1
  s_add_u32 s41, s50, 71680
  buffer_load_dwordx4 v[128:131], v242, s[4:7], s41 offen sc1
  s_add_u32 s75, s75, 1
  s_cmp_gt_u32 s75, 300000
  s_cbranch_scc1 L_end
  s_waitcnt vmcnt(0)
  v_bitop3_b32 v235, v116, v112, v124 bitop3:0x80
  v_bitop3_b32 v235, v120, v132, v235 bitop3:0x80
  v_bitop3_b32 v235, v128, v235, 1 bitop3:0x80
  v_cmp_ne_u32 vcc, 1, v235
  s_nop 4
  s_cbranch_vccnz SLOW_99
  s_branch BACK_100
SLOW_101:
  s_add_u32 s41, s53, 6144
  buffer_load_dwordx4 v[140:143], v246, s[4:7], s41 offen sc1
  s_add_u32 s41, s50, 23552
  buffer_load_dwordx4 v[148:151], v246, s[4:7], s41 offen sc1
  s_add_u32 s41, s50, 56320
  buffer_load_dwordx4 v[156:159], v246, s[4:7], s41 offen sc1
  s_add_u32 s41, s50, 89088
  buffer_load_dwordx4 v[164:167], v246, s[4:7], s41 offen sc1
  s_add_u32 s75, s75, 1
  s_cmp_gt_u32 s75, 300000
  s_cbranch_scc1 L_end
  s_waitcnt vmcnt(0)
  v_bitop3_b32 v235, v140, v148, v156 bitop3:0x80
  v_bitop3_b32 v235, v164, v235, 1 bitop3:0x80
  v_cmp_ne_u32 vcc, 1, v235
  s_nop 4
  s_cbranch_vccnz SLOW_101
  s_branch BACK_102
SLOW_103:
  s_add_u32 s41, s53, 6144
  buffer_load_dwordx4 v[136:139], v242, s[4:7], s41 offen sc1
  s_add_u32 s41, s50, 23552
  buffer_load_dwordx4 v[144:147], v242, s[4:7], s41 offen sc1
  s_add_u32 s41, s50, 56320
  buffer_load_dwordx4 v[152:155], v242, s[4:7], s41 offen sc1
  s_add_u32 s41, s50, 89088
  buffer_load_dwordx4 v[160:163], v242, s[4:7], s41 offen sc1
  s_add_u32 s75, s75, 1
  s_cmp_gt_u32 s75, 300000
  s_cbranch_scc1 L_end
  s_waitcnt vmcnt(0)
  v_bitop3_b32 v235, v136, v144, v152 bitop3:0x80
  v_bitop3_b32 v235, v160, v235, 1 bitop3:0x80
  v_cmp_ne_u32 vcc, 1, v235
  s_nop 4
  s_cbranch_vccnz SLOW_103
  s_branch BACK_104
SLOW_105:
  buffer_load_dwordx4 v[144:147], v255, s[4:7], s96 offen offset:0 sc1
  buffer_load_dwordx4 v[148:151], v255, s[4:7], s96 offen offset:1024 sc1
  buffer_load_dwordx4 v[152:155], v255, s[4:7], s96 offen offset:2048 sc1
  s_mov_b64 exec, s[78:79]
  buffer_load_dwordx4 v[156:159], v255, s[4:7], s96 offen offset:3072 sc1
  s_mov_b64 exec, -1
  s_add_u32 s75, s75, 1
  s_cmp_gt_u32 s75, 300000
  s_cbranch_scc1 L_end
  s_waitcnt vmcnt(0)
  v_cmp_ne_u64 vcc, v[146:147], s[38:39]
  v_cmp_ne_u64 s[88:89], v[150:151], s[38:39]
  v_cmp_ne_u64 s[92:93], v[154:155], s[38:39]
  v_cmp_ne_u64 s[94:95], v[158:159], s[38:39]
  s_or_b64 s[88:89], s[88:89], vcc
  s_or_b64 s[92:93], s[92:93], s[94:95]
  s_or_b64 s[88:89], s[88:89], s[92:93]
  s_cbranch_scc1 SLOW_105
  s_branch BACK_106
L_code_end:
.section .rodata,"a"
.p2align 6
.amdhsa_kernel interleave_layers__spectral_fnet__swiglu_ffn__prompt_kernel
  .amdhsa_next_free_vgpr 512
  .amdhsa_next_free_sgpr 102
  .amdhsa_accum_offset 256
  .amdhsa_group_segment_fixed_size 0
  .amdhsa_kernarg_size 96
  .amdhsa_user_sgpr_count 2
  .amdhsa_user_sgpr_kernarg_segment_ptr 1
  .amdhsa_system_sgpr_workgroup_id_x 1
.end_amdhsa_kernel
```
